```python
import torch

def _softmax(x, axis=-1):
    return torch.softmax(x, dim=axis)
def _gelu(x):
    return torch.nn.functional.gelu(x, approximate="tanh")
def _silu(x):
    return torch.nn.functional.silu(x)
def _sigmoid(x):
    return torch.sigmoid(x)
def _layernorm(x, axis=-1, eps=1e-5):
    m = x.mean(dim=axis, keepdim=True)
    v = x.var(dim=axis, keepdim=True, unbiased=False)
    return (x - m) / torch.sqrt(v + eps)
def _scatter_add(tgt, idx, src, axis=0):
    return tgt.clone().index_add_(axis, idx, src)
def _segment_sum(src, seg, n):
    out = torch.zeros((n,) + src.shape[1:], dtype=src.dtype)
    return out.index_add_(0, seg, src)
def _pad(x, pw):
    flat = tuple(v for pair in reversed(pw) for v in pair)
    return torch.nn.functional.pad(x, flat)

kernel_name = 'gated_mix__softmax_full_mha__mixer_token_mlp__prompt'

def setup_inputs():

    _w = (lambda a: (lambda t: t.to(torch.bfloat16) if t.is_floating_point() else t)(torch.as_tensor(a)))
    def _A_setup():
        B, S, D = 1, 2048, 576
        return {
            "x": _w((lambda *s: torch.randn(*s, dtype=torch.bfloat16) * 0.05)(B, S, D)),
            "wqkv": _w((lambda *s: torch.randn(*s, dtype=torch.bfloat16) * 0.8)(D, 3 * D)),
            "wo": _w((lambda *s: torch.randn(*s, dtype=torch.bfloat16) * 0.05)(D, D)),
        }
    _A_in = _A_setup()

    def _B_setup():
        B, S, D, F = 1, 2048, 576, 4608
        return {
            "x": _w((lambda *s: torch.randn(*s, dtype=torch.bfloat16) * 0.05)(B, S, D)),
            "w1": _w((lambda *s: torch.randn(*s, dtype=torch.bfloat16) * 0.8)(S, F) * (S ** -0.5)),
            "b1": _w((lambda *s: torch.randn(*s, dtype=torch.bfloat16) * 12.8)(F) * 0.02),
            "w2": _w((lambda *s: torch.randn(*s, dtype=torch.bfloat16) * 0.1)(F, S) * (F ** -0.5)),
            "b2": _w((lambda *s: torch.randn(*s, dtype=torch.bfloat16) * 1.6)(S) * 0.02),
        }
    _B_in = _B_setup()

    return {
        "A_x": _A_in["x"],
        "A_wqkv": _A_in["wqkv"],
        "A_wo": _A_in["wo"],
        "B_x": _B_in["x"],
        "B_w1": _B_in["w1"],
        "B_b1": _B_in["b1"],
        "B_w2": _B_in["w2"],
        "B_b2": _B_in["b2"],
        "gate_w": _w((lambda *s: torch.randn(*s, dtype=torch.bfloat16) * 0.05)(576) * 16.0),
    }

def reference(A_x, A_wqkv, A_wo, B_x, B_w1, B_b1, B_w2, B_b2, gate_w):
    def _A_ref(x, wqkv, wo):
        B, S, D = x.shape
        H = 32; Dh = D // H
        qkv = (lambda x, *d: x.permute(*d))((x @ wqkv).reshape(B, S, 3, H, Dh), 2, 0, 3, 1, 4)
        q, k, v = qkv[0], qkv[1], qkv[2]
        scale = Dh ** -0.5
        scores = torch.einsum("bhqd,bhkd->bhqk", q, k) * scale
        p = _softmax(scores, axis=-1)
        o = torch.einsum("bhqk,bhkd->bhqd", p, v)
        return (lambda x, *d: x.permute(*d))(o, 0, 2, 1, 3).reshape(B, S, D) @ wo

    def _B_ref(x, w1, b1, w2, b2):
        B, S, D = x.shape
        h = _layernorm(x, axis=-1)
        u = torch.einsum("bsd,sf->bdf", h, w1) + b1
        u = _gelu(u)
        y = torch.einsum("bdf,fs->bds", u, w2) + b2
        return (lambda x, *d: x.permute(*d))(y, 0, 2, 1)

    x = A_x
    g = _sigmoid((x * gate_w).sum(-1, keepdims=True))
    a = _A_ref(x, A_wqkv, A_wo)
    b = _B_ref(x, B_w1, B_b1, B_w2, B_b2)
    return g * a + (1 - g) * b
```

```asm
; @launch grid=(512,1,1) block=(256,1,1) lds=81920
.amdgcn_target "amdgcn-amd-amdhsa--gfx950"
.text
.globl gated_mix__softmax_full_mha__mixer_token_mlp__prompt_kernel
.p2align 8
.type gated_mix__softmax_full_mha__mixer_token_mlp__prompt_kernel,@function
gated_mix__softmax_full_mha__mixer_token_mlp__prompt_kernel:
  s_cmp_ge_u32 s2, 512
  s_cbranch_scc1 END_1
  s_load_dwordx16 s[64:79], s[0:1], 0
  s_load_dwordx8 s[80:87], s[0:1], 64
  v_and_b32 v1, 63, v0
  v_lshrrev_b32 v5, 6, v0
  s_nop 0
  v_readfirstlane_b32 s20, v5
  v_lshrrev_b32 v2, 5, v1
  v_and_b32 v3, 31, v1
  v_lshlrev_b32 v4, 4, v1
  s_lshr_b32 s3, s2, 8
  s_and_b32 s2, s2, 255
  s_setprio 3
  s_cmp_ge_u32 s2, 192
  s_cselect_b32 s21, 1, 0
  s_xor_b32 s3, s3, s21
  s_cmp_eq_u32 s3, 0
  s_cbranch_scc1 ROLEA_2
  s_cmp_ge_u32 s2, 192
  s_cbranch_scc1 LN_3
  s_waitcnt lgkmcnt(0)
  s_mov_b32 s16, s86
  s_and_b32 s17, s87, 0xffff
  s_mov_b32 s18, 22171648
  s_mov_b32 s19, 0x20000
  s_mov_b32 s12, s84
  s_and_b32 s13, s85, 0xffff
  s_mov_b32 s14, 256
  s_mov_b32 s15, 0x20000
  s_lshl_b32 s21, s2, 2
  s_add_u32 s21, s21, s20
  s_cmp_lg_u32 s21, 1
  s_cbranch_scc1 NOZ_9
  v_mov_b32 v12, 0
  v_mov_b32 v13, 0
  v_mov_b32 v14, 0
  v_mov_b32 v15, 0
  v_lshlrev_b32 v6, 8, v1
  s_mov_b32 s21, 17387520
  buffer_store_dwordx4 v[12:15], v6, s[16:19], s21 offen offset:0 sc1
  buffer_store_dwordx4 v[12:15], v6, s[16:19], s21 offen offset:16 sc1
  buffer_store_dwordx4 v[12:15], v6, s[16:19], s21 offen offset:32 sc1
  buffer_store_dwordx4 v[12:15], v6, s[16:19], s21 offen offset:48 sc1
  buffer_store_dwordx4 v[12:15], v6, s[16:19], s21 offen offset:64 sc1
  buffer_store_dwordx4 v[12:15], v6, s[16:19], s21 offen offset:80 sc1
  buffer_store_dwordx4 v[12:15], v6, s[16:19], s21 offen offset:96 sc1
  buffer_store_dwordx4 v[12:15], v6, s[16:19], s21 offen offset:112 sc1
  buffer_store_dwordx4 v[12:15], v6, s[16:19], s21 offen offset:128 sc1
  buffer_store_dwordx4 v[12:15], v6, s[16:19], s21 offen offset:192 sc1
  v_mov_b32 v7, 1
  s_waitcnt vmcnt(0)
  s_mov_b64 exec, 1
  buffer_store_dword v7, v12, s[12:15], 0 offen offset:132 sc1
  s_mov_b64 exec, -1
NOZ_9:
  s_cmp_ge_u32 s20, 2
  s_cbranch_scc1 TW5_10
  s_mov_b32 s8, s66
  s_and_b32 s9, s67, 0xffff
  s_mov_b32 s10, 1990656
  s_mov_b32 s11, 0x20000
  s_lshr_b32 s21, s2, 5
  s_mul_i32 s22, s21, 3
  s_bfe_u32 s23, s2, 0x20003
  s_mul_i32 s23, s23, 9
  s_add_u32 s23, s23, 1
  s_lshr_b32 s23, s23, 1
  s_add_u32 s22, s22, s23
  s_add_u32 s22, s22, 4
  s_sub_u32 s23, s22, 18
  s_cmp_ge_u32 s22, 18
  s_cselect_b32 s22, s23, s22
  s_lshl_b32 s22, s22, 1
  s_add_u32 s22, s22, s20
  s_mul_i32 s22, s22, 55296
  s_bfe_u32 s23, s2, 0x10002
  s_mul_i32 s23, s23, 6
  s_add_u32 s23, s23, s21
  s_mul_i32 s23, s23, 288
  s_add_u32 s22, s22, s23
  v_lshrrev_b32 v5, 2, v1
  v_mul_u32_u24 v5, 3456, v5
  v_and_b32 v6, 3, v1
  v_mul_u32_u24 v6, 92, v6
  v_add_u32 v5, v5, v6
  buffer_load_dword v9, v5, s[8:11], s22 offen
TW5_10:
  s_mov_b32 s52, s76
  s_and_b32 s53, s77, 0xffff
  s_mov_b32 s54, 18874368
  s_mov_b32 s55, 0x20000
  s_mov_b32 s56, s68
  s_and_b32 s57, s69, 0xffff
  s_mov_b32 s58, 663552
  s_mov_b32 s59, 0x20000
  s_mov_b32 s44, s78
  s_and_b32 s45, s79, 0xffff
  s_mov_b32 s46, 4096
  s_mov_b32 s47, 0x20000
  s_mov_b32 s48, s82
  s_and_b32 s49, s83, 0xffff
  s_mov_b32 s50, 2359296
  s_mov_b32 s51, 0x20000
  s_lshr_b32 s21, s2, 3
  s_mul_i32 s22, s21, 43
  s_lshr_b32 s22, s22, 8
  s_mul_i32 s23, s22, 6
  s_sub_u32 s39, s21, s23
  s_lshl_b32 s23, s20, 3
  s_add_u32 s23, s23, 256
  s_mov_b32 s33, 3
  s_mul_i32 s89, s20, 44
  s_sub_u32 s89, s89, 264
  s_lshl_b32 s62, s20, 2
  s_add_u32 s62, s62, 768
  s_lshr_b32 s90, s20, 1
  s_lshl_b32 s90, s90, 8
  s_and_b32 s38, s2, 7
  s_lshl_b32 s38, s38, 2
  s_add_u32 s38, s38, s22
  s_mul_i32 s21, s39, 288
  s_add_u32 s21, s21, s23
  s_mul_i32 s40, s21, 3072
  s_add_u32 s40, s40, 2363392
  s_lshl_b32 s41, s23, 16
  s_lshl_b32 s21, s38, 7
  s_add_u32 s41, s41, s21
  s_lshl_b32 s21, s39, 10
  s_add_u32 s21, s21, 17388544
  s_add_u32 s62, s62, s21
  s_add_u32 s90, s90, s21
  s_mul_i32 s91, s89, 3072
  s_lshl_b32 s89, s89, 16
  s_mul_i32 s63, s38, 6
  s_add_u32 s63, s63, s39
  s_mul_i32 s63, s63, 24576
  s_add_u32 s63, s63, 17453056
  s_cmp_ge_u32 s39, 3
  s_cselect_b32 s21, 3, 0
  s_cselect_b32 s22, 8, 0
  s_sub_u32 s21, s39, s21
  s_lshl_b32 s21, s21, 2
  s_and_b32 s88, s38, 3
  s_lshl_b32 s88, s88, 4
  s_add_u32 s88, s88, s22
  s_lshr_b32 s22, s38, 2
  s_add_u32 s88, s88, s22
  s_lshl_b32 s88, s88, 8
  s_add_u32 s88, s88, s21
  s_add_u32 s88, s88, 17387584
  s_mul_i32 s42, s20, 20480
  v_lshrrev_b32 v5, 3, v1
  v_lshrrev_b32 v6, 4, v1
  v_lshlrev_b32 v6, 1, v6
  v_and_b32 v7, 7, v1
  v_xor_b32 v6, v6, v7
  v_lshlrev_b32 v5, 12, v5
  v_lshl_add_u32 v11, v6, 4, v5
  v_add_u32 v12, 31744, v11
  v_and_b32 v5, 15, v1
  v_bfe_u32 v6, v1, 4, 1
  v_lshlrev_b32 v6, 9, v6
  v_lshl_add_u32 v8, v5, 4, v6
  v_mul_u32_u24 v10, 3072, v2
  v_add_u32 v10, v10, v8
  v_lshl_add_u32 v33, v2, 10, v8
  v_bfe_u32 v5, v1, 2, 3
  v_lshl_add_u32 v6, v2, 4, v5
  v_and_b32 v7, 3, v1
  v_lshlrev_b32 v7, 3, v7
  v_add_u32 v7, s42, v7
  v_mul_u32_u24 v32, 192, v6
  v_add_u32 v32, v32, v7
  v_lshl_add_u32 v6, v6, 7, v7
  v_lshrrev_b32 v5, 1, v5
  v_xor_b32 v5, s20, v5
  v_xor_b32 v7, 0, v5
  v_lshl_add_u32 v13, v7, 5, v6
  v_xor_b32 v7, 1, v5
  v_lshl_add_u32 v14, v7, 5, v6
  v_xor_b32 v7, 2, v5
  v_lshl_add_u32 v15, v7, 5, v6
  v_xor_b32 v7, 3, v5
  v_lshl_add_u32 v16, v7, 5, v6
  s_lshl_b32 s22, s38, 6
  s_lshl_b32 s21, s20, 4
  s_add_u32 s21, s21, s22
  v_and_b32 v5, 15, v1
  v_add_u32 v5, s21, v5
  v_lshlrev_b32 v6, 1, v5
  v_lshlrev_b32 v18, 3, v5
  v_add_u32 v18, 15011844, v18
  buffer_load_ushort v17, v6, s[44:47], 0 offen
  v_mul_u32_u24 v23, 1152, v5
  v_bfe_u32 v6, v1, 4, 1
  v_lshl_add_u32 v23, v6, 5, v23
  v_lshl_add_u32 v23, v2, 4, v23
  s_mul_i32 s23, s20, 9216
  s_mul_i32 s22, s38, 73728
  s_add_u32 s23, s23, s22
  s_add_u32 s23, s23, 15028224
  s_xor_b32 s21, s20, 0
  s_lshr_b32 s22, s21, 1
  s_mul_i32 s22, s22, 36864
  s_and_b32 s21, s21, 1
  s_lshl_b32 s21, s21, 8
  s_add_u32 s35, s21, s22
  s_add_u32 s35, s35, s23
  s_xor_b32 s21, s20, 1
  s_lshr_b32 s22, s21, 1
  s_mul_i32 s22, s22, 36864
  s_and_b32 s21, s21, 1
  s_lshl_b32 s21, s21, 8
  s_add_u32 s36, s21, s22
  s_add_u32 s36, s36, s23
  s_xor_b32 s21, s20, 2
  s_lshr_b32 s22, s21, 1
  s_mul_i32 s22, s22, 36864
  s_and_b32 s21, s21, 1
  s_lshl_b32 s21, s21, 8
  s_add_u32 s92, s21, s22
  s_add_u32 s92, s92, s23
  s_xor_b32 s21, s20, 3
  s_lshr_b32 s22, s21, 1
  s_mul_i32 s22, s22, 36864
  s_and_b32 s21, s21, 1
  s_lshl_b32 s21, s21, 8
  s_add_u32 s93, s21, s22
  s_add_u32 s93, s93, s23
  s_mul_i32 s37, s20, 165888
  s_mul_i32 s21, s39, 192
  s_add_u32 s37, s37, s21
  v_add_u32 v5, 0, v1
  v_mul_u32_u24 v6, 171, v5
  v_lshrrev_b32 v6, 11, v6
  v_mul_u32_u24 v7, 12, v6
  v_sub_u32 v7, v5, v7
  v_lshlrev_b32 v7, 4, v7
  v_mul_u32_u24 v5, 1152, v6
  v_add_u32 v26, v5, v7
  v_lshrrev_b32 v5, 1, v6
  v_mul_u32_u24 v5, 18, v5
  v_and_b32 v8, 1, v6
  v_add3_u32 v5, v5, v8, 16
  v_mul_u32_u24 v5, 1152, v5
  v_add_u32 v29, v5, v7
  v_add_u32 v5, 64, v1
  v_mul_u32_u24 v6, 171, v5
  v_lshrrev_b32 v6, 11, v6
  v_mul_u32_u24 v7, 12, v6
  v_sub_u32 v7, v5, v7
  v_lshlrev_b32 v7, 4, v7
  v_subrev_u32 v7, 1024, v7
  v_mul_u32_u24 v5, 1152, v6
  v_add_u32 v27, v5, v7
  v_lshrrev_b32 v5, 1, v6
  v_mul_u32_u24 v5, 18, v5
  v_and_b32 v8, 1, v6
  v_add3_u32 v5, v5, v8, 16
  v_mul_u32_u24 v5, 1152, v5
  v_add_u32 v30, v5, v7
  v_add_u32 v5, 128, v1
  v_mul_u32_u24 v6, 171, v5
  v_lshrrev_b32 v6, 11, v6
  v_mul_u32_u24 v7, 12, v6
  v_sub_u32 v7, v5, v7
  v_lshlrev_b32 v7, 4, v7
  v_subrev_u32 v7, 2048, v7
  v_mul_u32_u24 v5, 1152, v6
  v_add_u32 v28, v5, v7
  v_lshrrev_b32 v5, 1, v6
  v_mul_u32_u24 v5, 18, v5
  v_and_b32 v8, 1, v6
  v_add3_u32 v5, v5, v8, 16
  v_mul_u32_u24 v5, 1152, v5
  v_add_u32 v31, v5, v7
  s_lshl_b32 s21, s38, 8
  s_lshl_b32 s22, s20, 5
  s_add_u32 s21, s21, s22
  s_add_u32 s21, s21, 17394560
  v_and_b32 v24, 7, v1
  v_lshl_add_u32 v24, v24, 2, s21
G1_4:
  s_mov_b32 s4, s72
  s_and_b32 s5, s73, 0xffff
  s_mov_b32 s6, 18874368
  s_mov_b32 s7, 0x20000
  s_mov_b32 s8, s74
  s_and_b32 s9, s75, 0xffff
  s_mov_b32 s10, 9216
  s_mov_b32 s11, 0x20000
  s_lshr_b32 s30, s2, 3
  s_mul_i32 s31, s30, 43
  s_lshr_b32 s31, s31, 8
  s_mul_i32 s32, s31, 6
  s_sub_u32 s25, s30, s32
  s_and_b32 s24, s2, 7
  s_lshl_b32 s24, s24, 2
  s_add_u32 s24, s24, s31
  s_bfe_u32 s30, s2, 0x20001
  s_add_u32 s30, s30, 32
  s_and_b32 s31, s2, 1
  s_mul_i32 s31, s31, 3
  s_add_u32 s31, s31, s25
  s_cmp_ge_u32 s2, 192
  s_cselect_b32 s24, s30, s24
  s_cselect_b32 s25, s31, s25
  s_lshl_b32 s28, s20, 12
  s_lshl_b32 s30, s20, 11
  s_cmp_eq_u32 s20, 3
  s_cselect_b32 s28, 11264, s28
  s_cselect_b32 s30, 5120, s30
  s_mul_i32 s26, s25, 393216
  s_add_u32 s26, s26, s30
  s_add_u32 s26, s26, 2048
  s_mul_i32 s27, s20, 73728
  s_lshl_b32 s30, s24, 8
  s_add_u32 s27, s27, s30
  v_lshrrev_b32 v5, 4, v1
  v_lshlrev_b32 v6, 2, v5
  v_and_b32 v7, 15, v1
  v_xor_b32 v6, v6, v7
  v_mul_u32_u24 v5, 9216, v5
  v_lshl_add_u32 v34, v6, 4, v5
  v_add_u32 v35, 35840, v34
  v_bfe_u32 v5, v1, 2, 2
  v_lshlrev_b32 v6, 8, v5
  v_bfe_u32 v7, v1, 4, 1
  v_lshl_add_u32 v6, v7, 5, v6
  v_and_b32 v7, 3, v1
  v_lshl_add_u32 v6, v7, 3, v6
  v_xor_b32 v5, s20, v5
  v_lshl_add_u32 v6, v5, 6, v6
  v_lshl_add_u32 v36, v2, 12, v6
  v_mul_u32_u24 v5, 3072, v2
  v_add_u32 v5, 8192, v5
  v_add_u32 v37, v5, v6
  v_add_u32 v39, 8192, v4
  s_lshl_b32 s30, s24, 8
  s_lshl_b32 s31, s20, 6
  s_add_u32 s30, s30, s31
  v_lshlrev_b32 v5, 3, v2
  buffer_load_dwordx2 v[40:41], v5, s[8:11], s30 offen offset:0
  buffer_load_dwordx2 v[42:43], v5, s[8:11], s30 offen offset:16
  buffer_load_dwordx2 v[44:45], v5, s[8:11], s30 offen offset:32
  buffer_load_dwordx2 v[46:47], v5, s[8:11], s30 offen offset:48
  s_cmp_lg_u32 s20, 0
  s_cbranch_scc1 PF0_11
  v_and_b32 v5, 1, v1
  v_lshlrev_b32 v5, 2, v5
  s_mov_b32 s31, 0x20000
POLL_12:
  buffer_load_dword v6, v5, s[12:15], 0 offen offset:128 sc1
  s_waitcnt vmcnt(0)
  v_cmp_ne_u32 vcc, 1, v6
  s_nop 4
  s_cbranch_vccz POLLD_13
  s_sleep 2
  s_sub_u32 s31, s31, 1
  s_cmp_lg_u32 s31, 0
  s_cbranch_scc1 POLL_12
POLLD_13:
PF0_11:
  s_barrier
  s_cmp_lt_u32 s20, 2
  s_cselect_b64 vcc, -1, 0
  s_add_u32 m0, s28, 0
  s_nop 0
  buffer_load_dwordx4 v34, s[4:7], s27 offen lds
  buffer_load_dwordx4 v35, s[4:7], s27 offen offset:1024 lds
  s_add_u32 s27, s27, 294912
  buffer_load_dwordx4 v4, s[16:19], s26 offen offset:2048 sc1 lds
  s_cbranch_vccz G1S_14
  buffer_load_dwordx4 v4, s[16:19], s26 offen offset:3072 sc1 lds
G1S_14:
  s_add_u32 s26, s26, 6144
  s_add_u32 m0, s28, 14336
  s_nop 0
  buffer_load_dwordx4 v34, s[4:7], s27 offen lds
  buffer_load_dwordx4 v35, s[4:7], s27 offen offset:1024 lds
  s_add_u32 s27, s27, 294912
  buffer_load_dwordx4 v4, s[16:19], s26 offen offset:2048 sc1 lds
  s_cbranch_vccz G1S_15
  buffer_load_dwordx4 v4, s[16:19], s26 offen offset:3072 sc1 lds
G1S_15:
  s_add_u32 s26, s26, 6144
  s_add_u32 m0, s28, 28672
  s_nop 0
  buffer_load_dwordx4 v34, s[4:7], s27 offen lds
  buffer_load_dwordx4 v35, s[4:7], s27 offen offset:1024 lds
  s_add_u32 s27, s27, 294912
  buffer_load_dwordx4 v4, s[16:19], s26 offen offset:2048 sc1 lds
  s_cbranch_vccz G1S_16
  buffer_load_dwordx4 v4, s[16:19], s26 offen offset:3072 sc1 lds
G1S_16:
  s_add_u32 s26, s26, 6144
  s_add_u32 m0, s28, 43008
  s_nop 0
  buffer_load_dwordx4 v34, s[4:7], s27 offen lds
  buffer_load_dwordx4 v35, s[4:7], s27 offen offset:1024 lds
  s_add_u32 s27, s27, 294912
  buffer_load_dwordx4 v4, s[16:19], s26 offen offset:2048 sc1 lds
  s_cbranch_vccz G1S_17
  buffer_load_dwordx4 v4, s[16:19], s26 offen offset:3072 sc1 lds
G1S_17:
  s_add_u32 s26, s26, 6144
  s_add_u32 m0, s28, 57344
  s_nop 0
  buffer_load_dwordx4 v34, s[4:7], s27 offen lds
  buffer_load_dwordx4 v35, s[4:7], s27 offen offset:1024 lds
  s_add_u32 s27, s27, 294912
  buffer_load_dwordx4 v4, s[16:19], s26 offen offset:2048 sc1 lds
  s_cbranch_vccz G1S_18
  buffer_load_dwordx4 v4, s[16:19], s26 offen offset:3072 sc1 lds
G1S_18:
  s_add_u32 s26, s26, 6144
  s_waitcnt vmcnt(12)
  s_barrier
  ds_read_b64_tr_b16 v[112:113], v36 offset:0
  ds_read_b64_tr_b16 v[114:115], v36 offset:1024
  ds_read_b128 v[116:119], v4 offset:2048
  ds_read_b128 v[120:123], v4 offset:3072
  ds_read_b128 v[124:127], v4 offset:6144
  ds_read_b64_tr_b16 v[128:129], v37 offset:0
  ds_read_b64_tr_b16 v[130:131], v37 offset:1024
  ds_read_b128 v[132:135], v4 offset:7168
  ds_read_b128 v[136:139], v39 offset:2048
  ds_read_b128 v[140:143], v39 offset:5120
  v_lshlrev_b32 v96, 16, v40
  v_and_b32 v97, 0xffff0000, v40
  v_lshlrev_b32 v98, 16, v41
  v_and_b32 v99, 0xffff0000, v41
  v_lshlrev_b32 v100, 16, v42
  v_and_b32 v101, 0xffff0000, v42
  v_lshlrev_b32 v102, 16, v43
  v_and_b32 v103, 0xffff0000, v43
  v_lshlrev_b32 v104, 16, v44
  v_and_b32 v105, 0xffff0000, v44
  v_lshlrev_b32 v106, 16, v45
  v_and_b32 v107, 0xffff0000, v45
  v_lshlrev_b32 v108, 16, v46
  v_and_b32 v109, 0xffff0000, v46
  v_lshlrev_b32 v110, 16, v47
  v_and_b32 v111, 0xffff0000, v47
  s_setprio 2
  s_waitcnt vmcnt(12) lgkmcnt(0)
  v_mfma_f32_32x32x16_bf16 v[48:63], v[112:115], v[116:119], v[96:111]
  s_cbranch_vccnz G1W_19
  s_waitcnt vmcnt(9)
G1W_19:
  s_barrier
  s_add_u32 m0, s28, 0
  ds_read_b64_tr_b16 v[144:145], v36 offset:14336
  buffer_load_dwordx4 v34, s[4:7], s27 offen lds
  ds_read_b64_tr_b16 v[146:147], v36 offset:15360
  ds_read_b128 v[148:151], v4 offset:16384
  v_mfma_f32_32x32x16_bf16 v[64:79], v[112:115], v[120:123], v[96:111]
  ds_read_b128 v[152:155], v4 offset:17408
  ds_read_b128 v[156:159], v4 offset:20480
  ds_read_b64_tr_b16 v[160:161], v37 offset:14336
  buffer_load_dwordx4 v35, s[4:7], s27 offen offset:1024 lds
  s_add_u32 s27, s27, 294912
  v_mfma_f32_32x32x16_bf16 v[80:95], v[112:115], v[124:127], v[96:111]
  ds_read_b64_tr_b16 v[162:163], v37 offset:15360
  ds_read_b128 v[164:167], v4 offset:21504
  ds_read_b128 v[168:171], v39 offset:16384
  ds_read_b128 v[172:175], v39 offset:19456
  v_mfma_f32_32x32x16_bf16 v[48:63], v[128:131], v[132:135], v[48:63]
  buffer_load_dwordx4 v4, s[16:19], s26 offen offset:2048 sc1 lds
  v_mfma_f32_32x32x16_bf16 v[64:79], v[128:131], v[136:139], v[64:79]
  v_mfma_f32_32x32x16_bf16 v[80:95], v[128:131], v[140:143], v[80:95]
  s_cbranch_vccz G1S_20
  buffer_load_dwordx4 v4, s[16:19], s26 offen offset:3072 sc1 lds
G1S_20:
  s_add_u32 s26, s26, 6144
  s_waitcnt vmcnt(12) lgkmcnt(0)
  v_mfma_f32_32x32x16_bf16 v[48:63], v[144:147], v[148:151], v[48:63]
  s_cbranch_vccnz G1W_21
  s_waitcnt vmcnt(9)
G1W_21:
  s_barrier
  s_add_u32 m0, s28, 14336
  ds_read_b64_tr_b16 v[112:113], v36 offset:28672
  buffer_load_dwordx4 v34, s[4:7], s27 offen lds
  ds_read_b64_tr_b16 v[114:115], v36 offset:29696
  ds_read_b128 v[116:119], v4 offset:30720
  v_mfma_f32_32x32x16_bf16 v[64:79], v[144:147], v[152:155], v[64:79]
  ds_read_b128 v[120:123], v4 offset:31744
  ds_read_b128 v[124:127], v4 offset:34816
  ds_read_b64_tr_b16 v[128:129], v37 offset:28672
  buffer_load_dwordx4 v35, s[4:7], s27 offen offset:1024 lds
  s_add_u32 s27, s27, 294912
  v_mfma_f32_32x32x16_bf16 v[80:95], v[144:147], v[156:159], v[80:95]
  ds_read_b64_tr_b16 v[130:131], v37 offset:29696
  ds_read_b128 v[132:135], v4 offset:35840
  ds_read_b128 v[136:139], v39 offset:30720
  ds_read_b128 v[140:143], v39 offset:33792
  v_mfma_f32_32x32x16_bf16 v[48:63], v[160:163], v[164:167], v[48:63]
  buffer_load_dwordx4 v4, s[16:19], s26 offen offset:2048 sc1 lds
  v_mfma_f32_32x32x16_bf16 v[64:79], v[160:163], v[168:171], v[64:79]
  v_mfma_f32_32x32x16_bf16 v[80:95], v[160:163], v[172:175], v[80:95]
  s_cbranch_vccz G1S_22
  buffer_load_dwordx4 v4, s[16:19], s26 offen offset:3072 sc1 lds
G1S_22:
  s_add_u32 s26, s26, 6144
  s_waitcnt vmcnt(12) lgkmcnt(0)
  v_mfma_f32_32x32x16_bf16 v[48:63], v[112:115], v[116:119], v[48:63]
  s_cbranch_vccnz G1W_23
  s_waitcnt vmcnt(9)
G1W_23:
  s_barrier
  s_add_u32 m0, s28, 28672
  ds_read_b64_tr_b16 v[144:145], v36 offset:43008
  buffer_load_dwordx4 v34, s[4:7], s27 offen lds
  ds_read_b64_tr_b16 v[146:147], v36 offset:44032
  ds_read_b128 v[148:151], v4 offset:45056
  v_mfma_f32_32x32x16_bf16 v[64:79], v[112:115], v[120:123], v[64:79]
  ds_read_b128 v[152:155], v4 offset:46080
  ds_read_b128 v[156:159], v4 offset:49152
  ds_read_b64_tr_b16 v[160:161], v37 offset:43008
  buffer_load_dwordx4 v35, s[4:7], s27 offen offset:1024 lds
  s_add_u32 s27, s27, 294912
  v_mfma_f32_32x32x16_bf16 v[80:95], v[112:115], v[124:127], v[80:95]
  ds_read_b64_tr_b16 v[162:163], v37 offset:44032
  ds_read_b128 v[164:167], v4 offset:50176
  ds_read_b128 v[168:171], v39 offset:45056
  ds_read_b128 v[172:175], v39 offset:48128
  v_mfma_f32_32x32x16_bf16 v[48:63], v[128:131], v[132:135], v[48:63]
  buffer_load_dwordx4 v4, s[16:19], s26 offen offset:2048 sc1 lds
  v_mfma_f32_32x32x16_bf16 v[64:79], v[128:131], v[136:139], v[64:79]
  v_mfma_f32_32x32x16_bf16 v[80:95], v[128:131], v[140:143], v[80:95]
  s_cbranch_vccz G1S_24
  buffer_load_dwordx4 v4, s[16:19], s26 offen offset:3072 sc1 lds
G1S_24:
  s_add_u32 s26, s26, 6144
  s_waitcnt vmcnt(12) lgkmcnt(0)
  v_mfma_f32_32x32x16_bf16 v[48:63], v[144:147], v[148:151], v[48:63]
  s_cbranch_vccnz G1W_25
  s_waitcnt vmcnt(9)
G1W_25:
  s_barrier
  s_add_u32 m0, s28, 43008
  ds_read_b64_tr_b16 v[112:113], v36 offset:57344
  buffer_load_dwordx4 v34, s[4:7], s27 offen lds
  ds_read_b64_tr_b16 v[114:115], v36 offset:58368
  ds_read_b128 v[116:119], v4 offset:59392
  v_mfma_f32_32x32x16_bf16 v[64:79], v[144:147], v[152:155], v[64:79]
  ds_read_b128 v[120:123], v4 offset:60416
  ds_read_b128 v[124:127], v4 offset:63488
  ds_read_b64_tr_b16 v[128:129], v37 offset:57344
  buffer_load_dwordx4 v35, s[4:7], s27 offen offset:1024 lds
  s_add_u32 s27, s27, 294912
  v_mfma_f32_32x32x16_bf16 v[80:95], v[144:147], v[156:159], v[80:95]
  ds_read_b64_tr_b16 v[130:131], v37 offset:58368
  ds_read_b128 v[132:135], v4 offset:64512
  ds_read_b128 v[136:139], v39 offset:59392
  ds_read_b128 v[140:143], v39 offset:62464
  v_mfma_f32_32x32x16_bf16 v[48:63], v[160:163], v[164:167], v[48:63]
  buffer_load_dwordx4 v4, s[16:19], s26 offen offset:2048 sc1 lds
  v_mfma_f32_32x32x16_bf16 v[64:79], v[160:163], v[168:171], v[64:79]
  v_mfma_f32_32x32x16_bf16 v[80:95], v[160:163], v[172:175], v[80:95]
  s_cbranch_vccz G1S_26
  buffer_load_dwordx4 v4, s[16:19], s26 offen offset:3072 sc1 lds
G1S_26:
  s_add_u32 s26, s26, 6144
  s_mov_b32 s29, 5
.p2align 4
G1L_27:
  s_waitcnt vmcnt(12) lgkmcnt(0)
  v_mfma_f32_32x32x16_bf16 v[48:63], v[112:115], v[116:119], v[48:63]
  s_cbranch_vccnz G1W_28
  s_waitcnt vmcnt(9)
G1W_28:
  s_barrier
  s_add_u32 m0, s28, 57344
  ds_read_b64_tr_b16 v[144:145], v36 offset:0
  buffer_load_dwordx4 v34, s[4:7], s27 offen lds
  ds_read_b64_tr_b16 v[146:147], v36 offset:1024
  ds_read_b128 v[148:151], v4 offset:2048
  v_mfma_f32_32x32x16_bf16 v[64:79], v[112:115], v[120:123], v[64:79]
  ds_read_b128 v[152:155], v4 offset:3072
  ds_read_b128 v[156:159], v4 offset:6144
  ds_read_b64_tr_b16 v[160:161], v37 offset:0
  buffer_load_dwordx4 v35, s[4:7], s27 offen offset:1024 lds
  s_add_u32 s27, s27, 294912
  v_mfma_f32_32x32x16_bf16 v[80:95], v[112:115], v[124:127], v[80:95]
  ds_read_b64_tr_b16 v[162:163], v37 offset:1024
  ds_read_b128 v[164:167], v4 offset:7168
  ds_read_b128 v[168:171], v39 offset:2048
  ds_read_b128 v[172:175], v39 offset:5120
  v_mfma_f32_32x32x16_bf16 v[48:63], v[128:131], v[132:135], v[48:63]
  buffer_load_dwordx4 v4, s[16:19], s26 offen offset:2048 sc1 lds
  v_mfma_f32_32x32x16_bf16 v[64:79], v[128:131], v[136:139], v[64:79]
  v_mfma_f32_32x32x16_bf16 v[80:95], v[128:131], v[140:143], v[80:95]
  s_cbranch_vccz G1S_29
  buffer_load_dwordx4 v4, s[16:19], s26 offen offset:3072 sc1 lds
G1S_29:
  s_add_u32 s26, s26, 6144
  s_waitcnt vmcnt(12) lgkmcnt(0)
  v_mfma_f32_32x32x16_bf16 v[48:63], v[144:147], v[148:151], v[48:63]
  s_cbranch_vccnz G1W_30
  s_waitcnt vmcnt(9)
G1W_30:
  s_barrier
  s_add_u32 m0, s28, 0
  ds_read_b64_tr_b16 v[112:113], v36 offset:14336
  buffer_load_dwordx4 v34, s[4:7], s27 offen lds
  ds_read_b64_tr_b16 v[114:115], v36 offset:15360
  ds_read_b128 v[116:119], v4 offset:16384
  v_mfma_f32_32x32x16_bf16 v[64:79], v[144:147], v[152:155], v[64:79]
  ds_read_b128 v[120:123], v4 offset:17408
  ds_read_b128 v[124:127], v4 offset:20480
  ds_read_b64_tr_b16 v[128:129], v37 offset:14336
  buffer_load_dwordx4 v35, s[4:7], s27 offen offset:1024 lds
  s_add_u32 s27, s27, 294912
  v_mfma_f32_32x32x16_bf16 v[80:95], v[144:147], v[156:159], v[80:95]
  ds_read_b64_tr_b16 v[130:131], v37 offset:15360
  ds_read_b128 v[132:135], v4 offset:21504
  ds_read_b128 v[136:139], v39 offset:16384
  ds_read_b128 v[140:143], v39 offset:19456
  v_mfma_f32_32x32x16_bf16 v[48:63], v[160:163], v[164:167], v[48:63]
  buffer_load_dwordx4 v4, s[16:19], s26 offen offset:2048 sc1 lds
  v_mfma_f32_32x32x16_bf16 v[64:79], v[160:163], v[168:171], v[64:79]
  v_mfma_f32_32x32x16_bf16 v[80:95], v[160:163], v[172:175], v[80:95]
  s_cbranch_vccz G1S_31
  buffer_load_dwordx4 v4, s[16:19], s26 offen offset:3072 sc1 lds
G1S_31:
  s_add_u32 s26, s26, 6144
  s_waitcnt vmcnt(12) lgkmcnt(0)
  v_mfma_f32_32x32x16_bf16 v[48:63], v[112:115], v[116:119], v[48:63]
  s_cbranch_vccnz G1W_32
  s_waitcnt vmcnt(9)
G1W_32:
  s_barrier
  s_add_u32 m0, s28, 14336
  ds_read_b64_tr_b16 v[144:145], v36 offset:28672
  buffer_load_dwordx4 v34, s[4:7], s27 offen lds
  ds_read_b64_tr_b16 v[146:147], v36 offset:29696
  ds_read_b128 v[148:151], v4 offset:30720
  v_mfma_f32_32x32x16_bf16 v[64:79], v[112:115], v[120:123], v[64:79]
  ds_read_b128 v[152:155], v4 offset:31744
  ds_read_b128 v[156:159], v4 offset:34816
  ds_read_b64_tr_b16 v[160:161], v37 offset:28672
  buffer_load_dwordx4 v35, s[4:7], s27 offen offset:1024 lds
  s_add_u32 s27, s27, 294912
  v_mfma_f32_32x32x16_bf16 v[80:95], v[112:115], v[124:127], v[80:95]
  ds_read_b64_tr_b16 v[162:163], v37 offset:29696
  ds_read_b128 v[164:167], v4 offset:35840
  ds_read_b128 v[168:171], v39 offset:30720
  ds_read_b128 v[172:175], v39 offset:33792
  v_mfma_f32_32x32x16_bf16 v[48:63], v[128:131], v[132:135], v[48:63]
  buffer_load_dwordx4 v4, s[16:19], s26 offen offset:2048 sc1 lds
  v_mfma_f32_32x32x16_bf16 v[64:79], v[128:131], v[136:139], v[64:79]
  v_mfma_f32_32x32x16_bf16 v[80:95], v[128:131], v[140:143], v[80:95]
  s_cbranch_vccz G1S_33
  buffer_load_dwordx4 v4, s[16:19], s26 offen offset:3072 sc1 lds
G1S_33:
  s_add_u32 s26, s26, 6144
  s_waitcnt vmcnt(12) lgkmcnt(0)
  v_mfma_f32_32x32x16_bf16 v[48:63], v[144:147], v[148:151], v[48:63]
  s_cbranch_vccnz G1W_34
  s_waitcnt vmcnt(9)
G1W_34:
  s_barrier
  s_add_u32 m0, s28, 28672
  ds_read_b64_tr_b16 v[112:113], v36 offset:43008
  buffer_load_dwordx4 v34, s[4:7], s27 offen lds
  ds_read_b64_tr_b16 v[114:115], v36 offset:44032
  ds_read_b128 v[116:119], v4 offset:45056
  v_mfma_f32_32x32x16_bf16 v[64:79], v[144:147], v[152:155], v[64:79]
  ds_read_b128 v[120:123], v4 offset:46080
  ds_read_b128 v[124:127], v4 offset:49152
  ds_read_b64_tr_b16 v[128:129], v37 offset:43008
  buffer_load_dwordx4 v35, s[4:7], s27 offen offset:1024 lds
  s_add_u32 s27, s27, 294912
  v_mfma_f32_32x32x16_bf16 v[80:95], v[144:147], v[156:159], v[80:95]
  ds_read_b64_tr_b16 v[130:131], v37 offset:44032
  ds_read_b128 v[132:135], v4 offset:50176
  ds_read_b128 v[136:139], v39 offset:45056
  ds_read_b128 v[140:143], v39 offset:48128
  v_mfma_f32_32x32x16_bf16 v[48:63], v[160:163], v[164:167], v[48:63]
  buffer_load_dwordx4 v4, s[16:19], s26 offen offset:2048 sc1 lds
  v_mfma_f32_32x32x16_bf16 v[64:79], v[160:163], v[168:171], v[64:79]
  v_mfma_f32_32x32x16_bf16 v[80:95], v[160:163], v[172:175], v[80:95]
  s_cbranch_vccz G1S_35
  buffer_load_dwordx4 v4, s[16:19], s26 offen offset:3072 sc1 lds
G1S_35:
  s_add_u32 s26, s26, 6144
  s_waitcnt vmcnt(12) lgkmcnt(0)
  v_mfma_f32_32x32x16_bf16 v[48:63], v[112:115], v[116:119], v[48:63]
  s_cbranch_vccnz G1W_36
  s_waitcnt vmcnt(9)
G1W_36:
  s_barrier
  s_add_u32 m0, s28, 43008
  ds_read_b64_tr_b16 v[144:145], v36 offset:57344
  buffer_load_dwordx4 v34, s[4:7], s27 offen lds
  ds_read_b64_tr_b16 v[146:147], v36 offset:58368
  ds_read_b128 v[148:151], v4 offset:59392
  v_mfma_f32_32x32x16_bf16 v[64:79], v[112:115], v[120:123], v[64:79]
  ds_read_b128 v[152:155], v4 offset:60416
  ds_read_b128 v[156:159], v4 offset:63488
  ds_read_b64_tr_b16 v[160:161], v37 offset:57344
  buffer_load_dwordx4 v35, s[4:7], s27 offen offset:1024 lds
  s_add_u32 s27, s27, 294912
  v_mfma_f32_32x32x16_bf16 v[80:95], v[112:115], v[124:127], v[80:95]
  ds_read_b64_tr_b16 v[162:163], v37 offset:58368
  ds_read_b128 v[164:167], v4 offset:64512
  ds_read_b128 v[168:171], v39 offset:59392
  ds_read_b128 v[172:175], v39 offset:62464
  v_mfma_f32_32x32x16_bf16 v[48:63], v[128:131], v[132:135], v[48:63]
  buffer_load_dwordx4 v4, s[16:19], s26 offen offset:2048 sc1 lds
  v_mfma_f32_32x32x16_bf16 v[64:79], v[128:131], v[136:139], v[64:79]
  v_mfma_f32_32x32x16_bf16 v[80:95], v[128:131], v[140:143], v[80:95]
  s_cbranch_vccz G1S_37
  buffer_load_dwordx4 v4, s[16:19], s26 offen offset:3072 sc1 lds
G1S_37:
  s_add_u32 s26, s26, 6144
  s_waitcnt vmcnt(12) lgkmcnt(0)
  v_mfma_f32_32x32x16_bf16 v[48:63], v[144:147], v[148:151], v[48:63]
  s_cbranch_vccnz G1W_38
  s_waitcnt vmcnt(9)
G1W_38:
  s_barrier
  s_add_u32 m0, s28, 57344
  ds_read_b64_tr_b16 v[112:113], v36 offset:0
  buffer_load_dwordx4 v34, s[4:7], s27 offen lds
  ds_read_b64_tr_b16 v[114:115], v36 offset:1024
  ds_read_b128 v[116:119], v4 offset:2048
  v_mfma_f32_32x32x16_bf16 v[64:79], v[144:147], v[152:155], v[64:79]
  ds_read_b128 v[120:123], v4 offset:3072
  ds_read_b128 v[124:127], v4 offset:6144
  ds_read_b64_tr_b16 v[128:129], v37 offset:0
  buffer_load_dwordx4 v35, s[4:7], s27 offen offset:1024 lds
  s_add_u32 s27, s27, 294912
  v_mfma_f32_32x32x16_bf16 v[80:95], v[144:147], v[156:159], v[80:95]
  ds_read_b64_tr_b16 v[130:131], v37 offset:1024
  ds_read_b128 v[132:135], v4 offset:7168
  ds_read_b128 v[136:139], v39 offset:2048
  ds_read_b128 v[140:143], v39 offset:5120
  v_mfma_f32_32x32x16_bf16 v[48:63], v[160:163], v[164:167], v[48:63]
  buffer_load_dwordx4 v4, s[16:19], s26 offen offset:2048 sc1 lds
  v_mfma_f32_32x32x16_bf16 v[64:79], v[160:163], v[168:171], v[64:79]
  v_mfma_f32_32x32x16_bf16 v[80:95], v[160:163], v[172:175], v[80:95]
  s_cbranch_vccz G1S_39
  buffer_load_dwordx4 v4, s[16:19], s26 offen offset:3072 sc1 lds
G1S_39:
  s_add_u32 s26, s26, 6144
  s_waitcnt vmcnt(12) lgkmcnt(0)
  v_mfma_f32_32x32x16_bf16 v[48:63], v[112:115], v[116:119], v[48:63]
  s_cbranch_vccnz G1W_40
  s_waitcnt vmcnt(9)
G1W_40:
  s_barrier
  s_add_u32 m0, s28, 0
  ds_read_b64_tr_b16 v[144:145], v36 offset:14336
  buffer_load_dwordx4 v34, s[4:7], s27 offen lds
  ds_read_b64_tr_b16 v[146:147], v36 offset:15360
  ds_read_b128 v[148:151], v4 offset:16384
  v_mfma_f32_32x32x16_bf16 v[64:79], v[112:115], v[120:123], v[64:79]
  ds_read_b128 v[152:155], v4 offset:17408
  ds_read_b128 v[156:159], v4 offset:20480
  ds_read_b64_tr_b16 v[160:161], v37 offset:14336
  buffer_load_dwordx4 v35, s[4:7], s27 offen offset:1024 lds
  s_add_u32 s27, s27, 294912
  v_mfma_f32_32x32x16_bf16 v[80:95], v[112:115], v[124:127], v[80:95]
  ds_read_b64_tr_b16 v[162:163], v37 offset:15360
  ds_read_b128 v[164:167], v4 offset:21504
  ds_read_b128 v[168:171], v39 offset:16384
  ds_read_b128 v[172:175], v39 offset:19456
  v_mfma_f32_32x32x16_bf16 v[48:63], v[128:131], v[132:135], v[48:63]
  buffer_load_dwordx4 v4, s[16:19], s26 offen offset:2048 sc1 lds
  v_mfma_f32_32x32x16_bf16 v[64:79], v[128:131], v[136:139], v[64:79]
  v_mfma_f32_32x32x16_bf16 v[80:95], v[128:131], v[140:143], v[80:95]
  s_cbranch_vccz G1S_41
  buffer_load_dwordx4 v4, s[16:19], s26 offen offset:3072 sc1 lds
G1S_41:
  s_add_u32 s26, s26, 6144
  s_waitcnt vmcnt(12) lgkmcnt(0)
  v_mfma_f32_32x32x16_bf16 v[48:63], v[144:147], v[148:151], v[48:63]
  s_cbranch_vccnz G1W_42
  s_waitcnt vmcnt(9)
G1W_42:
  s_barrier
  s_add_u32 m0, s28, 14336
  ds_read_b64_tr_b16 v[112:113], v36 offset:28672
  buffer_load_dwordx4 v34, s[4:7], s27 offen lds
  ds_read_b64_tr_b16 v[114:115], v36 offset:29696
  ds_read_b128 v[116:119], v4 offset:30720
  v_mfma_f32_32x32x16_bf16 v[64:79], v[144:147], v[152:155], v[64:79]
  ds_read_b128 v[120:123], v4 offset:31744
  ds_read_b128 v[124:127], v4 offset:34816
  ds_read_b64_tr_b16 v[128:129], v37 offset:28672
  buffer_load_dwordx4 v35, s[4:7], s27 offen offset:1024 lds
  s_add_u32 s27, s27, 294912
  v_mfma_f32_32x32x16_bf16 v[80:95], v[144:147], v[156:159], v[80:95]
  ds_read_b64_tr_b16 v[130:131], v37 offset:29696
  ds_read_b128 v[132:135], v4 offset:35840
  ds_read_b128 v[136:139], v39 offset:30720
  ds_read_b128 v[140:143], v39 offset:33792
  v_mfma_f32_32x32x16_bf16 v[48:63], v[160:163], v[164:167], v[48:63]
  buffer_load_dwordx4 v4, s[16:19], s26 offen offset:2048 sc1 lds
  v_mfma_f32_32x32x16_bf16 v[64:79], v[160:163], v[168:171], v[64:79]
  v_mfma_f32_32x32x16_bf16 v[80:95], v[160:163], v[172:175], v[80:95]
  s_cbranch_vccz G1S_43
  buffer_load_dwordx4 v4, s[16:19], s26 offen offset:3072 sc1 lds
G1S_43:
  s_add_u32 s26, s26, 6144
  s_waitcnt vmcnt(12) lgkmcnt(0)
  v_mfma_f32_32x32x16_bf16 v[48:63], v[112:115], v[116:119], v[48:63]
  s_cbranch_vccnz G1W_44
  s_waitcnt vmcnt(9)
G1W_44:
  s_barrier
  s_add_u32 m0, s28, 28672
  ds_read_b64_tr_b16 v[144:145], v36 offset:43008
  buffer_load_dwordx4 v34, s[4:7], s27 offen lds
  ds_read_b64_tr_b16 v[146:147], v36 offset:44032
  ds_read_b128 v[148:151], v4 offset:45056
  v_mfma_f32_32x32x16_bf16 v[64:79], v[112:115], v[120:123], v[64:79]
  ds_read_b128 v[152:155], v4 offset:46080
  ds_read_b128 v[156:159], v4 offset:49152
  ds_read_b64_tr_b16 v[160:161], v37 offset:43008
  buffer_load_dwordx4 v35, s[4:7], s27 offen offset:1024 lds
  s_add_u32 s27, s27, 294912
  v_mfma_f32_32x32x16_bf16 v[80:95], v[112:115], v[124:127], v[80:95]
  ds_read_b64_tr_b16 v[162:163], v37 offset:44032
  ds_read_b128 v[164:167], v4 offset:50176
  ds_read_b128 v[168:171], v39 offset:45056
  ds_read_b128 v[172:175], v39 offset:48128
  v_mfma_f32_32x32x16_bf16 v[48:63], v[128:131], v[132:135], v[48:63]
  buffer_load_dwordx4 v4, s[16:19], s26 offen offset:2048 sc1 lds
  v_mfma_f32_32x32x16_bf16 v[64:79], v[128:131], v[136:139], v[64:79]
  v_mfma_f32_32x32x16_bf16 v[80:95], v[128:131], v[140:143], v[80:95]
  s_cbranch_vccz G1S_45
  buffer_load_dwordx4 v4, s[16:19], s26 offen offset:3072 sc1 lds
G1S_45:
  s_add_u32 s26, s26, 6144
  s_waitcnt vmcnt(12) lgkmcnt(0)
  v_mfma_f32_32x32x16_bf16 v[48:63], v[144:147], v[148:151], v[48:63]
  s_cbranch_vccnz G1W_46
  s_waitcnt vmcnt(9)
G1W_46:
  s_barrier
  s_add_u32 m0, s28, 43008
  ds_read_b64_tr_b16 v[112:113], v36 offset:57344
  buffer_load_dwordx4 v34, s[4:7], s27 offen lds
  ds_read_b64_tr_b16 v[114:115], v36 offset:58368
  ds_read_b128 v[116:119], v4 offset:59392
  v_mfma_f32_32x32x16_bf16 v[64:79], v[144:147], v[152:155], v[64:79]
  ds_read_b128 v[120:123], v4 offset:60416
  ds_read_b128 v[124:127], v4 offset:63488
  ds_read_b64_tr_b16 v[128:129], v37 offset:57344
  buffer_load_dwordx4 v35, s[4:7], s27 offen offset:1024 lds
  s_add_u32 s27, s27, 294912
  v_mfma_f32_32x32x16_bf16 v[80:95], v[144:147], v[156:159], v[80:95]
  ds_read_b64_tr_b16 v[130:131], v37 offset:58368
  ds_read_b128 v[132:135], v4 offset:64512
  ds_read_b128 v[136:139], v39 offset:59392
  ds_read_b128 v[140:143], v39 offset:62464
  v_mfma_f32_32x32x16_bf16 v[48:63], v[160:163], v[164:167], v[48:63]
  buffer_load_dwordx4 v4, s[16:19], s26 offen offset:2048 sc1 lds
  v_mfma_f32_32x32x16_bf16 v[64:79], v[160:163], v[168:171], v[64:79]
  v_mfma_f32_32x32x16_bf16 v[80:95], v[160:163], v[172:175], v[80:95]
  s_cbranch_vccz G1S_47
  buffer_load_dwordx4 v4, s[16:19], s26 offen offset:3072 sc1 lds
G1S_47:
  s_add_u32 s26, s26, 6144
  s_cmp_ge_u32 s2, 192
  s_cselect_b32 s30, 1, 2
  s_cmp_lg_u32 s29, s30
  s_cbranch_scc1 G1D_48
  s_setprio 0
G1D_48:
  s_sub_u32 s29, s29, 1
  s_cmp_lg_u32 s29, 0
  s_cbranch_scc1 G1L_27
  s_waitcnt vmcnt(12) lgkmcnt(0)
  v_mfma_f32_32x32x16_bf16 v[48:63], v[112:115], v[116:119], v[48:63]
  s_cbranch_vccnz G1W_49
  s_waitcnt vmcnt(9)
G1W_49:
  s_barrier
  s_add_u32 m0, s28, 57344
  ds_read_b64_tr_b16 v[144:145], v36 offset:0
  buffer_load_dwordx4 v34, s[4:7], s27 offen lds
  ds_read_b64_tr_b16 v[146:147], v36 offset:1024
  ds_read_b128 v[148:151], v4 offset:2048
  v_mfma_f32_32x32x16_bf16 v[64:79], v[112:115], v[120:123], v[64:79]
  ds_read_b128 v[152:155], v4 offset:3072
  ds_read_b128 v[156:159], v4 offset:6144
  ds_read_b64_tr_b16 v[160:161], v37 offset:0
  buffer_load_dwordx4 v35, s[4:7], s27 offen offset:1024 lds
  s_add_u32 s27, s27, 294912
  v_mfma_f32_32x32x16_bf16 v[80:95], v[112:115], v[124:127], v[80:95]
  ds_read_b64_tr_b16 v[162:163], v37 offset:1024
  ds_read_b128 v[164:167], v4 offset:7168
  ds_read_b128 v[168:171], v39 offset:2048
  ds_read_b128 v[172:175], v39 offset:5120
  v_mfma_f32_32x32x16_bf16 v[48:63], v[128:131], v[132:135], v[48:63]
  buffer_load_dwordx4 v4, s[16:19], s26 offen offset:2048 sc1 lds
  v_mfma_f32_32x32x16_bf16 v[64:79], v[128:131], v[136:139], v[64:79]
  v_mfma_f32_32x32x16_bf16 v[80:95], v[128:131], v[140:143], v[80:95]
  s_cbranch_vccz G1S_50
  buffer_load_dwordx4 v4, s[16:19], s26 offen offset:3072 sc1 lds
G1S_50:
  s_add_u32 s26, s26, 6144
  s_waitcnt vmcnt(12) lgkmcnt(0)
  v_mfma_f32_32x32x16_bf16 v[48:63], v[144:147], v[148:151], v[48:63]
  s_cbranch_vccnz G1W_51
  s_waitcnt vmcnt(9)
G1W_51:
  s_barrier
  s_add_u32 m0, s28, 0
  ds_read_b64_tr_b16 v[112:113], v36 offset:14336
  buffer_load_dwordx4 v34, s[4:7], s27 offen lds
  ds_read_b64_tr_b16 v[114:115], v36 offset:15360
  ds_read_b128 v[116:119], v4 offset:16384
  v_mfma_f32_32x32x16_bf16 v[64:79], v[144:147], v[152:155], v[64:79]
  ds_read_b128 v[120:123], v4 offset:17408
  ds_read_b128 v[124:127], v4 offset:20480
  ds_read_b64_tr_b16 v[128:129], v37 offset:14336
  buffer_load_dwordx4 v35, s[4:7], s27 offen offset:1024 lds
  s_add_u32 s27, s27, 294912
  v_mfma_f32_32x32x16_bf16 v[80:95], v[144:147], v[156:159], v[80:95]
  ds_read_b64_tr_b16 v[130:131], v37 offset:15360
  ds_read_b128 v[132:135], v4 offset:21504
  ds_read_b128 v[136:139], v39 offset:16384
  ds_read_b128 v[140:143], v39 offset:19456
  v_mfma_f32_32x32x16_bf16 v[48:63], v[160:163], v[164:167], v[48:63]
  buffer_load_dwordx4 v4, s[16:19], s26 offen offset:2048 sc1 lds
  v_mfma_f32_32x32x16_bf16 v[64:79], v[160:163], v[168:171], v[64:79]
  v_mfma_f32_32x32x16_bf16 v[80:95], v[160:163], v[172:175], v[80:95]
  s_cbranch_vccz G1S_52
  buffer_load_dwordx4 v4, s[16:19], s26 offen offset:3072 sc1 lds
G1S_52:
  s_add_u32 s26, s26, 6144
  s_waitcnt vmcnt(12) lgkmcnt(0)
  v_mfma_f32_32x32x16_bf16 v[48:63], v[112:115], v[116:119], v[48:63]
  s_cbranch_vccnz G1W_53
  s_waitcnt vmcnt(9)
G1W_53:
  s_barrier
  s_add_u32 m0, s28, 14336
  ds_read_b64_tr_b16 v[144:145], v36 offset:28672
  buffer_load_dwordx4 v34, s[4:7], s27 offen lds
  ds_read_b64_tr_b16 v[146:147], v36 offset:29696
  ds_read_b128 v[148:151], v4 offset:30720
  v_mfma_f32_32x32x16_bf16 v[64:79], v[112:115], v[120:123], v[64:79]
  ds_read_b128 v[152:155], v4 offset:31744
  ds_read_b128 v[156:159], v4 offset:34816
  ds_read_b64_tr_b16 v[160:161], v37 offset:28672
  buffer_load_dwordx4 v35, s[4:7], s27 offen offset:1024 lds
  s_add_u32 s27, s27, 294912
  v_mfma_f32_32x32x16_bf16 v[80:95], v[112:115], v[124:127], v[80:95]
  ds_read_b64_tr_b16 v[162:163], v37 offset:29696
  ds_read_b128 v[164:167], v4 offset:35840
  ds_read_b128 v[168:171], v39 offset:30720
  ds_read_b128 v[172:175], v39 offset:33792
  v_mfma_f32_32x32x16_bf16 v[48:63], v[128:131], v[132:135], v[48:63]
  buffer_load_dwordx4 v4, s[16:19], s26 offen offset:2048 sc1 lds
  v_mfma_f32_32x32x16_bf16 v[64:79], v[128:131], v[136:139], v[64:79]
  v_mfma_f32_32x32x16_bf16 v[80:95], v[128:131], v[140:143], v[80:95]
  s_cbranch_vccz G1S_54
  buffer_load_dwordx4 v4, s[16:19], s26 offen offset:3072 sc1 lds
G1S_54:
  s_add_u32 s26, s26, 6144
  s_waitcnt vmcnt(12) lgkmcnt(0)
  v_mfma_f32_32x32x16_bf16 v[48:63], v[144:147], v[148:151], v[48:63]
  s_cbranch_vccnz G1W_55
  s_waitcnt vmcnt(9)
G1W_55:
  s_barrier
  s_add_u32 m0, s28, 28672
  ds_read_b64_tr_b16 v[112:113], v36 offset:43008
  buffer_load_dwordx4 v34, s[4:7], s27 offen lds
  ds_read_b64_tr_b16 v[114:115], v36 offset:44032
  ds_read_b128 v[116:119], v4 offset:45056
  v_mfma_f32_32x32x16_bf16 v[64:79], v[144:147], v[152:155], v[64:79]
  ds_read_b128 v[120:123], v4 offset:46080
  ds_read_b128 v[124:127], v4 offset:49152
  ds_read_b64_tr_b16 v[128:129], v37 offset:43008
  buffer_load_dwordx4 v35, s[4:7], s27 offen offset:1024 lds
  s_add_u32 s27, s27, 294912
  v_mfma_f32_32x32x16_bf16 v[80:95], v[144:147], v[156:159], v[80:95]
  ds_read_b64_tr_b16 v[130:131], v37 offset:44032
  ds_read_b128 v[132:135], v4 offset:50176
  ds_read_b128 v[136:139], v39 offset:45056
  ds_read_b128 v[140:143], v39 offset:48128
  v_mfma_f32_32x32x16_bf16 v[48:63], v[160:163], v[164:167], v[48:63]
  buffer_load_dwordx4 v4, s[16:19], s26 offen offset:2048 sc1 lds
  v_mfma_f32_32x32x16_bf16 v[64:79], v[160:163], v[168:171], v[64:79]
  v_mfma_f32_32x32x16_bf16 v[80:95], v[160:163], v[172:175], v[80:95]
  s_cbranch_vccz G1S_56
  buffer_load_dwordx4 v4, s[16:19], s26 offen offset:3072 sc1 lds
G1S_56:
  s_add_u32 s26, s26, 6144
  s_waitcnt vmcnt(12) lgkmcnt(0)
  v_mfma_f32_32x32x16_bf16 v[48:63], v[112:115], v[116:119], v[48:63]
  s_cbranch_vccnz G1W_57
  s_waitcnt vmcnt(9)
G1W_57:
  s_barrier
  s_add_u32 m0, s28, 43008
  ds_read_b64_tr_b16 v[144:145], v36 offset:57344
  buffer_load_dwordx4 v34, s[4:7], s27 offen lds
  ds_read_b64_tr_b16 v[146:147], v36 offset:58368
  ds_read_b128 v[148:151], v4 offset:59392
  v_mfma_f32_32x32x16_bf16 v[64:79], v[112:115], v[120:123], v[64:79]
  ds_read_b128 v[152:155], v4 offset:60416
  ds_read_b128 v[156:159], v4 offset:63488
  ds_read_b64_tr_b16 v[160:161], v37 offset:57344
  buffer_load_dwordx4 v35, s[4:7], s27 offen offset:1024 lds
  s_add_u32 s27, s27, 294912
  v_mfma_f32_32x32x16_bf16 v[80:95], v[112:115], v[124:127], v[80:95]
  ds_read_b64_tr_b16 v[162:163], v37 offset:58368
  ds_read_b128 v[164:167], v4 offset:64512
  ds_read_b128 v[168:171], v39 offset:59392
  ds_read_b128 v[172:175], v39 offset:62464
  v_mfma_f32_32x32x16_bf16 v[48:63], v[128:131], v[132:135], v[48:63]
  buffer_load_dwordx4 v4, s[16:19], s26 offen offset:2048 sc1 lds
  v_mfma_f32_32x32x16_bf16 v[64:79], v[128:131], v[136:139], v[64:79]
  v_mfma_f32_32x32x16_bf16 v[80:95], v[128:131], v[140:143], v[80:95]
  s_cbranch_vccz G1S_58
  buffer_load_dwordx4 v4, s[16:19], s26 offen offset:3072 sc1 lds
G1S_58:
  s_add_u32 s26, s26, 6144
  s_waitcnt vmcnt(12) lgkmcnt(0)
  v_mfma_f32_32x32x16_bf16 v[48:63], v[144:147], v[148:151], v[48:63]
  s_cbranch_vccnz G1W_59
  s_waitcnt vmcnt(9)
G1W_59:
  s_barrier
  ds_read_b64_tr_b16 v[112:113], v36 offset:0
  ds_read_b64_tr_b16 v[114:115], v36 offset:1024
  ds_read_b128 v[116:119], v4 offset:2048
  v_mfma_f32_32x32x16_bf16 v[64:79], v[144:147], v[152:155], v[64:79]
  ds_read_b128 v[120:123], v4 offset:3072
  ds_read_b128 v[124:127], v4 offset:6144
  ds_read_b64_tr_b16 v[128:129], v37 offset:0
  v_mfma_f32_32x32x16_bf16 v[80:95], v[144:147], v[156:159], v[80:95]
  ds_read_b64_tr_b16 v[130:131], v37 offset:1024
  ds_read_b128 v[132:135], v4 offset:7168
  ds_read_b128 v[136:139], v39 offset:2048
  ds_read_b128 v[140:143], v39 offset:5120
  v_mfma_f32_32x32x16_bf16 v[48:63], v[160:163], v[164:167], v[48:63]
  v_mfma_f32_32x32x16_bf16 v[64:79], v[160:163], v[168:171], v[64:79]
  v_mfma_f32_32x32x16_bf16 v[80:95], v[160:163], v[172:175], v[80:95]
  s_waitcnt vmcnt(8) lgkmcnt(0)
  v_mfma_f32_32x32x16_bf16 v[48:63], v[112:115], v[116:119], v[48:63]
  s_cbranch_vccnz G1W_60
  s_waitcnt vmcnt(6)
G1W_60:
  s_barrier
  ds_read_b64_tr_b16 v[144:145], v36 offset:14336
  ds_read_b64_tr_b16 v[146:147], v36 offset:15360
  ds_read_b128 v[148:151], v4 offset:16384
  v_mfma_f32_32x32x16_bf16 v[64:79], v[112:115], v[120:123], v[64:79]
  ds_read_b128 v[152:155], v4 offset:17408
  ds_read_b128 v[156:159], v4 offset:20480
  ds_read_b64_tr_b16 v[160:161], v37 offset:14336
  v_mfma_f32_32x32x16_bf16 v[80:95], v[112:115], v[124:127], v[80:95]
  ds_read_b64_tr_b16 v[162:163], v37 offset:15360
  ds_read_b128 v[164:167], v4 offset:21504
  ds_read_b128 v[168:171], v39 offset:16384
  ds_read_b128 v[172:175], v39 offset:19456
  v_mfma_f32_32x32x16_bf16 v[48:63], v[128:131], v[132:135], v[48:63]
  v_mfma_f32_32x32x16_bf16 v[64:79], v[128:131], v[136:139], v[64:79]
  v_mfma_f32_32x32x16_bf16 v[80:95], v[128:131], v[140:143], v[80:95]
  s_waitcnt vmcnt(4) lgkmcnt(0)
  v_mfma_f32_32x32x16_bf16 v[48:63], v[144:147], v[148:151], v[48:63]
  s_cbranch_vccnz G1W_61
  s_waitcnt vmcnt(3)
G1W_61:
  s_barrier
  ds_read_b64_tr_b16 v[112:113], v36 offset:28672
  ds_read_b64_tr_b16 v[114:115], v36 offset:29696
  ds_read_b128 v[116:119], v4 offset:30720
  v_mfma_f32_32x32x16_bf16 v[64:79], v[144:147], v[152:155], v[64:79]
  ds_read_b128 v[120:123], v4 offset:31744
  ds_read_b128 v[124:127], v4 offset:34816
  ds_read_b64_tr_b16 v[128:129], v37 offset:28672
  v_mfma_f32_32x32x16_bf16 v[80:95], v[144:147], v[156:159], v[80:95]
  ds_read_b64_tr_b16 v[130:131], v37 offset:29696
  ds_read_b128 v[132:135], v4 offset:35840
  ds_read_b128 v[136:139], v39 offset:30720
  ds_read_b128 v[140:143], v39 offset:33792
  v_mfma_f32_32x32x16_bf16 v[48:63], v[160:163], v[164:167], v[48:63]
  v_mfma_f32_32x32x16_bf16 v[64:79], v[160:163], v[168:171], v[64:79]
  v_mfma_f32_32x32x16_bf16 v[80:95], v[160:163], v[172:175], v[80:95]
  s_waitcnt vmcnt(0) lgkmcnt(0)
  v_mfma_f32_32x32x16_bf16 v[48:63], v[112:115], v[116:119], v[48:63]
  s_barrier
  ds_read_b64_tr_b16 v[144:145], v36 offset:43008
  ds_read_b64_tr_b16 v[146:147], v36 offset:44032
  ds_read_b128 v[148:151], v4 offset:45056
  v_mfma_f32_32x32x16_bf16 v[64:79], v[112:115], v[120:123], v[64:79]
  ds_read_b128 v[152:155], v4 offset:46080
  ds_read_b128 v[156:159], v4 offset:49152
  ds_read_b64_tr_b16 v[160:161], v37 offset:43008
  v_mfma_f32_32x32x16_bf16 v[80:95], v[112:115], v[124:127], v[80:95]
  ds_read_b64_tr_b16 v[162:163], v37 offset:44032
  ds_read_b128 v[164:167], v4 offset:50176
  ds_read_b128 v[168:171], v39 offset:45056
  ds_read_b128 v[172:175], v39 offset:48128
  v_mfma_f32_32x32x16_bf16 v[48:63], v[128:131], v[132:135], v[48:63]
  v_mfma_f32_32x32x16_bf16 v[64:79], v[128:131], v[136:139], v[64:79]
  v_mfma_f32_32x32x16_bf16 v[80:95], v[128:131], v[140:143], v[80:95]
  s_waitcnt lgkmcnt(0)
  v_mfma_f32_32x32x16_bf16 v[48:63], v[144:147], v[148:151], v[48:63]
  v_mfma_f32_32x32x16_bf16 v[64:79], v[144:147], v[152:155], v[64:79]
  v_mfma_f32_32x32x16_bf16 v[80:95], v[144:147], v[156:159], v[80:95]
  v_mfma_f32_32x32x16_bf16 v[48:63], v[160:163], v[164:167], v[48:63]
  v_mfma_f32_32x32x16_bf16 v[64:79], v[160:163], v[168:171], v[64:79]
  v_mfma_f32_32x32x16_bf16 v[80:95], v[160:163], v[172:175], v[80:95]
  s_setprio 3
  s_barrier
  s_cmp_ge_u32 s2, 192
  s_cbranch_scc1 NORING_62
  s_add_u32 m0, s42, 0
  s_nop 0
  buffer_load_dwordx4 v11, s[52:55], s41 offen lds
  buffer_load_dwordx4 v12, s[52:55], s41 offen offset:1024 lds
  s_add_u32 s41, s41, 65536
  s_add_u32 m0, s42, 2048
  s_nop 0
  buffer_load_dwordx4 v11, s[52:55], s41 offen lds
  buffer_load_dwordx4 v12, s[52:55], s41 offen offset:1024 lds
  s_add_u32 s41, s41, 65536
  s_add_u32 m0, s42, 4096
  s_nop 0
  buffer_load_dwordx4 v11, s[52:55], s41 offen lds
  buffer_load_dwordx4 v12, s[52:55], s41 offen offset:1024 lds
  s_add_u32 s41, s41, 65536
  s_add_u32 m0, s42, 6144
  s_nop 0
  buffer_load_dwordx4 v11, s[52:55], s41 offen lds
  buffer_load_dwordx4 v12, s[52:55], s41 offen offset:1024 lds
  s_add_u32 s41, s41, 65536
  s_add_u32 m0, s42, 8192
  s_nop 0
  buffer_load_dwordx4 v11, s[52:55], s41 offen lds
  buffer_load_dwordx4 v12, s[52:55], s41 offen offset:1024 lds
  s_add_u32 s41, s41, 65536
  s_add_u32 m0, s42, 10240
  s_nop 0
  buffer_load_dwordx4 v11, s[52:55], s41 offen lds
  buffer_load_dwordx4 v12, s[52:55], s41 offen offset:1024 lds
  s_add_u32 s41, s41, 65536
NORING_62:
  s_nop 3
  s_mov_b32 s60, 0xbdd2d3e8
  v_mov_b32 v120, 0xc0135761
  s_mul_i32 s30, s25, 288
  s_lshl_b32 s31, s24, 3
  s_add_u32 s30, s30, s31
  s_lshl_b32 s31, s20, 1
  s_add_u32 s30, s30, s31
  s_mul_i32 s30, s30, 3072
  s_add_u32 s30, s30, 2363392
  s_add_u32 s31, s30, 3072
  v_mul_f32 v96, v48, v48
  v_mul_f32 v97, v49, v49
  v_mul_f32 v98, v50, v50
  v_mul_f32 v99, v51, v51
  v_mul_f32 v100, v52, v52
  v_mul_f32 v101, v53, v53
  v_mul_f32 v102, v54, v54
  v_mul_f32 v103, v55, v55
  v_fma_f32 v96, v96, s60, v120
  v_fma_f32 v97, v97, s60, v120
  v_fma_f32 v98, v98, s60, v120
  v_fma_f32 v99, v99, s60, v120
  v_fma_f32 v100, v100, s60, v120
  v_fma_f32 v101, v101, s60, v120
  v_fma_f32 v102, v102, s60, v120
  v_fma_f32 v103, v103, s60, v120
  v_mul_f32 v96, v96, v48
  v_mul_f32 v97, v97, v49
  v_mul_f32 v98, v98, v50
  v_mul_f32 v99, v99, v51
  v_mul_f32 v100, v100, v52
  v_mul_f32 v101, v101, v53
  v_mul_f32 v102, v102, v54
  v_mul_f32 v103, v103, v55
  v_exp_f32 v96, v96
  v_exp_f32 v97, v97
  v_exp_f32 v98, v98
  v_exp_f32 v99, v99
  v_exp_f32 v100, v100
  v_exp_f32 v101, v101
  v_exp_f32 v102, v102
  v_exp_f32 v103, v103
  v_add_f32 v96, 1.0, v96
  v_add_f32 v97, 1.0, v97
  v_add_f32 v98, 1.0, v98
  v_add_f32 v99, 1.0, v99
  v_add_f32 v100, 1.0, v100
  v_add_f32 v101, 1.0, v101
  v_add_f32 v102, 1.0, v102
  v_add_f32 v103, 1.0, v103
  v_rcp_f32 v96, v96
  v_rcp_f32 v97, v97
  v_rcp_f32 v98, v98
  v_rcp_f32 v99, v99
  v_rcp_f32 v100, v100
  v_rcp_f32 v101, v101
  v_rcp_f32 v102, v102
  v_rcp_f32 v103, v103
  v_mul_f32 v48, v48, v96
  v_mul_f32 v49, v49, v97
  v_mul_f32 v50, v50, v98
  v_mul_f32 v51, v51, v99
  v_mul_f32 v52, v52, v100
  v_mul_f32 v53, v53, v101
  v_mul_f32 v54, v54, v102
  v_mul_f32 v55, v55, v103
  v_cvt_pk_bf16_f32 v112, v48, v49
  v_cvt_pk_bf16_f32 v113, v50, v51
  v_cvt_pk_bf16_f32 v114, v52, v53
  v_cvt_pk_bf16_f32 v115, v54, v55
  buffer_store_dwordx4 v[112:115], v4, s[16:19], s30 offen offset:0 sc1
  v_mul_f32 v96, v56, v56
  v_mul_f32 v97, v57, v57
  v_mul_f32 v98, v58, v58
  v_mul_f32 v99, v59, v59
  v_mul_f32 v100, v60, v60
  v_mul_f32 v101, v61, v61
  v_mul_f32 v102, v62, v62
  v_mul_f32 v103, v63, v63
  v_fma_f32 v96, v96, s60, v120
  v_fma_f32 v97, v97, s60, v120
  v_fma_f32 v98, v98, s60, v120
  v_fma_f32 v99, v99, s60, v120
  v_fma_f32 v100, v100, s60, v120
  v_fma_f32 v101, v101, s60, v120
  v_fma_f32 v102, v102, s60, v120
  v_fma_f32 v103, v103, s60, v120
  v_mul_f32 v96, v96, v56
  v_mul_f32 v97, v97, v57
  v_mul_f32 v98, v98, v58
  v_mul_f32 v99, v99, v59
  v_mul_f32 v100, v100, v60
  v_mul_f32 v101, v101, v61
  v_mul_f32 v102, v102, v62
  v_mul_f32 v103, v103, v63
  v_exp_f32 v96, v96
  v_exp_f32 v97, v97
  v_exp_f32 v98, v98
  v_exp_f32 v99, v99
  v_exp_f32 v100, v100
  v_exp_f32 v101, v101
  v_exp_f32 v102, v102
  v_exp_f32 v103, v103
  v_add_f32 v96, 1.0, v96
  v_add_f32 v97, 1.0, v97
  v_add_f32 v98, 1.0, v98
  v_add_f32 v99, 1.0, v99
  v_add_f32 v100, 1.0, v100
  v_add_f32 v101, 1.0, v101
  v_add_f32 v102, 1.0, v102
  v_add_f32 v103, 1.0, v103
  v_rcp_f32 v96, v96
  v_rcp_f32 v97, v97
  v_rcp_f32 v98, v98
  v_rcp_f32 v99, v99
  v_rcp_f32 v100, v100
  v_rcp_f32 v101, v101
  v_rcp_f32 v102, v102
  v_rcp_f32 v103, v103
  v_mul_f32 v56, v56, v96
  v_mul_f32 v57, v57, v97
  v_mul_f32 v58, v58, v98
  v_mul_f32 v59, v59, v99
  v_mul_f32 v60, v60, v100
  v_mul_f32 v61, v61, v101
  v_mul_f32 v62, v62, v102
  v_mul_f32 v63, v63, v103
  v_cvt_pk_bf16_f32 v116, v56, v57
  v_cvt_pk_bf16_f32 v117, v58, v59
  v_cvt_pk_bf16_f32 v118, v60, v61
  v_cvt_pk_bf16_f32 v119, v62, v63
  buffer_store_dwordx4 v[116:119], v4, s[16:19], s31 offen offset:0 sc1
  v_mul_f32 v96, v64, v64
  v_mul_f32 v97, v65, v65
  v_mul_f32 v98, v66, v66
  v_mul_f32 v99, v67, v67
  v_mul_f32 v100, v68, v68
  v_mul_f32 v101, v69, v69
  v_mul_f32 v102, v70, v70
  v_mul_f32 v103, v71, v71
  v_fma_f32 v96, v96, s60, v120
  v_fma_f32 v97, v97, s60, v120
  v_fma_f32 v98, v98, s60, v120
  v_fma_f32 v99, v99, s60, v120
  v_fma_f32 v100, v100, s60, v120
  v_fma_f32 v101, v101, s60, v120
  v_fma_f32 v102, v102, s60, v120
  v_fma_f32 v103, v103, s60, v120
  v_mul_f32 v96, v96, v64
  v_mul_f32 v97, v97, v65
  v_mul_f32 v98, v98, v66
  v_mul_f32 v99, v99, v67
  v_mul_f32 v100, v100, v68
  v_mul_f32 v101, v101, v69
  v_mul_f32 v102, v102, v70
  v_mul_f32 v103, v103, v71
  v_exp_f32 v96, v96
  v_exp_f32 v97, v97
  v_exp_f32 v98, v98
  v_exp_f32 v99, v99
  v_exp_f32 v100, v100
  v_exp_f32 v101, v101
  v_exp_f32 v102, v102
  v_exp_f32 v103, v103
  v_add_f32 v96, 1.0, v96
  v_add_f32 v97, 1.0, v97
  v_add_f32 v98, 1.0, v98
  v_add_f32 v99, 1.0, v99
  v_add_f32 v100, 1.0, v100
  v_add_f32 v101, 1.0, v101
  v_add_f32 v102, 1.0, v102
  v_add_f32 v103, 1.0, v103
  v_rcp_f32 v96, v96
  v_rcp_f32 v97, v97
  v_rcp_f32 v98, v98
  v_rcp_f32 v99, v99
  v_rcp_f32 v100, v100
  v_rcp_f32 v101, v101
  v_rcp_f32 v102, v102
  v_rcp_f32 v103, v103
  v_mul_f32 v64, v64, v96
  v_mul_f32 v65, v65, v97
  v_mul_f32 v66, v66, v98
  v_mul_f32 v67, v67, v99
  v_mul_f32 v68, v68, v100
  v_mul_f32 v69, v69, v101
  v_mul_f32 v70, v70, v102
  v_mul_f32 v71, v71, v103
  v_cvt_pk_bf16_f32 v112, v64, v65
  v_cvt_pk_bf16_f32 v113, v66, v67
  v_cvt_pk_bf16_f32 v114, v68, v69
  v_cvt_pk_bf16_f32 v115, v70, v71
  buffer_store_dwordx4 v[112:115], v4, s[16:19], s30 offen offset:1024 sc1
  v_mul_f32 v96, v72, v72
  v_mul_f32 v97, v73, v73
  v_mul_f32 v98, v74, v74
  v_mul_f32 v99, v75, v75
  v_mul_f32 v100, v76, v76
  v_mul_f32 v101, v77, v77
  v_mul_f32 v102, v78, v78
  v_mul_f32 v103, v79, v79
  v_fma_f32 v96, v96, s60, v120
  v_fma_f32 v97, v97, s60, v120
  v_fma_f32 v98, v98, s60, v120
  v_fma_f32 v99, v99, s60, v120
  v_fma_f32 v100, v100, s60, v120
  v_fma_f32 v101, v101, s60, v120
  v_fma_f32 v102, v102, s60, v120
  v_fma_f32 v103, v103, s60, v120
  v_mul_f32 v96, v96, v72
  v_mul_f32 v97, v97, v73
  v_mul_f32 v98, v98, v74
  v_mul_f32 v99, v99, v75
  v_mul_f32 v100, v100, v76
  v_mul_f32 v101, v101, v77
  v_mul_f32 v102, v102, v78
  v_mul_f32 v103, v103, v79
  v_exp_f32 v96, v96
  v_exp_f32 v97, v97
  v_exp_f32 v98, v98
  v_exp_f32 v99, v99
  v_exp_f32 v100, v100
  v_exp_f32 v101, v101
  v_exp_f32 v102, v102
  v_exp_f32 v103, v103
  v_add_f32 v96, 1.0, v96
  v_add_f32 v97, 1.0, v97
  v_add_f32 v98, 1.0, v98
  v_add_f32 v99, 1.0, v99
  v_add_f32 v100, 1.0, v100
  v_add_f32 v101, 1.0, v101
  v_add_f32 v102, 1.0, v102
  v_add_f32 v103, 1.0, v103
  v_rcp_f32 v96, v96
  v_rcp_f32 v97, v97
  v_rcp_f32 v98, v98
  v_rcp_f32 v99, v99
  v_rcp_f32 v100, v100
  v_rcp_f32 v101, v101
  v_rcp_f32 v102, v102
  v_rcp_f32 v103, v103
  v_mul_f32 v72, v72, v96
  v_mul_f32 v73, v73, v97
  v_mul_f32 v74, v74, v98
  v_mul_f32 v75, v75, v99
  v_mul_f32 v76, v76, v100
  v_mul_f32 v77, v77, v101
  v_mul_f32 v78, v78, v102
  v_mul_f32 v79, v79, v103
  v_cvt_pk_bf16_f32 v116, v72, v73
  v_cvt_pk_bf16_f32 v117, v74, v75
  v_cvt_pk_bf16_f32 v118, v76, v77
  v_cvt_pk_bf16_f32 v119, v78, v79
  buffer_store_dwordx4 v[116:119], v4, s[16:19], s31 offen offset:1024 sc1
  v_mul_f32 v96, v80, v80
  v_mul_f32 v97, v81, v81
  v_mul_f32 v98, v82, v82
  v_mul_f32 v99, v83, v83
  v_mul_f32 v100, v84, v84
  v_mul_f32 v101, v85, v85
  v_mul_f32 v102, v86, v86
  v_mul_f32 v103, v87, v87
  v_fma_f32 v96, v96, s60, v120
  v_fma_f32 v97, v97, s60, v120
  v_fma_f32 v98, v98, s60, v120
  v_fma_f32 v99, v99, s60, v120
  v_fma_f32 v100, v100, s60, v120
  v_fma_f32 v101, v101, s60, v120
  v_fma_f32 v102, v102, s60, v120
  v_fma_f32 v103, v103, s60, v120
  v_mul_f32 v96, v96, v80
  v_mul_f32 v97, v97, v81
  v_mul_f32 v98, v98, v82
  v_mul_f32 v99, v99, v83
  v_mul_f32 v100, v100, v84
  v_mul_f32 v101, v101, v85
  v_mul_f32 v102, v102, v86
  v_mul_f32 v103, v103, v87
  v_exp_f32 v96, v96
  v_exp_f32 v97, v97
  v_exp_f32 v98, v98
  v_exp_f32 v99, v99
  v_exp_f32 v100, v100
  v_exp_f32 v101, v101
  v_exp_f32 v102, v102
  v_exp_f32 v103, v103
  v_add_f32 v96, 1.0, v96
  v_add_f32 v97, 1.0, v97
  v_add_f32 v98, 1.0, v98
  v_add_f32 v99, 1.0, v99
  v_add_f32 v100, 1.0, v100
  v_add_f32 v101, 1.0, v101
  v_add_f32 v102, 1.0, v102
  v_add_f32 v103, 1.0, v103
  v_rcp_f32 v96, v96
  v_rcp_f32 v97, v97
  v_rcp_f32 v98, v98
  v_rcp_f32 v99, v99
  v_rcp_f32 v100, v100
  v_rcp_f32 v101, v101
  v_rcp_f32 v102, v102
  v_rcp_f32 v103, v103
  v_mul_f32 v80, v80, v96
  v_mul_f32 v81, v81, v97
  v_mul_f32 v82, v82, v98
  v_mul_f32 v83, v83, v99
  v_mul_f32 v84, v84, v100
  v_mul_f32 v85, v85, v101
  v_mul_f32 v86, v86, v102
  v_mul_f32 v87, v87, v103
  v_cvt_pk_bf16_f32 v112, v80, v81
  v_cvt_pk_bf16_f32 v113, v82, v83
  v_cvt_pk_bf16_f32 v114, v84, v85
  v_cvt_pk_bf16_f32 v115, v86, v87
  buffer_store_dwordx4 v[112:115], v4, s[16:19], s30 offen offset:2048 sc1
  v_mul_f32 v96, v88, v88
  v_mul_f32 v97, v89, v89
  v_mul_f32 v98, v90, v90
  v_mul_f32 v99, v91, v91
  v_mul_f32 v100, v92, v92
  v_mul_f32 v101, v93, v93
  v_mul_f32 v102, v94, v94
  v_mul_f32 v103, v95, v95
  v_fma_f32 v96, v96, s60, v120
  v_fma_f32 v97, v97, s60, v120
  v_fma_f32 v98, v98, s60, v120
  v_fma_f32 v99, v99, s60, v120
  v_fma_f32 v100, v100, s60, v120
  v_fma_f32 v101, v101, s60, v120
  v_fma_f32 v102, v102, s60, v120
  v_fma_f32 v103, v103, s60, v120
  v_mul_f32 v96, v96, v88
  v_mul_f32 v97, v97, v89
  v_mul_f32 v98, v98, v90
  v_mul_f32 v99, v99, v91
  v_mul_f32 v100, v100, v92
  v_mul_f32 v101, v101, v93
  v_mul_f32 v102, v102, v94
  v_mul_f32 v103, v103, v95
  v_exp_f32 v96, v96
  v_exp_f32 v97, v97
  v_exp_f32 v98, v98
  v_exp_f32 v99, v99
  v_exp_f32 v100, v100
  v_exp_f32 v101, v101
  v_exp_f32 v102, v102
  v_exp_f32 v103, v103
  v_add_f32 v96, 1.0, v96
  v_add_f32 v97, 1.0, v97
  v_add_f32 v98, 1.0, v98
  v_add_f32 v99, 1.0, v99
  v_add_f32 v100, 1.0, v100
  v_add_f32 v101, 1.0, v101
  v_add_f32 v102, 1.0, v102
  v_add_f32 v103, 1.0, v103
  v_rcp_f32 v96, v96
  v_rcp_f32 v97, v97
  v_rcp_f32 v98, v98
  v_rcp_f32 v99, v99
  v_rcp_f32 v100, v100
  v_rcp_f32 v101, v101
  v_rcp_f32 v102, v102
  v_rcp_f32 v103, v103
  v_mul_f32 v88, v88, v96
  v_mul_f32 v89, v89, v97
  v_mul_f32 v90, v90, v98
  v_mul_f32 v91, v91, v99
  v_mul_f32 v92, v92, v100
  v_mul_f32 v93, v93, v101
  v_mul_f32 v94, v94, v102
  v_mul_f32 v95, v95, v103
  v_cvt_pk_bf16_f32 v116, v88, v89
  v_cvt_pk_bf16_f32 v117, v90, v91
  v_cvt_pk_bf16_f32 v118, v92, v93
  v_cvt_pk_bf16_f32 v119, v94, v95
  buffer_store_dwordx4 v[116:119], v4, s[16:19], s31 offen offset:2048 sc1
  s_mul_i32 s30, s24, 79
  s_lshr_b32 s30, s30, 10
  s_cmp_eq_u32 s30, 2
  s_cselect_b32 s61, 5, 12
  s_lshl_b32 s30, s30, 8
  s_lshl_b32 s31, s24, 2
  s_add_u32 s31, s31, 640
  s_cmp_ge_u32 s2, 192
  s_cselect_b32 s30, s31, s30
  s_cselect_b32 s61, 0, s61
  s_lshl_b32 s34, s25, 10
  s_add_u32 s34, s34, s30
  s_add_u32 s34, s34, 17388544
  s_waitcnt vmcnt(0)
  s_barrier
  s_cmp_lg_u32 s20, 0
  s_cbranch_scc1 SIG_65
  v_mov_b32 v5, 0
  v_mov_b32 v6, 1
  v_mov_b32 v7, 1
  s_mov_b64 exec, 1
  buffer_atomic_add v6, v5, s[16:19], s34 offen sc0 sc1
  s_waitcnt vmcnt(0)
  v_readfirstlane_b32 s43, v6
  s_nop 0
  s_cmp_lg_u32 s43, s61
  s_cbranch_scc1 SIGR_66
  buffer_store_dword v7, v5, s[16:19], s34 offen offset:128 sc1
SIGR_66:
  s_mov_b64 exec, -1
SIG_65:
  s_cmp_ge_u32 s2, 192
  s_cbranch_scc1 NOG2_8
  s_cmp_lt_u32 s20, 2
  s_cbranch_scc1 G2M_64
  s_lshr_b32 s21, s2, 3
  s_lshl_b32 s21, s21, 1
  s_add_u32 s21, s21, s20
  s_sub_u32 s21, s21, 2
  s_and_b32 s22, s21, 3
  s_mul_i32 s22, s22, 52
  s_lshr_b32 s21, s21, 2
  s_add_u32 s21, s21, s22
  s_add_u32 s21, s21, 31
  s_lshl_b32 s21, s21, 16
  s_and_b32 s22, s2, 7
  s_lshl_b32 s22, s22, 9
  s_add_u32 s21, s21, s22
  v_lshrrev_b32 v5, 2, v1
  v_lshlrev_b32 v5, 12, v5
  v_and_b32 v6, 3, v1
  v_lshl_add_u32 v5, v6, 7, v5
  buffer_load_dword v9, v5, s[52:55], s21 offen
G2M_64:
  v_mov_b32 v5, 0
  s_mov_b32 s22, 0x20000
POLL_68:
  buffer_load_dword v6, v5, s[16:19], s62 offen offset:128 sc1
  s_waitcnt vmcnt(0)
  v_cmp_ne_u32 vcc, 1, v6
  s_nop 4
  s_cbranch_vccz POLLD_69
  s_sleep 2
  s_sub_u32 s22, s22, 1
  s_cmp_lg_u32 s22, 0
  s_cbranch_scc1 POLL_68
POLLD_69:
  buffer_load_dwordx4 v[132:135], v10, s[16:19], s40 offen offset:0 sc1
  buffer_load_dwordx4 v[136:139], v10, s[16:19], s40 offen offset:256 sc1
  buffer_load_dwordx4 v[140:143], v10, s[16:19], s40 offen offset:1024 sc1
  buffer_load_dwordx4 v[144:147], v10, s[16:19], s40 offen offset:1280 sc1
  buffer_load_dwordx4 v[148:151], v10, s[16:19], s40 offen offset:2048 sc1
  buffer_load_dwordx4 v[152:155], v10, s[16:19], s40 offen offset:2304 sc1
  s_add_u32 s40, s40, 6144
  buffer_load_dwordx4 v[156:159], v10, s[16:19], s40 offen offset:0 sc1
  buffer_load_dwordx4 v[160:163], v10, s[16:19], s40 offen offset:256 sc1
  buffer_load_dwordx4 v[164:167], v10, s[16:19], s40 offen offset:1024 sc1
  buffer_load_dwordx4 v[168:171], v10, s[16:19], s40 offen offset:1280 sc1
  buffer_load_dwordx4 v[172:175], v10, s[16:19], s40 offen offset:2048 sc1
  buffer_load_dwordx4 v[176:179], v10, s[16:19], s40 offen offset:2304 sc1
  s_add_u32 s40, s40, 6144
  buffer_load_dwordx4 v[180:183], v10, s[16:19], s40 offen offset:0 sc1
  buffer_load_dwordx4 v[184:187], v10, s[16:19], s40 offen offset:256 sc1
  buffer_load_dwordx4 v[188:191], v10, s[16:19], s40 offen offset:1024 sc1
G2GOT_67:
  ds_read_b64_tr_b16 v[204:205], v13 offset:0
  ds_read_b64_tr_b16 v[206:207], v13 offset:1024
  ds_read_b64_tr_b16 v[208:209], v14 offset:0
  ds_read_b64_tr_b16 v[210:211], v14 offset:1024
  ds_read_b64_tr_b16 v[212:213], v15 offset:0
  ds_read_b64_tr_b16 v[214:215], v15 offset:1024
  ds_read_b64_tr_b16 v[216:217], v16 offset:0
  ds_read_b64_tr_b16 v[218:219], v16 offset:1024
  s_waitcnt vmcnt(12)
  s_setprio 2
  s_cmp_ge_u32 s2, 216
  s_cbranch_scc1 G2P_70
  s_setprio 0
  s_cmp_ge_u32 s2, 192
  s_cbranch_scc1 G2P_70
  s_setprio 0
G2P_70:
  s_waitcnt lgkmcnt(0)
  v_mfma_f32_16x16x32_bf16 v[36:39], v[132:135], v[204:207], 0
  s_add_u32 m0, s42, 0
  s_waitcnt vmcnt(9)
  v_mfma_f32_16x16x32_bf16 v[40:43], v[136:139], v[204:207], 0
  ds_read_b64_tr_b16 v[220:221], v13 offset:4096
  ds_read_b64_tr_b16 v[222:223], v13 offset:5120
  v_mfma_f32_16x16x32_bf16 v[44:47], v[140:143], v[204:207], 0
  buffer_load_dwordx4 v11, s[52:55], s41 offen lds
  v_mfma_f32_16x16x32_bf16 v[60:63], v[132:135], v[208:211], 0
  ds_read_b64_tr_b16 v[224:225], v14 offset:4096
  ds_read_b64_tr_b16 v[226:227], v14 offset:5120
  v_mfma_f32_16x16x32_bf16 v[64:67], v[136:139], v[208:211], 0
  buffer_load_dwordx4 v12, s[52:55], s41 offen offset:1024 lds
  s_add_u32 s41, s41, 65536
  v_mfma_f32_16x16x32_bf16 v[68:71], v[140:143], v[208:211], 0
  v_mfma_f32_16x16x32_bf16 v[84:87], v[132:135], v[212:215], 0
  buffer_load_dwordx4 v[192:195], v10, s[16:19], s40 offen offset:1280 sc1
  v_mfma_f32_16x16x32_bf16 v[88:91], v[136:139], v[212:215], 0
  v_mfma_f32_16x16x32_bf16 v[92:95], v[140:143], v[212:215], 0
  buffer_load_dwordx4 v[196:199], v10, s[16:19], s40 offen offset:2048 sc1
  v_mfma_f32_16x16x32_bf16 v[108:111], v[132:135], v[216:219], 0
  v_mfma_f32_16x16x32_bf16 v[112:115], v[136:139], v[216:219], 0
  buffer_load_dwordx4 v[200:203], v10, s[16:19], s40 offen offset:2304 sc1
  s_add_u32 s40, s40, 6144
  v_mfma_f32_16x16x32_bf16 v[116:119], v[140:143], v[216:219], 0
  v_mfma_f32_16x16x32_bf16 v[48:51], v[144:147], v[204:207], 0
  s_add_u32 m0, s42, 2048
  s_waitcnt vmcnt(11)
  v_mfma_f32_16x16x32_bf16 v[52:55], v[148:151], v[204:207], 0
  ds_read_b64_tr_b16 v[228:229], v15 offset:4096
  ds_read_b64_tr_b16 v[230:231], v15 offset:5120
  v_mfma_f32_16x16x32_bf16 v[56:59], v[152:155], v[204:207], 0
  buffer_load_dwordx4 v11, s[52:55], s41 offen lds
  v_mfma_f32_16x16x32_bf16 v[72:75], v[144:147], v[208:211], 0
  ds_read_b64_tr_b16 v[232:233], v16 offset:4096
  ds_read_b64_tr_b16 v[234:235], v16 offset:5120
  v_mfma_f32_16x16x32_bf16 v[76:79], v[148:151], v[208:211], 0
  buffer_load_dwordx4 v12, s[52:55], s41 offen offset:1024 lds
  s_add_u32 s41, s41, 65536
  s_add_u32 s41, s41, s89
  v_mfma_f32_16x16x32_bf16 v[80:83], v[152:155], v[208:211], 0
  v_mfma_f32_16x16x32_bf16 v[96:99], v[144:147], v[212:215], 0
  buffer_load_dwordx4 v[132:135], v10, s[16:19], s40 offen offset:0 sc1
  v_mfma_f32_16x16x32_bf16 v[100:103], v[148:151], v[212:215], 0
  v_mfma_f32_16x16x32_bf16 v[104:107], v[152:155], v[212:215], 0
  buffer_load_dwordx4 v[136:139], v10, s[16:19], s40 offen offset:256 sc1
  v_mfma_f32_16x16x32_bf16 v[120:123], v[144:147], v[216:219], 0
  v_mfma_f32_16x16x32_bf16 v[124:127], v[148:151], v[216:219], 0
  buffer_load_dwordx4 v[140:143], v10, s[16:19], s40 offen offset:1024 sc1
  v_mfma_f32_16x16x32_bf16 v[128:131], v[152:155], v[216:219], 0
  s_waitcnt lgkmcnt(0)
  v_mfma_f32_16x16x32_bf16 v[36:39], v[156:159], v[220:223], v[36:39]
  s_add_u32 m0, s42, 4096
  s_waitcnt vmcnt(13)
  v_mfma_f32_16x16x32_bf16 v[40:43], v[160:163], v[220:223], v[40:43]
  ds_read_b64_tr_b16 v[204:205], v13 offset:8192
  ds_read_b64_tr_b16 v[206:207], v13 offset:9216
  v_mfma_f32_16x16x32_bf16 v[44:47], v[164:167], v[220:223], v[44:47]
  buffer_load_dwordx4 v11, s[52:55], s41 offen lds
  v_mfma_f32_16x16x32_bf16 v[60:63], v[156:159], v[224:227], v[60:63]
  ds_read_b64_tr_b16 v[208:209], v14 offset:8192
  ds_read_b64_tr_b16 v[210:211], v14 offset:9216
  v_mfma_f32_16x16x32_bf16 v[64:67], v[160:163], v[224:227], v[64:67]
  buffer_load_dwordx4 v12, s[52:55], s41 offen offset:1024 lds
  s_add_u32 s41, s41, 65536
  v_mfma_f32_16x16x32_bf16 v[68:71], v[164:167], v[224:227], v[68:71]
  v_mfma_f32_16x16x32_bf16 v[84:87], v[156:159], v[228:231], v[84:87]
  buffer_load_dwordx4 v[144:147], v10, s[16:19], s40 offen offset:1280 sc1
  v_mfma_f32_16x16x32_bf16 v[88:91], v[160:163], v[228:231], v[88:91]
  v_mfma_f32_16x16x32_bf16 v[92:95], v[164:167], v[228:231], v[92:95]
  buffer_load_dwordx4 v[148:151], v10, s[16:19], s40 offen offset:2048 sc1
  v_mfma_f32_16x16x32_bf16 v[108:111], v[156:159], v[232:235], v[108:111]
  v_mfma_f32_16x16x32_bf16 v[112:115], v[160:163], v[232:235], v[112:115]
  buffer_load_dwordx4 v[152:155], v10, s[16:19], s40 offen offset:2304 sc1
  s_add_u32 s40, s40, 6144
  s_add_u32 s40, s40, s91
  v_mfma_f32_16x16x32_bf16 v[116:119], v[164:167], v[232:235], v[116:119]
  buffer_load_dword v25, v5, s[16:19], s90 offen offset:128 sc1
  v_mfma_f32_16x16x32_bf16 v[48:51], v[168:171], v[220:223], v[48:51]
  s_add_u32 m0, s42, 6144
  s_waitcnt vmcnt(16)
  v_mfma_f32_16x16x32_bf16 v[52:55], v[172:175], v[220:223], v[52:55]
  ds_read_b64_tr_b16 v[212:213], v15 offset:8192
  ds_read_b64_tr_b16 v[214:215], v15 offset:9216
  v_mfma_f32_16x16x32_bf16 v[56:59], v[176:179], v[220:223], v[56:59]
  buffer_load_dwordx4 v11, s[52:55], s41 offen lds
  v_mfma_f32_16x16x32_bf16 v[72:75], v[168:171], v[224:227], v[72:75]
  ds_read_b64_tr_b16 v[216:217], v16 offset:8192
  ds_read_b64_tr_b16 v[218:219], v16 offset:9216
  v_mfma_f32_16x16x32_bf16 v[76:79], v[172:175], v[224:227], v[76:79]
  buffer_load_dwordx4 v12, s[52:55], s41 offen offset:1024 lds
  s_add_u32 s41, s41, 65536
  v_mfma_f32_16x16x32_bf16 v[80:83], v[176:179], v[224:227], v[80:83]
  v_mfma_f32_16x16x32_bf16 v[96:99], v[168:171], v[228:231], v[96:99]
  v_mfma_f32_16x16x32_bf16 v[100:103], v[172:175], v[228:231], v[100:103]
  v_mfma_f32_16x16x32_bf16 v[104:107], v[176:179], v[228:231], v[104:107]
  v_mfma_f32_16x16x32_bf16 v[120:123], v[168:171], v[232:235], v[120:123]
  v_mfma_f32_16x16x32_bf16 v[124:127], v[172:175], v[232:235], v[124:127]
  v_mfma_f32_16x16x32_bf16 v[128:131], v[176:179], v[232:235], v[128:131]
  s_waitcnt lgkmcnt(0)
  v_mfma_f32_16x16x32_bf16 v[36:39], v[180:183], v[204:207], v[36:39]
  s_add_u32 m0, s42, 8192
  s_waitcnt vmcnt(11)
  v_mfma_f32_16x16x32_bf16 v[40:43], v[184:187], v[204:207], v[40:43]
  ds_read_b64_tr_b16 v[220:221], v13 offset:0
  ds_read_b64_tr_b16 v[222:223], v13 offset:1024
  v_mfma_f32_16x16x32_bf16 v[44:47], v[188:191], v[204:207], v[44:47]
  buffer_load_dwordx4 v11, s[52:55], s41 offen lds
  v_mfma_f32_16x16x32_bf16 v[60:63], v[180:183], v[208:211], v[60:63]
  ds_read_b64_tr_b16 v[224:225], v14 offset:0
  ds_read_b64_tr_b16 v[226:227], v14 offset:1024
  v_mfma_f32_16x16x32_bf16 v[64:67], v[184:187], v[208:211], v[64:67]
  buffer_load_dwordx4 v12, s[52:55], s41 offen offset:1024 lds
  s_add_u32 s41, s41, 65536
  v_mfma_f32_16x16x32_bf16 v[68:71], v[188:191], v[208:211], v[68:71]
  v_mfma_f32_16x16x32_bf16 v[84:87], v[180:183], v[212:215], v[84:87]
  v_mfma_f32_16x16x32_bf16 v[88:91], v[184:187], v[212:215], v[88:91]
  v_mfma_f32_16x16x32_bf16 v[92:95], v[188:191], v[212:215], v[92:95]
  v_mfma_f32_16x16x32_bf16 v[108:111], v[180:183], v[216:219], v[108:111]
  v_mfma_f32_16x16x32_bf16 v[112:115], v[184:187], v[216:219], v[112:115]
  v_mfma_f32_16x16x32_bf16 v[116:119], v[188:191], v[216:219], v[116:119]
  v_mfma_f32_16x16x32_bf16 v[48:51], v[192:195], v[204:207], v[48:51]
  s_add_u32 m0, s42, 10240
  s_waitcnt vmcnt(10)
  s_waitcnt vmcnt(4)
  v_cmp_ne_u32 vcc, 1, v25
  s_nop 4
  s_cbranch_vccnz G2SU_71
G2BU_72:
  v_mfma_f32_16x16x32_bf16 v[52:55], v[196:199], v[204:207], v[52:55]
  ds_read_b64_tr_b16 v[228:229], v15 offset:0
  ds_read_b64_tr_b16 v[230:231], v15 offset:1024
  v_mfma_f32_16x16x32_bf16 v[56:59], v[200:203], v[204:207], v[56:59]
  buffer_load_dwordx4 v11, s[52:55], s41 offen lds
  v_mfma_f32_16x16x32_bf16 v[72:75], v[192:195], v[208:211], v[72:75]
  ds_read_b64_tr_b16 v[232:233], v16 offset:0
  ds_read_b64_tr_b16 v[234:235], v16 offset:1024
  v_mfma_f32_16x16x32_bf16 v[76:79], v[196:199], v[208:211], v[76:79]
  buffer_load_dwordx4 v12, s[52:55], s41 offen offset:1024 lds
  s_add_u32 s41, s41, 65536
  v_mfma_f32_16x16x32_bf16 v[80:83], v[200:203], v[208:211], v[80:83]
  buffer_load_dwordx4 v[156:159], v10, s[16:19], s40 offen offset:0 sc1
  v_mfma_f32_16x16x32_bf16 v[96:99], v[192:195], v[212:215], v[96:99]
  buffer_load_dwordx4 v[160:163], v10, s[16:19], s40 offen offset:256 sc1
  v_mfma_f32_16x16x32_bf16 v[100:103], v[196:199], v[212:215], v[100:103]
  buffer_load_dwordx4 v[164:167], v10, s[16:19], s40 offen offset:1024 sc1
  v_mfma_f32_16x16x32_bf16 v[104:107], v[200:203], v[212:215], v[104:107]
  buffer_load_dwordx4 v[168:171], v10, s[16:19], s40 offen offset:1280 sc1
  v_mfma_f32_16x16x32_bf16 v[120:123], v[192:195], v[216:219], v[120:123]
  buffer_load_dwordx4 v[172:175], v10, s[16:19], s40 offen offset:2048 sc1
  v_mfma_f32_16x16x32_bf16 v[124:127], v[196:199], v[216:219], v[124:127]
  buffer_load_dwordx4 v[176:179], v10, s[16:19], s40 offen offset:2304 sc1
  s_add_u32 s40, s40, 6144
  v_mfma_f32_16x16x32_bf16 v[128:131], v[200:203], v[216:219], v[128:131]
  s_waitcnt lgkmcnt(0)
  v_mfma_f32_16x16x32_bf16 v[36:39], v[132:135], v[220:223], v[36:39]
  s_add_u32 m0, s42, 0
  s_waitcnt vmcnt(10)
  v_mfma_f32_16x16x32_bf16 v[40:43], v[136:139], v[220:223], v[40:43]
  ds_read_b64_tr_b16 v[204:205], v13 offset:4096
  ds_read_b64_tr_b16 v[206:207], v13 offset:5120
  v_mfma_f32_16x16x32_bf16 v[44:47], v[140:143], v[220:223], v[44:47]
  buffer_load_dwordx4 v11, s[52:55], s41 offen lds
  v_mfma_f32_16x16x32_bf16 v[60:63], v[132:135], v[224:227], v[60:63]
  ds_read_b64_tr_b16 v[208:209], v14 offset:4096
  ds_read_b64_tr_b16 v[210:211], v14 offset:5120
  v_mfma_f32_16x16x32_bf16 v[64:67], v[136:139], v[224:227], v[64:67]
  buffer_load_dwordx4 v12, s[52:55], s41 offen offset:1024 lds
  s_add_u32 s41, s41, 65536
  v_mfma_f32_16x16x32_bf16 v[68:71], v[140:143], v[224:227], v[68:71]
  buffer_load_dwordx4 v[180:183], v10, s[16:19], s40 offen offset:0 sc1
  v_mfma_f32_16x16x32_bf16 v[84:87], v[132:135], v[228:231], v[84:87]
  buffer_load_dwordx4 v[184:187], v10, s[16:19], s40 offen offset:256 sc1
  v_mfma_f32_16x16x32_bf16 v[88:91], v[136:139], v[228:231], v[88:91]
  buffer_load_dwordx4 v[188:191], v10, s[16:19], s40 offen offset:1024 sc1
  v_mfma_f32_16x16x32_bf16 v[92:95], v[140:143], v[228:231], v[92:95]
  buffer_load_dwordx4 v[192:195], v10, s[16:19], s40 offen offset:1280 sc1
  v_mfma_f32_16x16x32_bf16 v[108:111], v[132:135], v[232:235], v[108:111]
  buffer_load_dwordx4 v[196:199], v10, s[16:19], s40 offen offset:2048 sc1
  v_mfma_f32_16x16x32_bf16 v[112:115], v[136:139], v[232:235], v[112:115]
  buffer_load_dwordx4 v[200:203], v10, s[16:19], s40 offen offset:2304 sc1
  s_add_u32 s40, s40, 6144
  v_mfma_f32_16x16x32_bf16 v[116:119], v[140:143], v[232:235], v[116:119]
  v_mfma_f32_16x16x32_bf16 v[48:51], v[144:147], v[220:223], v[48:51]
  s_add_u32 m0, s42, 2048
  s_waitcnt vmcnt(11)
  v_mfma_f32_16x16x32_bf16 v[52:55], v[148:151], v[220:223], v[52:55]
  ds_read_b64_tr_b16 v[212:213], v15 offset:4096
  ds_read_b64_tr_b16 v[214:215], v15 offset:5120
  v_mfma_f32_16x16x32_bf16 v[56:59], v[152:155], v[220:223], v[56:59]
  buffer_load_dwordx4 v11, s[52:55], s41 offen lds
  v_mfma_f32_16x16x32_bf16 v[72:75], v[144:147], v[224:227], v[72:75]
  ds_read_b64_tr_b16 v[216:217], v16 offset:4096
  ds_read_b64_tr_b16 v[218:219], v16 offset:5120
  v_mfma_f32_16x16x32_bf16 v[76:79], v[148:151], v[224:227], v[76:79]
  buffer_load_dwordx4 v12, s[52:55], s41 offen offset:1024 lds
  s_add_u32 s41, s41, 65536
  v_mfma_f32_16x16x32_bf16 v[80:83], v[152:155], v[224:227], v[80:83]
  v_mfma_f32_16x16x32_bf16 v[96:99], v[144:147], v[228:231], v[96:99]
  buffer_load_dwordx4 v[132:135], v10, s[16:19], s40 offen offset:0 sc1
  v_mfma_f32_16x16x32_bf16 v[100:103], v[148:151], v[228:231], v[100:103]
  v_mfma_f32_16x16x32_bf16 v[104:107], v[152:155], v[228:231], v[104:107]
  buffer_load_dwordx4 v[136:139], v10, s[16:19], s40 offen offset:256 sc1
  v_mfma_f32_16x16x32_bf16 v[120:123], v[144:147], v[232:235], v[120:123]
  v_mfma_f32_16x16x32_bf16 v[124:127], v[148:151], v[232:235], v[124:127]
  buffer_load_dwordx4 v[140:143], v10, s[16:19], s40 offen offset:1024 sc1
  v_mfma_f32_16x16x32_bf16 v[128:131], v[152:155], v[232:235], v[128:131]
  s_waitcnt lgkmcnt(0)
  v_mfma_f32_16x16x32_bf16 v[36:39], v[156:159], v[204:207], v[36:39]
  s_add_u32 m0, s42, 4096
  s_waitcnt vmcnt(13)
  v_mfma_f32_16x16x32_bf16 v[40:43], v[160:163], v[204:207], v[40:43]
  ds_read_b64_tr_b16 v[220:221], v13 offset:8192
  ds_read_b64_tr_b16 v[222:223], v13 offset:9216
  v_mfma_f32_16x16x32_bf16 v[44:47], v[164:167], v[204:207], v[44:47]
  buffer_load_dwordx4 v11, s[52:55], s41 offen lds
  v_mfma_f32_16x16x32_bf16 v[60:63], v[156:159], v[208:211], v[60:63]
  ds_read_b64_tr_b16 v[224:225], v14 offset:8192
  ds_read_b64_tr_b16 v[226:227], v14 offset:9216
  v_mfma_f32_16x16x32_bf16 v[64:67], v[160:163], v[208:211], v[64:67]
  buffer_load_dwordx4 v12, s[52:55], s41 offen offset:1024 lds
  s_add_u32 s41, s41, 65536
  v_mfma_f32_16x16x32_bf16 v[68:71], v[164:167], v[208:211], v[68:71]
  v_mfma_f32_16x16x32_bf16 v[84:87], v[156:159], v[212:215], v[84:87]
  buffer_load_dwordx4 v[144:147], v10, s[16:19], s40 offen offset:1280 sc1
  v_mfma_f32_16x16x32_bf16 v[88:91], v[160:163], v[212:215], v[88:91]
  v_mfma_f32_16x16x32_bf16 v[92:95], v[164:167], v[212:215], v[92:95]
  buffer_load_dwordx4 v[148:151], v10, s[16:19], s40 offen offset:2048 sc1
  v_mfma_f32_16x16x32_bf16 v[108:111], v[156:159], v[216:219], v[108:111]
  v_mfma_f32_16x16x32_bf16 v[112:115], v[160:163], v[216:219], v[112:115]
  buffer_load_dwordx4 v[152:155], v10, s[16:19], s40 offen offset:2304 sc1
  s_add_u32 s40, s40, 6144
  v_mfma_f32_16x16x32_bf16 v[116:119], v[164:167], v[216:219], v[116:119]
  v_mfma_f32_16x16x32_bf16 v[48:51], v[168:171], v[204:207], v[48:51]
  s_add_u32 m0, s42, 6144
  s_waitcnt vmcnt(13)
  v_mfma_f32_16x16x32_bf16 v[52:55], v[172:175], v[204:207], v[52:55]
  ds_read_b64_tr_b16 v[228:229], v15 offset:8192
  ds_read_b64_tr_b16 v[230:231], v15 offset:9216
  v_mfma_f32_16x16x32_bf16 v[56:59], v[176:179], v[204:207], v[56:59]
  buffer_load_dwordx4 v11, s[52:55], s41 offen lds
  v_mfma_f32_16x16x32_bf16 v[72:75], v[168:171], v[208:211], v[72:75]
  ds_read_b64_tr_b16 v[232:233], v16 offset:8192
  ds_read_b64_tr_b16 v[234:235], v16 offset:9216
  v_mfma_f32_16x16x32_bf16 v[76:79], v[172:175], v[208:211], v[76:79]
  buffer_load_dwordx4 v12, s[52:55], s41 offen offset:1024 lds
  s_add_u32 s41, s41, 65536
  v_mfma_f32_16x16x32_bf16 v[80:83], v[176:179], v[208:211], v[80:83]
  v_mfma_f32_16x16x32_bf16 v[96:99], v[168:171], v[212:215], v[96:99]
  buffer_load_dwordx4 v[156:159], v10, s[16:19], s40 offen offset:0 sc1
  v_mfma_f32_16x16x32_bf16 v[100:103], v[172:175], v[212:215], v[100:103]
  v_mfma_f32_16x16x32_bf16 v[104:107], v[176:179], v[212:215], v[104:107]
  buffer_load_dwordx4 v[160:163], v10, s[16:19], s40 offen offset:256 sc1
  v_mfma_f32_16x16x32_bf16 v[120:123], v[168:171], v[216:219], v[120:123]
  v_mfma_f32_16x16x32_bf16 v[124:127], v[172:175], v[216:219], v[124:127]
  buffer_load_dwordx4 v[164:167], v10, s[16:19], s40 offen offset:1024 sc1
  v_mfma_f32_16x16x32_bf16 v[128:131], v[176:179], v[216:219], v[128:131]
  s_waitcnt lgkmcnt(0)
  v_mfma_f32_16x16x32_bf16 v[36:39], v[180:183], v[220:223], v[36:39]
  s_add_u32 m0, s42, 8192
  s_waitcnt vmcnt(13)
  v_mfma_f32_16x16x32_bf16 v[40:43], v[184:187], v[220:223], v[40:43]
  ds_read_b64_tr_b16 v[204:205], v13 offset:0
  ds_read_b64_tr_b16 v[206:207], v13 offset:1024
  v_mfma_f32_16x16x32_bf16 v[44:47], v[188:191], v[220:223], v[44:47]
  buffer_load_dwordx4 v11, s[52:55], s41 offen lds
  v_mfma_f32_16x16x32_bf16 v[60:63], v[180:183], v[224:227], v[60:63]
  ds_read_b64_tr_b16 v[208:209], v14 offset:0
  ds_read_b64_tr_b16 v[210:211], v14 offset:1024
  v_mfma_f32_16x16x32_bf16 v[64:67], v[184:187], v[224:227], v[64:67]
  buffer_load_dwordx4 v12, s[52:55], s41 offen offset:1024 lds
  s_add_u32 s41, s41, 65536
  v_mfma_f32_16x16x32_bf16 v[68:71], v[188:191], v[224:227], v[68:71]
  v_mfma_f32_16x16x32_bf16 v[84:87], v[180:183], v[228:231], v[84:87]
  buffer_load_dwordx4 v[168:171], v10, s[16:19], s40 offen offset:1280 sc1
  v_mfma_f32_16x16x32_bf16 v[88:91], v[184:187], v[228:231], v[88:91]
  v_mfma_f32_16x16x32_bf16 v[92:95], v[188:191], v[228:231], v[92:95]
  buffer_load_dwordx4 v[172:175], v10, s[16:19], s40 offen offset:2048 sc1
  v_mfma_f32_16x16x32_bf16 v[108:111], v[180:183], v[232:235], v[108:111]
  v_mfma_f32_16x16x32_bf16 v[112:115], v[184:187], v[232:235], v[112:115]
  buffer_load_dwordx4 v[176:179], v10, s[16:19], s40 offen offset:2304 sc1
  s_add_u32 s40, s40, 6144
  v_mfma_f32_16x16x32_bf16 v[116:119], v[188:191], v[232:235], v[116:119]
  v_mfma_f32_16x16x32_bf16 v[48:51], v[192:195], v[220:223], v[48:51]
  s_add_u32 m0, s42, 10240
  s_waitcnt vmcnt(15)
  v_mfma_f32_16x16x32_bf16 v[52:55], v[196:199], v[220:223], v[52:55]
  ds_read_b64_tr_b16 v[212:213], v15 offset:0
  ds_read_b64_tr_b16 v[214:215], v15 offset:1024
  v_mfma_f32_16x16x32_bf16 v[56:59], v[200:203], v[220:223], v[56:59]
  buffer_load_dwordx4 v11, s[52:55], s41 offen lds
  v_mfma_f32_16x16x32_bf16 v[72:75], v[192:195], v[224:227], v[72:75]
  ds_read_b64_tr_b16 v[216:217], v16 offset:0
  ds_read_b64_tr_b16 v[218:219], v16 offset:1024
  v_mfma_f32_16x16x32_bf16 v[76:79], v[196:199], v[224:227], v[76:79]
  buffer_load_dwordx4 v12, s[52:55], s41 offen offset:1024 lds
  s_add_u32 s41, s41, 65536
  v_mfma_f32_16x16x32_bf16 v[80:83], v[200:203], v[224:227], v[80:83]
  v_mfma_f32_16x16x32_bf16 v[96:99], v[192:195], v[228:231], v[96:99]
  buffer_load_dwordx4 v[180:183], v10, s[16:19], s40 offen offset:0 sc1
  v_mfma_f32_16x16x32_bf16 v[100:103], v[196:199], v[228:231], v[100:103]
  v_mfma_f32_16x16x32_bf16 v[104:107], v[200:203], v[228:231], v[104:107]
  buffer_load_dwordx4 v[184:187], v10, s[16:19], s40 offen offset:256 sc1
  v_mfma_f32_16x16x32_bf16 v[120:123], v[192:195], v[232:235], v[120:123]
  v_mfma_f32_16x16x32_bf16 v[124:127], v[196:199], v[232:235], v[124:127]
  buffer_load_dwordx4 v[188:191], v10, s[16:19], s40 offen offset:1024 sc1
  v_mfma_f32_16x16x32_bf16 v[128:131], v[200:203], v[232:235], v[128:131]
  s_waitcnt lgkmcnt(0)
  v_mfma_f32_16x16x32_bf16 v[36:39], v[132:135], v[204:207], v[36:39]
  s_add_u32 m0, s42, 0
  s_waitcnt vmcnt(13)
  v_mfma_f32_16x16x32_bf16 v[40:43], v[136:139], v[204:207], v[40:43]
  ds_read_b64_tr_b16 v[220:221], v13 offset:4096
  ds_read_b64_tr_b16 v[222:223], v13 offset:5120
  v_mfma_f32_16x16x32_bf16 v[44:47], v[140:143], v[204:207], v[44:47]
  buffer_load_dwordx4 v11, s[52:55], s41 offen lds
  v_mfma_f32_16x16x32_bf16 v[60:63], v[132:135], v[208:211], v[60:63]
  ds_read_b64_tr_b16 v[224:225], v14 offset:4096
  ds_read_b64_tr_b16 v[226:227], v14 offset:5120
  v_mfma_f32_16x16x32_bf16 v[64:67], v[136:139], v[208:211], v[64:67]
  buffer_load_dwordx4 v12, s[52:55], s41 offen offset:1024 lds
  s_add_u32 s41, s41, 65536
  v_mfma_f32_16x16x32_bf16 v[68:71], v[140:143], v[208:211], v[68:71]
  v_mfma_f32_16x16x32_bf16 v[84:87], v[132:135], v[212:215], v[84:87]
  buffer_load_dwordx4 v[192:195], v10, s[16:19], s40 offen offset:1280 sc1
  v_mfma_f32_16x16x32_bf16 v[88:91], v[136:139], v[212:215], v[88:91]
  v_mfma_f32_16x16x32_bf16 v[92:95], v[140:143], v[212:215], v[92:95]
  buffer_load_dwordx4 v[196:199], v10, s[16:19], s40 offen offset:2048 sc1
  v_mfma_f32_16x16x32_bf16 v[108:111], v[132:135], v[216:219], v[108:111]
  v_mfma_f32_16x16x32_bf16 v[112:115], v[136:139], v[216:219], v[112:115]
  buffer_load_dwordx4 v[200:203], v10, s[16:19], s40 offen offset:2304 sc1
  s_add_u32 s40, s40, 6144
  v_mfma_f32_16x16x32_bf16 v[116:119], v[140:143], v[216:219], v[116:119]
  v_mfma_f32_16x16x32_bf16 v[48:51], v[144:147], v[204:207], v[48:51]
  s_add_u32 m0, s42, 2048
  s_waitcnt vmcnt(15)
  v_mfma_f32_16x16x32_bf16 v[52:55], v[148:151], v[204:207], v[52:55]
  ds_read_b64_tr_b16 v[228:229], v15 offset:4096
  ds_read_b64_tr_b16 v[230:231], v15 offset:5120
  v_mfma_f32_16x16x32_bf16 v[56:59], v[152:155], v[204:207], v[56:59]
  buffer_load_dwordx4 v11, s[52:55], s41 offen lds
  v_mfma_f32_16x16x32_bf16 v[72:75], v[144:147], v[208:211], v[72:75]
  ds_read_b64_tr_b16 v[232:233], v16 offset:4096
  ds_read_b64_tr_b16 v[234:235], v16 offset:5120
  v_mfma_f32_16x16x32_bf16 v[76:79], v[148:151], v[208:211], v[76:79]
  buffer_load_dwordx4 v12, s[52:55], s41 offen offset:1024 lds
  s_add_u32 s41, s41, 65536
  v_mfma_f32_16x16x32_bf16 v[80:83], v[152:155], v[208:211], v[80:83]
  v_mfma_f32_16x16x32_bf16 v[96:99], v[144:147], v[212:215], v[96:99]
  buffer_load_dwordx4 v[132:135], v10, s[16:19], s40 offen offset:0 sc1
  v_mfma_f32_16x16x32_bf16 v[100:103], v[148:151], v[212:215], v[100:103]
  v_mfma_f32_16x16x32_bf16 v[104:107], v[152:155], v[212:215], v[104:107]
  buffer_load_dwordx4 v[136:139], v10, s[16:19], s40 offen offset:256 sc1
  v_mfma_f32_16x16x32_bf16 v[120:123], v[144:147], v[216:219], v[120:123]
  v_mfma_f32_16x16x32_bf16 v[124:127], v[148:151], v[216:219], v[124:127]
  buffer_load_dwordx4 v[140:143], v10, s[16:19], s40 offen offset:1024 sc1
  v_mfma_f32_16x16x32_bf16 v[128:131], v[152:155], v[216:219], v[128:131]
  s_waitcnt lgkmcnt(0)
  v_mfma_f32_16x16x32_bf16 v[36:39], v[156:159], v[220:223], v[36:39]
  s_add_u32 m0, s42, 4096
  s_waitcnt vmcnt(13)
  v_mfma_f32_16x16x32_bf16 v[40:43], v[160:163], v[220:223], v[40:43]
  ds_read_b64_tr_b16 v[204:205], v13 offset:8192
  ds_read_b64_tr_b16 v[206:207], v13 offset:9216
  v_mfma_f32_16x16x32_bf16 v[44:47], v[164:167], v[220:223], v[44:47]
  buffer_load_dwordx4 v11, s[52:55], s41 offen lds
  v_mfma_f32_16x16x32_bf16 v[60:63], v[156:159], v[224:227], v[60:63]
  ds_read_b64_tr_b16 v[208:209], v14 offset:8192
  ds_read_b64_tr_b16 v[210:211], v14 offset:9216
  v_mfma_f32_16x16x32_bf16 v[64:67], v[160:163], v[224:227], v[64:67]
  buffer_load_dwordx4 v12, s[52:55], s41 offen offset:1024 lds
  s_add_u32 s41, s41, 65536
  v_mfma_f32_16x16x32_bf16 v[68:71], v[164:167], v[224:227], v[68:71]
  v_mfma_f32_16x16x32_bf16 v[84:87], v[156:159], v[228:231], v[84:87]
  buffer_load_dwordx4 v[144:147], v10, s[16:19], s40 offen offset:1280 sc1
  v_mfma_f32_16x16x32_bf16 v[88:91], v[160:163], v[228:231], v[88:91]
  v_mfma_f32_16x16x32_bf16 v[92:95], v[164:167], v[228:231], v[92:95]
  buffer_load_dwordx4 v[148:151], v10, s[16:19], s40 offen offset:2048 sc1
  v_mfma_f32_16x16x32_bf16 v[108:111], v[156:159], v[232:235], v[108:111]
  v_mfma_f32_16x16x32_bf16 v[112:115], v[160:163], v[232:235], v[112:115]
  buffer_load_dwordx4 v[152:155], v10, s[16:19], s40 offen offset:2304 sc1
  s_add_u32 s40, s40, 6144
  v_mfma_f32_16x16x32_bf16 v[116:119], v[164:167], v[232:235], v[116:119]
  v_mfma_f32_16x16x32_bf16 v[48:51], v[168:171], v[220:223], v[48:51]
  s_add_u32 m0, s42, 6144
  s_waitcnt vmcnt(15)
  v_mfma_f32_16x16x32_bf16 v[52:55], v[172:175], v[220:223], v[52:55]
  ds_read_b64_tr_b16 v[212:213], v15 offset:8192
  ds_read_b64_tr_b16 v[214:215], v15 offset:9216
  v_mfma_f32_16x16x32_bf16 v[56:59], v[176:179], v[220:223], v[56:59]
  buffer_load_dwordx4 v11, s[52:55], s41 offen lds
  v_mfma_f32_16x16x32_bf16 v[72:75], v[168:171], v[224:227], v[72:75]
  ds_read_b64_tr_b16 v[216:217], v16 offset:8192
  ds_read_b64_tr_b16 v[218:219], v16 offset:9216
  v_mfma_f32_16x16x32_bf16 v[76:79], v[172:175], v[224:227], v[76:79]
  buffer_load_dwordx4 v12, s[52:55], s41 offen offset:1024 lds
  s_add_u32 s41, s41, 65536
  v_mfma_f32_16x16x32_bf16 v[80:83], v[176:179], v[224:227], v[80:83]
  v_mfma_f32_16x16x32_bf16 v[96:99], v[168:171], v[228:231], v[96:99]
  buffer_load_dwordx4 v[156:159], v10, s[16:19], s40 offen offset:0 sc1
  v_mfma_f32_16x16x32_bf16 v[100:103], v[172:175], v[228:231], v[100:103]
  v_mfma_f32_16x16x32_bf16 v[104:107], v[176:179], v[228:231], v[104:107]
  buffer_load_dwordx4 v[160:163], v10, s[16:19], s40 offen offset:256 sc1
  v_mfma_f32_16x16x32_bf16 v[120:123], v[168:171], v[232:235], v[120:123]
  v_mfma_f32_16x16x32_bf16 v[124:127], v[172:175], v[232:235], v[124:127]
  buffer_load_dwordx4 v[164:167], v10, s[16:19], s40 offen offset:1024 sc1
  v_mfma_f32_16x16x32_bf16 v[128:131], v[176:179], v[232:235], v[128:131]
.p2align 4
G2L_73:
  s_waitcnt lgkmcnt(0)
  v_mfma_f32_16x16x32_bf16 v[36:39], v[180:183], v[204:207], v[36:39]
  s_add_u32 m0, s42, 8192
  s_waitcnt vmcnt(13)
  v_mfma_f32_16x16x32_bf16 v[40:43], v[184:187], v[204:207], v[40:43]
  ds_read_b64_tr_b16 v[220:221], v13 offset:0
  ds_read_b64_tr_b16 v[222:223], v13 offset:1024
  v_mfma_f32_16x16x32_bf16 v[44:47], v[188:191], v[204:207], v[44:47]
  buffer_load_dwordx4 v11, s[52:55], s41 offen lds
  v_mfma_f32_16x16x32_bf16 v[60:63], v[180:183], v[208:211], v[60:63]
  ds_read_b64_tr_b16 v[224:225], v14 offset:0
  ds_read_b64_tr_b16 v[226:227], v14 offset:1024
  v_mfma_f32_16x16x32_bf16 v[64:67], v[184:187], v[208:211], v[64:67]
  buffer_load_dwordx4 v12, s[52:55], s41 offen offset:1024 lds
  s_add_u32 s41, s41, 65536
  v_mfma_f32_16x16x32_bf16 v[68:71], v[188:191], v[208:211], v[68:71]
  v_mfma_f32_16x16x32_bf16 v[84:87], v[180:183], v[212:215], v[84:87]
  buffer_load_dwordx4 v[168:171], v10, s[16:19], s40 offen offset:1280 sc1
  v_mfma_f32_16x16x32_bf16 v[88:91], v[184:187], v[212:215], v[88:91]
  v_mfma_f32_16x16x32_bf16 v[92:95], v[188:191], v[212:215], v[92:95]
  buffer_load_dwordx4 v[172:175], v10, s[16:19], s40 offen offset:2048 sc1
  v_mfma_f32_16x16x32_bf16 v[108:111], v[180:183], v[216:219], v[108:111]
  v_mfma_f32_16x16x32_bf16 v[112:115], v[184:187], v[216:219], v[112:115]
  buffer_load_dwordx4 v[176:179], v10, s[16:19], s40 offen offset:2304 sc1
  s_add_u32 s40, s40, 6144
  v_mfma_f32_16x16x32_bf16 v[116:119], v[188:191], v[216:219], v[116:119]
  v_mfma_f32_16x16x32_bf16 v[48:51], v[192:195], v[204:207], v[48:51]
  s_add_u32 m0, s42, 10240
  s_waitcnt vmcnt(15)
  v_mfma_f32_16x16x32_bf16 v[52:55], v[196:199], v[204:207], v[52:55]
  ds_read_b64_tr_b16 v[228:229], v15 offset:0
  ds_read_b64_tr_b16 v[230:231], v15 offset:1024
  v_mfma_f32_16x16x32_bf16 v[56:59], v[200:203], v[204:207], v[56:59]
  buffer_load_dwordx4 v11, s[52:55], s41 offen lds
  v_mfma_f32_16x16x32_bf16 v[72:75], v[192:195], v[208:211], v[72:75]
  ds_read_b64_tr_b16 v[232:233], v16 offset:0
  ds_read_b64_tr_b16 v[234:235], v16 offset:1024
  v_mfma_f32_16x16x32_bf16 v[76:79], v[196:199], v[208:211], v[76:79]
  buffer_load_dwordx4 v12, s[52:55], s41 offen offset:1024 lds
  s_add_u32 s41, s41, 65536
  v_mfma_f32_16x16x32_bf16 v[80:83], v[200:203], v[208:211], v[80:83]
  v_mfma_f32_16x16x32_bf16 v[96:99], v[192:195], v[212:215], v[96:99]
  buffer_load_dwordx4 v[180:183], v10, s[16:19], s40 offen offset:0 sc1
  v_mfma_f32_16x16x32_bf16 v[100:103], v[196:199], v[212:215], v[100:103]
  v_mfma_f32_16x16x32_bf16 v[104:107], v[200:203], v[212:215], v[104:107]
  buffer_load_dwordx4 v[184:187], v10, s[16:19], s40 offen offset:256 sc1
  v_mfma_f32_16x16x32_bf16 v[120:123], v[192:195], v[216:219], v[120:123]
  v_mfma_f32_16x16x32_bf16 v[124:127], v[196:199], v[216:219], v[124:127]
  buffer_load_dwordx4 v[188:191], v10, s[16:19], s40 offen offset:1024 sc1
  v_mfma_f32_16x16x32_bf16 v[128:131], v[200:203], v[216:219], v[128:131]
  s_waitcnt lgkmcnt(0)
  v_mfma_f32_16x16x32_bf16 v[36:39], v[132:135], v[220:223], v[36:39]
  s_add_u32 m0, s42, 0
  s_waitcnt vmcnt(13)
  v_mfma_f32_16x16x32_bf16 v[40:43], v[136:139], v[220:223], v[40:43]
  ds_read_b64_tr_b16 v[204:205], v13 offset:4096
  ds_read_b64_tr_b16 v[206:207], v13 offset:5120
  v_mfma_f32_16x16x32_bf16 v[44:47], v[140:143], v[220:223], v[44:47]
  buffer_load_dwordx4 v11, s[52:55], s41 offen lds
  v_mfma_f32_16x16x32_bf16 v[60:63], v[132:135], v[224:227], v[60:63]
  ds_read_b64_tr_b16 v[208:209], v14 offset:4096
  ds_read_b64_tr_b16 v[210:211], v14 offset:5120
  v_mfma_f32_16x16x32_bf16 v[64:67], v[136:139], v[224:227], v[64:67]
  buffer_load_dwordx4 v12, s[52:55], s41 offen offset:1024 lds
  s_add_u32 s41, s41, 65536
  v_mfma_f32_16x16x32_bf16 v[68:71], v[140:143], v[224:227], v[68:71]
  v_mfma_f32_16x16x32_bf16 v[84:87], v[132:135], v[228:231], v[84:87]
  buffer_load_dwordx4 v[192:195], v10, s[16:19], s40 offen offset:1280 sc1
  v_mfma_f32_16x16x32_bf16 v[88:91], v[136:139], v[228:231], v[88:91]
  v_mfma_f32_16x16x32_bf16 v[92:95], v[140:143], v[228:231], v[92:95]
  buffer_load_dwordx4 v[196:199], v10, s[16:19], s40 offen offset:2048 sc1
  v_mfma_f32_16x16x32_bf16 v[108:111], v[132:135], v[232:235], v[108:111]
  v_mfma_f32_16x16x32_bf16 v[112:115], v[136:139], v[232:235], v[112:115]
  buffer_load_dwordx4 v[200:203], v10, s[16:19], s40 offen offset:2304 sc1
  s_add_u32 s40, s40, 6144
  v_mfma_f32_16x16x32_bf16 v[116:119], v[140:143], v[232:235], v[116:119]
  v_mfma_f32_16x16x32_bf16 v[48:51], v[144:147], v[220:223], v[48:51]
  s_add_u32 m0, s42, 2048
  s_waitcnt vmcnt(15)
  v_mfma_f32_16x16x32_bf16 v[52:55], v[148:151], v[220:223], v[52:55]
  ds_read_b64_tr_b16 v[212:213], v15 offset:4096
  ds_read_b64_tr_b16 v[214:215], v15 offset:5120
  v_mfma_f32_16x16x32_bf16 v[56:59], v[152:155], v[220:223], v[56:59]
  buffer_load_dwordx4 v11, s[52:55], s41 offen lds
  v_mfma_f32_16x16x32_bf16 v[72:75], v[144:147], v[224:227], v[72:75]
  ds_read_b64_tr_b16 v[216:217], v16 offset:4096
  ds_read_b64_tr_b16 v[218:219], v16 offset:5120
  v_mfma_f32_16x16x32_bf16 v[76:79], v[148:151], v[224:227], v[76:79]
  buffer_load_dwordx4 v12, s[52:55], s41 offen offset:1024 lds
  s_add_u32 s41, s41, 65536
  v_mfma_f32_16x16x32_bf16 v[80:83], v[152:155], v[224:227], v[80:83]
  v_mfma_f32_16x16x32_bf16 v[96:99], v[144:147], v[228:231], v[96:99]
  buffer_load_dwordx4 v[132:135], v10, s[16:19], s40 offen offset:0 sc1
  v_mfma_f32_16x16x32_bf16 v[100:103], v[148:151], v[228:231], v[100:103]
  v_mfma_f32_16x16x32_bf16 v[104:107], v[152:155], v[228:231], v[104:107]
  buffer_load_dwordx4 v[136:139], v10, s[16:19], s40 offen offset:256 sc1
  v_mfma_f32_16x16x32_bf16 v[120:123], v[144:147], v[232:235], v[120:123]
  v_mfma_f32_16x16x32_bf16 v[124:127], v[148:151], v[232:235], v[124:127]
  buffer_load_dwordx4 v[140:143], v10, s[16:19], s40 offen offset:1024 sc1
  v_mfma_f32_16x16x32_bf16 v[128:131], v[152:155], v[232:235], v[128:131]
  s_waitcnt lgkmcnt(0)
  v_mfma_f32_16x16x32_bf16 v[36:39], v[156:159], v[204:207], v[36:39]
  s_add_u32 m0, s42, 4096
  s_waitcnt vmcnt(13)
  v_mfma_f32_16x16x32_bf16 v[40:43], v[160:163], v[204:207], v[40:43]
  ds_read_b64_tr_b16 v[220:221], v13 offset:8192
  ds_read_b64_tr_b16 v[222:223], v13 offset:9216
  v_mfma_f32_16x16x32_bf16 v[44:47], v[164:167], v[204:207], v[44:47]
  buffer_load_dwordx4 v11, s[52:55], s41 offen lds
  v_mfma_f32_16x16x32_bf16 v[60:63], v[156:159], v[208:211], v[60:63]
  ds_read_b64_tr_b16 v[224:225], v14 offset:8192
  ds_read_b64_tr_b16 v[226:227], v14 offset:9216
  v_mfma_f32_16x16x32_bf16 v[64:67], v[160:163], v[208:211], v[64:67]
  buffer_load_dwordx4 v12, s[52:55], s41 offen offset:1024 lds
  s_add_u32 s41, s41, 65536
  v_mfma_f32_16x16x32_bf16 v[68:71], v[164:167], v[208:211], v[68:71]
  v_mfma_f32_16x16x32_bf16 v[84:87], v[156:159], v[212:215], v[84:87]
  buffer_load_dwordx4 v[144:147], v10, s[16:19], s40 offen offset:1280 sc1
  v_mfma_f32_16x16x32_bf16 v[88:91], v[160:163], v[212:215], v[88:91]
  v_mfma_f32_16x16x32_bf16 v[92:95], v[164:167], v[212:215], v[92:95]
  buffer_load_dwordx4 v[148:151], v10, s[16:19], s40 offen offset:2048 sc1
  v_mfma_f32_16x16x32_bf16 v[108:111], v[156:159], v[216:219], v[108:111]
  v_mfma_f32_16x16x32_bf16 v[112:115], v[160:163], v[216:219], v[112:115]
  buffer_load_dwordx4 v[152:155], v10, s[16:19], s40 offen offset:2304 sc1
  s_add_u32 s40, s40, 6144
  v_mfma_f32_16x16x32_bf16 v[116:119], v[164:167], v[216:219], v[116:119]
  v_mfma_f32_16x16x32_bf16 v[48:51], v[168:171], v[204:207], v[48:51]
  s_add_u32 m0, s42, 6144
  s_waitcnt vmcnt(15)
  v_mfma_f32_16x16x32_bf16 v[52:55], v[172:175], v[204:207], v[52:55]
  ds_read_b64_tr_b16 v[228:229], v15 offset:8192
  ds_read_b64_tr_b16 v[230:231], v15 offset:9216
  v_mfma_f32_16x16x32_bf16 v[56:59], v[176:179], v[204:207], v[56:59]
  buffer_load_dwordx4 v11, s[52:55], s41 offen lds
  v_mfma_f32_16x16x32_bf16 v[72:75], v[168:171], v[208:211], v[72:75]
  ds_read_b64_tr_b16 v[232:233], v16 offset:8192
  ds_read_b64_tr_b16 v[234:235], v16 offset:9216
  v_mfma_f32_16x16x32_bf16 v[76:79], v[172:175], v[208:211], v[76:79]
  buffer_load_dwordx4 v12, s[52:55], s41 offen offset:1024 lds
  s_add_u32 s41, s41, 65536
  v_mfma_f32_16x16x32_bf16 v[80:83], v[176:179], v[208:211], v[80:83]
  v_mfma_f32_16x16x32_bf16 v[96:99], v[168:171], v[212:215], v[96:99]
  buffer_load_dwordx4 v[156:159], v10, s[16:19], s40 offen offset:0 sc1
  v_mfma_f32_16x16x32_bf16 v[100:103], v[172:175], v[212:215], v[100:103]
  v_mfma_f32_16x16x32_bf16 v[104:107], v[176:179], v[212:215], v[104:107]
  buffer_load_dwordx4 v[160:163], v10, s[16:19], s40 offen offset:256 sc1
  v_mfma_f32_16x16x32_bf16 v[120:123], v[168:171], v[216:219], v[120:123]
  v_mfma_f32_16x16x32_bf16 v[124:127], v[172:175], v[216:219], v[124:127]
  buffer_load_dwordx4 v[164:167], v10, s[16:19], s40 offen offset:1024 sc1
  v_mfma_f32_16x16x32_bf16 v[128:131], v[176:179], v[216:219], v[128:131]
  s_waitcnt lgkmcnt(0)
  v_mfma_f32_16x16x32_bf16 v[36:39], v[180:183], v[220:223], v[36:39]
  s_add_u32 m0, s42, 8192
  s_waitcnt vmcnt(13)
  v_mfma_f32_16x16x32_bf16 v[40:43], v[184:187], v[220:223], v[40:43]
  ds_read_b64_tr_b16 v[204:205], v13 offset:0
  ds_read_b64_tr_b16 v[206:207], v13 offset:1024
  v_mfma_f32_16x16x32_bf16 v[44:47], v[188:191], v[220:223], v[44:47]
  buffer_load_dwordx4 v11, s[52:55], s41 offen lds
  v_mfma_f32_16x16x32_bf16 v[60:63], v[180:183], v[224:227], v[60:63]
  ds_read_b64_tr_b16 v[208:209], v14 offset:0
  ds_read_b64_tr_b16 v[210:211], v14 offset:1024
  v_mfma_f32_16x16x32_bf16 v[64:67], v[184:187], v[224:227], v[64:67]
  buffer_load_dwordx4 v12, s[52:55], s41 offen offset:1024 lds
  s_add_u32 s41, s41, 65536
  v_mfma_f32_16x16x32_bf16 v[68:71], v[188:191], v[224:227], v[68:71]
  v_mfma_f32_16x16x32_bf16 v[84:87], v[180:183], v[228:231], v[84:87]
  buffer_load_dwordx4 v[168:171], v10, s[16:19], s40 offen offset:1280 sc1
  v_mfma_f32_16x16x32_bf16 v[88:91], v[184:187], v[228:231], v[88:91]
  v_mfma_f32_16x16x32_bf16 v[92:95], v[188:191], v[228:231], v[92:95]
  buffer_load_dwordx4 v[172:175], v10, s[16:19], s40 offen offset:2048 sc1
  v_mfma_f32_16x16x32_bf16 v[108:111], v[180:183], v[232:235], v[108:111]
  v_mfma_f32_16x16x32_bf16 v[112:115], v[184:187], v[232:235], v[112:115]
  buffer_load_dwordx4 v[176:179], v10, s[16:19], s40 offen offset:2304 sc1
  s_add_u32 s40, s40, 6144
  v_mfma_f32_16x16x32_bf16 v[116:119], v[188:191], v[232:235], v[116:119]
  v_mfma_f32_16x16x32_bf16 v[48:51], v[192:195], v[220:223], v[48:51]
  s_add_u32 m0, s42, 10240
  s_waitcnt vmcnt(15)
  v_mfma_f32_16x16x32_bf16 v[52:55], v[196:199], v[220:223], v[52:55]
  ds_read_b64_tr_b16 v[212:213], v15 offset:0
  ds_read_b64_tr_b16 v[214:215], v15 offset:1024
  v_mfma_f32_16x16x32_bf16 v[56:59], v[200:203], v[220:223], v[56:59]
  buffer_load_dwordx4 v11, s[52:55], s41 offen lds
  v_mfma_f32_16x16x32_bf16 v[72:75], v[192:195], v[224:227], v[72:75]
  ds_read_b64_tr_b16 v[216:217], v16 offset:0
  ds_read_b64_tr_b16 v[218:219], v16 offset:1024
  v_mfma_f32_16x16x32_bf16 v[76:79], v[196:199], v[224:227], v[76:79]
  buffer_load_dwordx4 v12, s[52:55], s41 offen offset:1024 lds
  s_add_u32 s41, s41, 65536
  v_mfma_f32_16x16x32_bf16 v[80:83], v[200:203], v[224:227], v[80:83]
  v_mfma_f32_16x16x32_bf16 v[96:99], v[192:195], v[228:231], v[96:99]
  buffer_load_dwordx4 v[180:183], v10, s[16:19], s40 offen offset:0 sc1
  v_mfma_f32_16x16x32_bf16 v[100:103], v[196:199], v[228:231], v[100:103]
  v_mfma_f32_16x16x32_bf16 v[104:107], v[200:203], v[228:231], v[104:107]
  buffer_load_dwordx4 v[184:187], v10, s[16:19], s40 offen offset:256 sc1
  v_mfma_f32_16x16x32_bf16 v[120:123], v[192:195], v[232:235], v[120:123]
  v_mfma_f32_16x16x32_bf16 v[124:127], v[196:199], v[232:235], v[124:127]
  buffer_load_dwordx4 v[188:191], v10, s[16:19], s40 offen offset:1024 sc1
  v_mfma_f32_16x16x32_bf16 v[128:131], v[200:203], v[232:235], v[128:131]
  s_waitcnt lgkmcnt(0)
  v_mfma_f32_16x16x32_bf16 v[36:39], v[132:135], v[204:207], v[36:39]
  s_add_u32 m0, s42, 0
  s_waitcnt vmcnt(13)
  v_mfma_f32_16x16x32_bf16 v[40:43], v[136:139], v[204:207], v[40:43]
  ds_read_b64_tr_b16 v[220:221], v13 offset:4096
  ds_read_b64_tr_b16 v[222:223], v13 offset:5120
  v_mfma_f32_16x16x32_bf16 v[44:47], v[140:143], v[204:207], v[44:47]
  buffer_load_dwordx4 v11, s[52:55], s41 offen lds
  v_mfma_f32_16x16x32_bf16 v[60:63], v[132:135], v[208:211], v[60:63]
  ds_read_b64_tr_b16 v[224:225], v14 offset:4096
  ds_read_b64_tr_b16 v[226:227], v14 offset:5120
  v_mfma_f32_16x16x32_bf16 v[64:67], v[136:139], v[208:211], v[64:67]
  buffer_load_dwordx4 v12, s[52:55], s41 offen offset:1024 lds
  s_add_u32 s41, s41, 65536
  v_mfma_f32_16x16x32_bf16 v[68:71], v[140:143], v[208:211], v[68:71]
  v_mfma_f32_16x16x32_bf16 v[84:87], v[132:135], v[212:215], v[84:87]
  buffer_load_dwordx4 v[192:195], v10, s[16:19], s40 offen offset:1280 sc1
  v_mfma_f32_16x16x32_bf16 v[88:91], v[136:139], v[212:215], v[88:91]
  v_mfma_f32_16x16x32_bf16 v[92:95], v[140:143], v[212:215], v[92:95]
  buffer_load_dwordx4 v[196:199], v10, s[16:19], s40 offen offset:2048 sc1
  v_mfma_f32_16x16x32_bf16 v[108:111], v[132:135], v[216:219], v[108:111]
  v_mfma_f32_16x16x32_bf16 v[112:115], v[136:139], v[216:219], v[112:115]
  buffer_load_dwordx4 v[200:203], v10, s[16:19], s40 offen offset:2304 sc1
  s_add_u32 s40, s40, 6144
  v_mfma_f32_16x16x32_bf16 v[116:119], v[140:143], v[216:219], v[116:119]
  v_mfma_f32_16x16x32_bf16 v[48:51], v[144:147], v[204:207], v[48:51]
  s_add_u32 m0, s42, 2048
  s_waitcnt vmcnt(15)
  v_mfma_f32_16x16x32_bf16 v[52:55], v[148:151], v[204:207], v[52:55]
  ds_read_b64_tr_b16 v[228:229], v15 offset:4096
  ds_read_b64_tr_b16 v[230:231], v15 offset:5120
  v_mfma_f32_16x16x32_bf16 v[56:59], v[152:155], v[204:207], v[56:59]
  buffer_load_dwordx4 v11, s[52:55], s41 offen lds
  v_mfma_f32_16x16x32_bf16 v[72:75], v[144:147], v[208:211], v[72:75]
  ds_read_b64_tr_b16 v[232:233], v16 offset:4096
  ds_read_b64_tr_b16 v[234:235], v16 offset:5120
  v_mfma_f32_16x16x32_bf16 v[76:79], v[148:151], v[208:211], v[76:79]
  buffer_load_dwordx4 v12, s[52:55], s41 offen offset:1024 lds
  s_add_u32 s41, s41, 65536
  v_mfma_f32_16x16x32_bf16 v[80:83], v[152:155], v[208:211], v[80:83]
  v_mfma_f32_16x16x32_bf16 v[96:99], v[144:147], v[212:215], v[96:99]
  buffer_load_dwordx4 v[132:135], v10, s[16:19], s40 offen offset:0 sc1
  v_mfma_f32_16x16x32_bf16 v[100:103], v[148:151], v[212:215], v[100:103]
  v_mfma_f32_16x16x32_bf16 v[104:107], v[152:155], v[212:215], v[104:107]
  buffer_load_dwordx4 v[136:139], v10, s[16:19], s40 offen offset:256 sc1
  v_mfma_f32_16x16x32_bf16 v[120:123], v[144:147], v[216:219], v[120:123]
  v_mfma_f32_16x16x32_bf16 v[124:127], v[148:151], v[216:219], v[124:127]
  buffer_load_dwordx4 v[140:143], v10, s[16:19], s40 offen offset:1024 sc1
  v_mfma_f32_16x16x32_bf16 v[128:131], v[152:155], v[216:219], v[128:131]
  s_waitcnt lgkmcnt(0)
  v_mfma_f32_16x16x32_bf16 v[36:39], v[156:159], v[220:223], v[36:39]
  s_add_u32 m0, s42, 4096
  s_waitcnt vmcnt(13)
  v_mfma_f32_16x16x32_bf16 v[40:43], v[160:163], v[220:223], v[40:43]
  ds_read_b64_tr_b16 v[204:205], v13 offset:8192
  ds_read_b64_tr_b16 v[206:207], v13 offset:9216
  v_mfma_f32_16x16x32_bf16 v[44:47], v[164:167], v[220:223], v[44:47]
  buffer_load_dwordx4 v11, s[52:55], s41 offen lds
  v_mfma_f32_16x16x32_bf16 v[60:63], v[156:159], v[224:227], v[60:63]
  ds_read_b64_tr_b16 v[208:209], v14 offset:8192
  ds_read_b64_tr_b16 v[210:211], v14 offset:9216
  v_mfma_f32_16x16x32_bf16 v[64:67], v[160:163], v[224:227], v[64:67]
  buffer_load_dwordx4 v12, s[52:55], s41 offen offset:1024 lds
  s_add_u32 s41, s41, 65536
  v_mfma_f32_16x16x32_bf16 v[68:71], v[164:167], v[224:227], v[68:71]
  v_mfma_f32_16x16x32_bf16 v[84:87], v[156:159], v[228:231], v[84:87]
  buffer_load_dwordx4 v[144:147], v10, s[16:19], s40 offen offset:1280 sc1
  v_mfma_f32_16x16x32_bf16 v[88:91], v[160:163], v[228:231], v[88:91]
  v_mfma_f32_16x16x32_bf16 v[92:95], v[164:167], v[228:231], v[92:95]
  buffer_load_dwordx4 v[148:151], v10, s[16:19], s40 offen offset:2048 sc1
  v_mfma_f32_16x16x32_bf16 v[108:111], v[156:159], v[232:235], v[108:111]
  v_mfma_f32_16x16x32_bf16 v[112:115], v[160:163], v[232:235], v[112:115]
  buffer_load_dwordx4 v[152:155], v10, s[16:19], s40 offen offset:2304 sc1
  s_add_u32 s40, s40, 6144
  v_mfma_f32_16x16x32_bf16 v[116:119], v[164:167], v[232:235], v[116:119]
  v_mfma_f32_16x16x32_bf16 v[48:51], v[168:171], v[220:223], v[48:51]
  s_add_u32 m0, s42, 6144
  s_waitcnt vmcnt(15)
  v_mfma_f32_16x16x32_bf16 v[52:55], v[172:175], v[220:223], v[52:55]
  ds_read_b64_tr_b16 v[212:213], v15 offset:8192
  ds_read_b64_tr_b16 v[214:215], v15 offset:9216
  v_mfma_f32_16x16x32_bf16 v[56:59], v[176:179], v[220:223], v[56:59]
  buffer_load_dwordx4 v11, s[52:55], s41 offen lds
  v_mfma_f32_16x16x32_bf16 v[72:75], v[168:171], v[224:227], v[72:75]
  ds_read_b64_tr_b16 v[216:217], v16 offset:8192
  ds_read_b64_tr_b16 v[218:219], v16 offset:9216
  v_mfma_f32_16x16x32_bf16 v[76:79], v[172:175], v[224:227], v[76:79]
  buffer_load_dwordx4 v12, s[52:55], s41 offen offset:1024 lds
  s_add_u32 s41, s41, 65536
  v_mfma_f32_16x16x32_bf16 v[80:83], v[176:179], v[224:227], v[80:83]
  v_mfma_f32_16x16x32_bf16 v[96:99], v[168:171], v[228:231], v[96:99]
  buffer_load_dwordx4 v[156:159], v10, s[16:19], s40 offen offset:0 sc1
  v_mfma_f32_16x16x32_bf16 v[100:103], v[172:175], v[228:231], v[100:103]
  v_mfma_f32_16x16x32_bf16 v[104:107], v[176:179], v[228:231], v[104:107]
  buffer_load_dwordx4 v[160:163], v10, s[16:19], s40 offen offset:256 sc1
  v_mfma_f32_16x16x32_bf16 v[120:123], v[168:171], v[232:235], v[120:123]
  v_mfma_f32_16x16x32_bf16 v[124:127], v[172:175], v[232:235], v[124:127]
  buffer_load_dwordx4 v[164:167], v10, s[16:19], s40 offen offset:1024 sc1
  v_mfma_f32_16x16x32_bf16 v[128:131], v[176:179], v[232:235], v[128:131]
  s_sub_u32 s33, s33, 1
  s_cmp_lg_u32 s33, 0
  s_cbranch_scc1 G2L_73
  s_cmp_ge_u32 s2, 192
  s_cbranch_scc1 G2XT_74
  s_waitcnt lgkmcnt(0)
  v_mfma_f32_16x16x32_bf16 v[36:39], v[180:183], v[204:207], v[36:39]
  s_add_u32 m0, s42, 8192
  s_waitcnt vmcnt(13)
  v_mfma_f32_16x16x32_bf16 v[40:43], v[184:187], v[204:207], v[40:43]
  ds_read_b64_tr_b16 v[220:221], v13 offset:0
  ds_read_b64_tr_b16 v[222:223], v13 offset:1024
  v_mfma_f32_16x16x32_bf16 v[44:47], v[188:191], v[204:207], v[44:47]
  buffer_load_dwordx4 v11, s[52:55], s41 offen lds
  v_mfma_f32_16x16x32_bf16 v[60:63], v[180:183], v[208:211], v[60:63]
  ds_read_b64_tr_b16 v[224:225], v14 offset:0
  ds_read_b64_tr_b16 v[226:227], v14 offset:1024
  v_mfma_f32_16x16x32_bf16 v[64:67], v[184:187], v[208:211], v[64:67]
  buffer_load_dwordx4 v12, s[52:55], s41 offen offset:1024 lds
  s_add_u32 s41, s41, 65536
  v_mfma_f32_16x16x32_bf16 v[68:71], v[188:191], v[208:211], v[68:71]
  v_mfma_f32_16x16x32_bf16 v[84:87], v[180:183], v[212:215], v[84:87]
  buffer_load_dwordx4 v[168:171], v10, s[16:19], s40 offen offset:1280 sc1
  v_mfma_f32_16x16x32_bf16 v[88:91], v[184:187], v[212:215], v[88:91]
  v_mfma_f32_16x16x32_bf16 v[92:95], v[188:191], v[212:215], v[92:95]
  buffer_load_dwordx4 v[172:175], v10, s[16:19], s40 offen offset:2048 sc1
  v_mfma_f32_16x16x32_bf16 v[108:111], v[180:183], v[216:219], v[108:111]
  v_mfma_f32_16x16x32_bf16 v[112:115], v[184:187], v[216:219], v[112:115]
  buffer_load_dwordx4 v[176:179], v10, s[16:19], s40 offen offset:2304 sc1
  s_add_u32 s40, s40, 6144
  v_mfma_f32_16x16x32_bf16 v[116:119], v[188:191], v[216:219], v[116:119]
  v_mfma_f32_16x16x32_bf16 v[48:51], v[192:195], v[204:207], v[48:51]
  s_add_u32 m0, s42, 10240
  s_waitcnt vmcnt(15)
  v_mfma_f32_16x16x32_bf16 v[52:55], v[196:199], v[204:207], v[52:55]
  ds_read_b64_tr_b16 v[228:229], v15 offset:0
  ds_read_b64_tr_b16 v[230:231], v15 offset:1024
  v_mfma_f32_16x16x32_bf16 v[56:59], v[200:203], v[204:207], v[56:59]
  buffer_load_dwordx4 v11, s[52:55], s41 offen lds
  v_mfma_f32_16x16x32_bf16 v[72:75], v[192:195], v[208:211], v[72:75]
  ds_read_b64_tr_b16 v[232:233], v16 offset:0
  ds_read_b64_tr_b16 v[234:235], v16 offset:1024
  v_mfma_f32_16x16x32_bf16 v[76:79], v[196:199], v[208:211], v[76:79]
  buffer_load_dwordx4 v12, s[52:55], s41 offen offset:1024 lds
  s_add_u32 s41, s41, 65536
  v_mfma_f32_16x16x32_bf16 v[80:83], v[200:203], v[208:211], v[80:83]
  v_mfma_f32_16x16x32_bf16 v[96:99], v[192:195], v[212:215], v[96:99]
  buffer_load_dwordx4 v[180:183], v10, s[16:19], s40 offen offset:0 sc1
  v_mfma_f32_16x16x32_bf16 v[100:103], v[196:199], v[212:215], v[100:103]
  v_mfma_f32_16x16x32_bf16 v[104:107], v[200:203], v[212:215], v[104:107]
  buffer_load_dwordx4 v[184:187], v10, s[16:19], s40 offen offset:256 sc1
  v_mfma_f32_16x16x32_bf16 v[120:123], v[192:195], v[216:219], v[120:123]
  v_mfma_f32_16x16x32_bf16 v[124:127], v[196:199], v[216:219], v[124:127]
  buffer_load_dwordx4 v[188:191], v10, s[16:19], s40 offen offset:1024 sc1
  v_mfma_f32_16x16x32_bf16 v[128:131], v[200:203], v[216:219], v[128:131]
  s_waitcnt lgkmcnt(0)
  v_mfma_f32_16x16x32_bf16 v[36:39], v[132:135], v[220:223], v[36:39]
  s_waitcnt vmcnt(13)
  v_mfma_f32_16x16x32_bf16 v[40:43], v[136:139], v[220:223], v[40:43]
  ds_read_b64_tr_b16 v[204:205], v13 offset:4096
  ds_read_b64_tr_b16 v[206:207], v13 offset:5120
  v_mfma_f32_16x16x32_bf16 v[44:47], v[140:143], v[220:223], v[44:47]
  v_mfma_f32_16x16x32_bf16 v[60:63], v[132:135], v[224:227], v[60:63]
  ds_read_b64_tr_b16 v[208:209], v14 offset:4096
  ds_read_b64_tr_b16 v[210:211], v14 offset:5120
  v_mfma_f32_16x16x32_bf16 v[64:67], v[136:139], v[224:227], v[64:67]
  v_mfma_f32_16x16x32_bf16 v[68:71], v[140:143], v[224:227], v[68:71]
  s_add_u32 m0, s42, 12288
  s_nop 0
  buffer_load_dwordx4 v26, s[56:59], s37 offen offset:0 lds
  buffer_load_dwordx4 v27, s[56:59], s37 offen offset:1024 lds
  buffer_load_dwordx4 v28, s[56:59], s37 offen offset:2048 lds
  s_add_u32 s37, s37, 20736
  v_mfma_f32_16x16x32_bf16 v[84:87], v[132:135], v[228:231], v[84:87]
  buffer_load_dwordx4 v[192:195], v10, s[16:19], s40 offen offset:1280 sc1
  v_mfma_f32_16x16x32_bf16 v[88:91], v[136:139], v[228:231], v[88:91]
  s_add_u32 m0, s42, 15360
  s_nop 0
  buffer_load_dwordx4 v26, s[56:59], s37 offen offset:0 lds
  buffer_load_dwordx4 v27, s[56:59], s37 offen offset:1024 lds
  buffer_load_dwordx4 v28, s[56:59], s37 offen offset:2048 lds
  s_add_u32 s37, s37, 20736
  v_mfma_f32_16x16x32_bf16 v[92:95], v[140:143], v[228:231], v[92:95]
  buffer_load_dwordx4 v[196:199], v10, s[16:19], s40 offen offset:2048 sc1
  v_mfma_f32_16x16x32_bf16 v[108:111], v[132:135], v[232:235], v[108:111]
  v_mfma_f32_16x16x32_bf16 v[112:115], v[136:139], v[232:235], v[112:115]
  buffer_load_dwordx4 v[200:203], v10, s[16:19], s40 offen offset:2304 sc1
  s_add_u32 s40, s40, 6144
  v_mfma_f32_16x16x32_bf16 v[116:119], v[140:143], v[232:235], v[116:119]
  v_mfma_f32_16x16x32_bf16 v[48:51], v[144:147], v[220:223], v[48:51]
  s_waitcnt vmcnt(19)
  v_mfma_f32_16x16x32_bf16 v[52:55], v[148:151], v[220:223], v[52:55]
  ds_read_b64_tr_b16 v[212:213], v15 offset:4096
  ds_read_b64_tr_b16 v[214:215], v15 offset:5120
  v_mfma_f32_16x16x32_bf16 v[56:59], v[152:155], v[220:223], v[56:59]
  v_mfma_f32_16x16x32_bf16 v[72:75], v[144:147], v[224:227], v[72:75]
  ds_read_b64_tr_b16 v[216:217], v16 offset:4096
  ds_read_b64_tr_b16 v[218:219], v16 offset:5120
  v_mfma_f32_16x16x32_bf16 v[76:79], v[148:151], v[224:227], v[76:79]
  v_mfma_f32_16x16x32_bf16 v[80:83], v[152:155], v[224:227], v[80:83]
  buffer_load_dword v25, v24, s[16:19], 0 offen offset:128 sc1
  v_mfma_f32_16x16x32_bf16 v[96:99], v[144:147], v[228:231], v[96:99]
  v_mfma_f32_16x16x32_bf16 v[100:103], v[148:151], v[228:231], v[100:103]
  v_mfma_f32_16x16x32_bf16 v[104:107], v[152:155], v[228:231], v[104:107]
  v_mfma_f32_16x16x32_bf16 v[120:123], v[144:147], v[232:235], v[120:123]
  v_mfma_f32_16x16x32_bf16 v[124:127], v[148:151], v[232:235], v[124:127]
  v_mfma_f32_16x16x32_bf16 v[128:131], v[152:155], v[232:235], v[128:131]
  s_waitcnt lgkmcnt(0)
  v_mfma_f32_16x16x32_bf16 v[36:39], v[156:159], v[204:207], v[36:39]
  s_waitcnt vmcnt(13)
  v_mfma_f32_16x16x32_bf16 v[40:43], v[160:163], v[204:207], v[40:43]
  ds_read_b64_tr_b16 v[220:221], v13 offset:8192
  ds_read_b64_tr_b16 v[222:223], v13 offset:9216
  v_mfma_f32_16x16x32_bf16 v[44:47], v[164:167], v[204:207], v[44:47]
  v_mfma_f32_16x16x32_bf16 v[60:63], v[156:159], v[208:211], v[60:63]
  ds_read_b64_tr_b16 v[224:225], v14 offset:8192
  ds_read_b64_tr_b16 v[226:227], v14 offset:9216
  v_mfma_f32_16x16x32_bf16 v[64:67], v[160:163], v[208:211], v[64:67]
  v_mfma_f32_16x16x32_bf16 v[68:71], v[164:167], v[208:211], v[68:71]
  s_add_u32 m0, s42, 0
  s_nop 0
  buffer_load_dwordx4 v26, s[56:59], s37 offen offset:0 lds
  buffer_load_dwordx4 v27, s[56:59], s37 offen offset:1024 lds
  buffer_load_dwordx4 v28, s[56:59], s37 offen offset:2048 lds
  s_add_u32 s37, s37, 20736
  v_mfma_f32_16x16x32_bf16 v[84:87], v[156:159], v[212:215], v[84:87]
  v_mfma_f32_16x16x32_bf16 v[88:91], v[160:163], v[212:215], v[88:91]
  s_add_u32 m0, s42, 3072
  s_nop 0
  buffer_load_dwordx4 v26, s[56:59], s37 offen offset:0 lds
  buffer_load_dwordx4 v27, s[56:59], s37 offen offset:1024 lds
  buffer_load_dwordx4 v28, s[56:59], s37 offen offset:2048 lds
  s_add_u32 s37, s37, 20736
  v_mfma_f32_16x16x32_bf16 v[92:95], v[164:167], v[212:215], v[92:95]
  v_mfma_f32_16x16x32_bf16 v[108:111], v[156:159], v[216:219], v[108:111]
  v_mfma_f32_16x16x32_bf16 v[112:115], v[160:163], v[216:219], v[112:115]
  v_mfma_f32_16x16x32_bf16 v[116:119], v[164:167], v[216:219], v[116:119]
  v_mfma_f32_16x16x32_bf16 v[48:51], v[168:171], v[204:207], v[48:51]
  s_waitcnt vmcnt(16)
  v_mfma_f32_16x16x32_bf16 v[52:55], v[172:175], v[204:207], v[52:55]
  ds_read_b64_tr_b16 v[228:229], v15 offset:8192
  ds_read_b64_tr_b16 v[230:231], v15 offset:9216
  v_mfma_f32_16x16x32_bf16 v[56:59], v[176:179], v[204:207], v[56:59]
  v_mfma_f32_16x16x32_bf16 v[72:75], v[168:171], v[208:211], v[72:75]
  ds_read_b64_tr_b16 v[232:233], v16 offset:8192
  ds_read_b64_tr_b16 v[234:235], v16 offset:9216
  v_mfma_f32_16x16x32_bf16 v[76:79], v[172:175], v[208:211], v[76:79]
  v_mfma_f32_16x16x32_bf16 v[80:83], v[176:179], v[208:211], v[80:83]
  v_mfma_f32_16x16x32_bf16 v[96:99], v[168:171], v[212:215], v[96:99]
  v_mfma_f32_16x16x32_bf16 v[100:103], v[172:175], v[212:215], v[100:103]
  v_mfma_f32_16x16x32_bf16 v[104:107], v[176:179], v[212:215], v[104:107]
  v_mfma_f32_16x16x32_bf16 v[120:123], v[168:171], v[216:219], v[120:123]
  v_mfma_f32_16x16x32_bf16 v[124:127], v[172:175], v[216:219], v[124:127]
  v_mfma_f32_16x16x32_bf16 v[128:131], v[176:179], v[216:219], v[128:131]
  s_waitcnt lgkmcnt(0)
  v_mfma_f32_16x16x32_bf16 v[36:39], v[180:183], v[220:223], v[36:39]
  s_waitcnt vmcnt(7)
  v_mfma_f32_16x16x32_bf16 v[40:43], v[184:187], v[220:223], v[40:43]
  v_mfma_f32_16x16x32_bf16 v[44:47], v[188:191], v[220:223], v[44:47]
  v_mfma_f32_16x16x32_bf16 v[60:63], v[180:183], v[224:227], v[60:63]
  v_mfma_f32_16x16x32_bf16 v[64:67], v[184:187], v[224:227], v[64:67]
  v_mfma_f32_16x16x32_bf16 v[68:71], v[188:191], v[224:227], v[68:71]
  s_add_u32 m0, s42, 6144
  s_nop 0
  buffer_load_dwordx4 v26, s[56:59], s37 offen offset:0 lds
  buffer_load_dwordx4 v27, s[56:59], s37 offen offset:1024 lds
  buffer_load_dwordx4 v28, s[56:59], s37 offen offset:2048 lds
  s_add_u32 s37, s37, 20736
  s_add_u32 m0, s42, 9216
  s_nop 0
  buffer_load_dwordx4 v26, s[56:59], s37 offen offset:0 lds
  buffer_load_dwordx4 v27, s[56:59], s37 offen offset:1024 lds
  buffer_load_dwordx4 v28, s[56:59], s37 offen offset:2048 lds
  s_add_u32 s37, s37, 20736
  v_mfma_f32_16x16x32_bf16 v[84:87], v[180:183], v[228:231], v[84:87]
  v_mfma_f32_16x16x32_bf16 v[88:91], v[184:187], v[228:231], v[88:91]
  s_waitcnt vmcnt(12)
  v_cmp_ne_u32 vcc, 1, v25
  s_nop 4
  s_cbranch_vccnz G2SLOW_75
G2BACK_76:
  buffer_load_dword v19, v18, s[16:19], 0 offen sc1
  v_xor_b32 v6, 128, v18
  buffer_load_dword v20, v6, s[16:19], 0 offen sc1
  v_xor_b32 v7, 256, v18
  buffer_load_dword v21, v7, s[16:19], 0 offen sc1
  v_xor_b32 v8, 384, v18
  buffer_load_dword v22, v8, s[16:19], 0 offen sc1
  v_mfma_f32_16x16x32_bf16 v[92:95], v[188:191], v[228:231], v[92:95]
  v_mfma_f32_16x16x32_bf16 v[108:111], v[180:183], v[232:235], v[108:111]
  buffer_load_dwordx4 v[236:239], v33, s[16:19], s35 offen offset:0 sc1
  buffer_load_dwordx4 v[240:243], v33, s[16:19], s36 offen offset:0 sc1
  buffer_load_dwordx4 v[244:247], v33, s[16:19], s92 offen offset:0 sc1
  buffer_load_dwordx4 v[248:251], v33, s[16:19], s93 offen offset:0 sc1
  v_mfma_f32_16x16x32_bf16 v[112:115], v[184:187], v[232:235], v[112:115]
  v_mfma_f32_16x16x32_bf16 v[116:119], v[188:191], v[232:235], v[116:119]
  v_mfma_f32_16x16x32_bf16 v[48:51], v[192:195], v[220:223], v[48:51]
  v_mfma_f32_16x16x32_bf16 v[52:55], v[196:199], v[220:223], v[52:55]
  v_mfma_f32_16x16x32_bf16 v[56:59], v[200:203], v[220:223], v[56:59]
  v_mfma_f32_16x16x32_bf16 v[72:75], v[192:195], v[224:227], v[72:75]
  v_mfma_f32_16x16x32_bf16 v[76:79], v[196:199], v[224:227], v[76:79]
  v_mfma_f32_16x16x32_bf16 v[80:83], v[200:203], v[224:227], v[80:83]
  buffer_load_dwordx4 v[132:135], v33, s[16:19], s35 offen offset:2048 sc1
  buffer_load_dwordx4 v[136:139], v33, s[16:19], s36 offen offset:2048 sc1
  buffer_load_dwordx4 v[140:143], v33, s[16:19], s92 offen offset:2048 sc1
  buffer_load_dwordx4 v[144:147], v33, s[16:19], s93 offen offset:2048 sc1
  s_add_u32 s35, s35, 4096
  s_add_u32 s36, s36, 4096
  s_add_u32 s92, s92, 4096
  s_add_u32 s93, s93, 4096
  v_mfma_f32_16x16x32_bf16 v[96:99], v[192:195], v[228:231], v[96:99]
  v_mfma_f32_16x16x32_bf16 v[100:103], v[196:199], v[228:231], v[100:103]
  buffer_load_dwordx4 v[148:151], v33, s[16:19], s35 offen offset:0 sc1
  buffer_load_dwordx4 v[152:155], v33, s[16:19], s36 offen offset:0 sc1
  buffer_load_dwordx4 v[156:159], v33, s[16:19], s92 offen offset:0 sc1
  buffer_load_dwordx4 v[160:163], v33, s[16:19], s93 offen offset:0 sc1
  v_mfma_f32_16x16x32_bf16 v[104:107], v[200:203], v[228:231], v[104:107]
  v_mfma_f32_16x16x32_bf16 v[120:123], v[192:195], v[232:235], v[120:123]
  buffer_load_dwordx4 v[204:207], v33, s[16:19], s35 offen offset:2048 sc1
  buffer_load_dwordx4 v[208:211], v33, s[16:19], s36 offen offset:2048 sc1
  buffer_load_dwordx4 v[212:215], v33, s[16:19], s92 offen offset:2048 sc1
  buffer_load_dwordx4 v[216:219], v33, s[16:19], s93 offen offset:2048 sc1
  s_add_u32 s35, s35, 4096
  s_add_u32 s36, s36, 4096
  s_add_u32 s92, s92, 4096
  s_add_u32 s93, s93, 4096
  v_mfma_f32_16x16x32_bf16 v[124:127], v[196:199], v[232:235], v[124:127]
  v_mfma_f32_16x16x32_bf16 v[128:131], v[200:203], v[232:235], v[128:131]
  s_setprio 3
  ds_read_b64_tr_b16 v[164:165], v32 offset:12288
  ds_read_b64_tr_b16 v[166:167], v32 offset:13824
  ds_read_b64_tr_b16 v[168:169], v32 offset:12320
  ds_read_b64_tr_b16 v[170:171], v32 offset:13856
  ds_read_b64_tr_b16 v[172:173], v32 offset:12352
  ds_read_b64_tr_b16 v[174:175], v32 offset:13888
  ds_read_b64_tr_b16 v[176:177], v32 offset:12384
  ds_read_b64_tr_b16 v[178:179], v32 offset:13920
  ds_read_b64_tr_b16 v[180:181], v32 offset:12416
  ds_read_b64_tr_b16 v[182:183], v32 offset:13952
  ds_read_b64_tr_b16 v[184:185], v32 offset:12448
  ds_read_b64_tr_b16 v[186:187], v32 offset:13984
  v_lshrrev_b32 v5, 4, v1
  v_lshlrev_b32 v5, 8, v5
  v_and_b32 v6, 15, v1
  v_lshl_add_u32 v5, v6, 2, v5
  s_and_b32 s21, s35, 256
  s_lshr_b32 s22, s21, 2
  s_sub_u32 s22, s22, s21
  s_add_u32 s22, s22, s35
  buffer_load_dword v188, v5, s[16:19], s22 offen offset:0 sc1
  buffer_load_dword v189, v5, s[16:19], s22 offen offset:128 sc1
  v_mov_b32 v190, 0
  v_mov_b32 v191, 0
  s_and_b32 s21, s36, 256
  s_lshr_b32 s22, s21, 2
  s_sub_u32 s22, s22, s21
  s_add_u32 s22, s22, s36
  buffer_load_dword v192, v5, s[16:19], s22 offen offset:0 sc1
  buffer_load_dword v193, v5, s[16:19], s22 offen offset:128 sc1
  v_mov_b32 v194, 0
  v_mov_b32 v195, 0
  s_and_b32 s21, s92, 256
  s_lshr_b32 s22, s21, 2
  s_sub_u32 s22, s22, s21
  s_add_u32 s22, s22, s92
  buffer_load_dword v196, v5, s[16:19], s22 offen offset:0 sc1
  buffer_load_dword v197, v5, s[16:19], s22 offen offset:128 sc1
  v_mov_b32 v198, 0
  v_mov_b32 v199, 0
  s_and_b32 s21, s93, 256
  s_lshr_b32 s22, s21, 2
  s_sub_u32 s22, s22, s21
  s_add_u32 s22, s22, s93
  buffer_load_dword v200, v5, s[16:19], s22 offen offset:0 sc1
  buffer_load_dword v201, v5, s[16:19], s22 offen offset:128 sc1
  v_mov_b32 v202, 0
  v_mov_b32 v203, 0
  v_mul_u32_u24 v7, 1536, v2
  v_sub_u32 v7, v32, v7
  s_waitcnt lgkmcnt(0)
  s_add_u32 m0, s42, 12288
  s_nop 0
  buffer_load_dwordx4 v26, s[56:59], s37 offen offset:0 lds
  buffer_load_dwordx4 v27, s[56:59], s37 offen offset:1024 lds
  buffer_load_dwordx4 v28, s[56:59], s37 offen offset:2048 lds
  s_add_u32 s37, s37, 20736
  s_add_u32 m0, s42, 15360
  s_nop 0
  buffer_load_dwordx4 v26, s[56:59], s37 offen offset:0 lds
  buffer_load_dwordx4 v27, s[56:59], s37 offen offset:1024 lds
  buffer_load_dwordx4 v28, s[56:59], s37 offen offset:2048 lds
  s_add_u32 s37, s37, 20736
  s_waitcnt vmcnt(30)
  v_mul_f32 v36, v36, v19
  v_mul_f32 v37, v37, v19
  v_mul_f32 v38, v38, v19
  v_mul_f32 v39, v39, v19
  v_mul_f32 v60, v60, v20
  v_mul_f32 v61, v61, v20
  v_mul_f32 v62, v62, v20
  v_mul_f32 v63, v63, v20
  v_mul_f32 v84, v84, v21
  v_mul_f32 v85, v85, v21
  v_mul_f32 v86, v86, v21
  v_mul_f32 v87, v87, v21
  v_mul_f32 v108, v108, v22
  v_mul_f32 v109, v109, v22
  v_mul_f32 v110, v110, v22
  v_mul_f32 v111, v111, v22
  v_mul_f32 v40, v40, v19
  v_mul_f32 v41, v41, v19
  v_mul_f32 v42, v42, v19
  v_mul_f32 v43, v43, v19
  v_mul_f32 v64, v64, v20
  v_mul_f32 v65, v65, v20
  v_mul_f32 v66, v66, v20
  v_mul_f32 v67, v67, v20
  v_mul_f32 v88, v88, v21
  v_mul_f32 v89, v89, v21
  v_mul_f32 v90, v90, v21
  v_mul_f32 v91, v91, v21
  v_mul_f32 v112, v112, v22
  v_mul_f32 v113, v113, v22
  v_mul_f32 v114, v114, v22
  v_mul_f32 v115, v115, v22
  s_waitcnt vmcnt(26)
  s_waitcnt lgkmcnt(10)
  v_mfma_f32_16x16x32_bf16 v[36:39], v[164:167], v[236:239], v[36:39]
  v_mfma_f32_16x16x32_bf16 v[60:63], v[164:167], v[240:243], v[60:63]
  v_mfma_f32_16x16x32_bf16 v[84:87], v[164:167], v[244:247], v[84:87]
  v_mfma_f32_16x16x32_bf16 v[108:111], v[164:167], v[248:251], v[108:111]
  ds_read_b64_tr_b16 v[164:165], v32 offset:0
  ds_read_b64_tr_b16 v[166:167], v32 offset:1536
  v_mul_f32 v44, v44, v19
  v_mul_f32 v45, v45, v19
  v_mul_f32 v46, v46, v19
  v_mul_f32 v47, v47, v19
  v_mul_f32 v68, v68, v20
  v_mul_f32 v69, v69, v20
  v_mul_f32 v70, v70, v20
  v_mul_f32 v71, v71, v20
  v_mul_f32 v92, v92, v21
  v_mul_f32 v93, v93, v21
  v_mul_f32 v94, v94, v21
  v_mul_f32 v95, v95, v21
  v_mul_f32 v116, v116, v22
  v_mul_f32 v117, v117, v22
  v_mul_f32 v118, v118, v22
  v_mul_f32 v119, v119, v22
  s_waitcnt lgkmcnt(10)
  v_mfma_f32_16x16x32_bf16 v[40:43], v[168:171], v[236:239], v[40:43]
  v_mfma_f32_16x16x32_bf16 v[64:67], v[168:171], v[240:243], v[64:67]
  v_mfma_f32_16x16x32_bf16 v[88:91], v[168:171], v[244:247], v[88:91]
  v_mfma_f32_16x16x32_bf16 v[112:115], v[168:171], v[248:251], v[112:115]
  ds_read_b64_tr_b16 v[168:169], v32 offset:32
  ds_read_b64_tr_b16 v[170:171], v32 offset:1568
  v_mul_f32 v48, v48, v19
  v_mul_f32 v49, v49, v19
  v_mul_f32 v50, v50, v19
  v_mul_f32 v51, v51, v19
  v_mul_f32 v72, v72, v20
  v_mul_f32 v73, v73, v20
  v_mul_f32 v74, v74, v20
  v_mul_f32 v75, v75, v20
  v_mul_f32 v96, v96, v21
  v_mul_f32 v97, v97, v21
  v_mul_f32 v98, v98, v21
  v_mul_f32 v99, v99, v21
  v_mul_f32 v120, v120, v22
  v_mul_f32 v121, v121, v22
  v_mul_f32 v122, v122, v22
  v_mul_f32 v123, v123, v22
  s_waitcnt lgkmcnt(10)
  v_mfma_f32_16x16x32_bf16 v[44:47], v[172:175], v[236:239], v[44:47]
  v_mfma_f32_16x16x32_bf16 v[68:71], v[172:175], v[240:243], v[68:71]
  v_mfma_f32_16x16x32_bf16 v[92:95], v[172:175], v[244:247], v[92:95]
  v_mfma_f32_16x16x32_bf16 v[116:119], v[172:175], v[248:251], v[116:119]
  ds_read_b64_tr_b16 v[172:173], v32 offset:64
  ds_read_b64_tr_b16 v[174:175], v32 offset:1600
  v_mul_f32 v52, v52, v19
  v_mul_f32 v53, v53, v19
  v_mul_f32 v54, v54, v19
  v_mul_f32 v55, v55, v19
  v_mul_f32 v76, v76, v20
  v_mul_f32 v77, v77, v20
  v_mul_f32 v78, v78, v20
  v_mul_f32 v79, v79, v20
  v_mul_f32 v100, v100, v21
  v_mul_f32 v101, v101, v21
  v_mul_f32 v102, v102, v21
  v_mul_f32 v103, v103, v21
  v_mul_f32 v124, v124, v22
  v_mul_f32 v125, v125, v22
  v_mul_f32 v126, v126, v22
  v_mul_f32 v127, v127, v22
  s_waitcnt lgkmcnt(10)
  v_mfma_f32_16x16x32_bf16 v[48:51], v[176:179], v[236:239], v[48:51]
  v_mfma_f32_16x16x32_bf16 v[72:75], v[176:179], v[240:243], v[72:75]
  v_mfma_f32_16x16x32_bf16 v[96:99], v[176:179], v[244:247], v[96:99]
  v_mfma_f32_16x16x32_bf16 v[120:123], v[176:179], v[248:251], v[120:123]
  ds_read_b64_tr_b16 v[176:177], v32 offset:96
  ds_read_b64_tr_b16 v[178:179], v32 offset:1632
  v_mul_f32 v56, v56, v19
  v_mul_f32 v57, v57, v19
  v_mul_f32 v58, v58, v19
  v_mul_f32 v59, v59, v19
  v_mul_f32 v80, v80, v20
  v_mul_f32 v81, v81, v20
  v_mul_f32 v82, v82, v20
  v_mul_f32 v83, v83, v20
  v_mul_f32 v104, v104, v21
  v_mul_f32 v105, v105, v21
  v_mul_f32 v106, v106, v21
  v_mul_f32 v107, v107, v21
  v_mul_f32 v128, v128, v22
  v_mul_f32 v129, v129, v22
  v_mul_f32 v130, v130, v22
  v_mul_f32 v131, v131, v22
  s_waitcnt lgkmcnt(10)
  v_mfma_f32_16x16x32_bf16 v[52:55], v[180:183], v[236:239], v[52:55]
  v_mfma_f32_16x16x32_bf16 v[76:79], v[180:183], v[240:243], v[76:79]
  v_mfma_f32_16x16x32_bf16 v[100:103], v[180:183], v[244:247], v[100:103]
  v_mfma_f32_16x16x32_bf16 v[124:127], v[180:183], v[248:251], v[124:127]
  ds_read_b64_tr_b16 v[180:181], v32 offset:128
  ds_read_b64_tr_b16 v[182:183], v32 offset:1664
  s_waitcnt lgkmcnt(10)
  v_mfma_f32_16x16x32_bf16 v[56:59], v[184:187], v[236:239], v[56:59]
  v_mfma_f32_16x16x32_bf16 v[80:83], v[184:187], v[240:243], v[80:83]
  v_mfma_f32_16x16x32_bf16 v[104:107], v[184:187], v[244:247], v[104:107]
  v_mfma_f32_16x16x32_bf16 v[128:131], v[184:187], v[248:251], v[128:131]
  ds_read_b64_tr_b16 v[184:185], v32 offset:160
  ds_read_b64_tr_b16 v[186:187], v32 offset:1696
  s_waitcnt vmcnt(22)
  s_waitcnt lgkmcnt(10)
  v_mfma_f32_16x16x32_bf16 v[36:39], v[164:167], v[132:135], v[36:39]
  v_mfma_f32_16x16x32_bf16 v[60:63], v[164:167], v[136:139], v[60:63]
  v_mfma_f32_16x16x32_bf16 v[84:87], v[164:167], v[140:143], v[84:87]
  v_mfma_f32_16x16x32_bf16 v[108:111], v[164:167], v[144:147], v[108:111]
  ds_read_b64_tr_b16 v[164:165], v32 offset:6144
  ds_read_b64_tr_b16 v[166:167], v32 offset:7680
  s_waitcnt lgkmcnt(10)
  v_mfma_f32_16x16x32_bf16 v[40:43], v[168:171], v[132:135], v[40:43]
  v_mfma_f32_16x16x32_bf16 v[64:67], v[168:171], v[136:139], v[64:67]
  v_mfma_f32_16x16x32_bf16 v[88:91], v[168:171], v[140:143], v[88:91]
  v_mfma_f32_16x16x32_bf16 v[112:115], v[168:171], v[144:147], v[112:115]
  ds_read_b64_tr_b16 v[168:169], v32 offset:6176
  ds_read_b64_tr_b16 v[170:171], v32 offset:7712
  s_waitcnt lgkmcnt(10)
  v_mfma_f32_16x16x32_bf16 v[44:47], v[172:175], v[132:135], v[44:47]
  v_mfma_f32_16x16x32_bf16 v[68:71], v[172:175], v[136:139], v[68:71]
  v_mfma_f32_16x16x32_bf16 v[92:95], v[172:175], v[140:143], v[92:95]
  v_mfma_f32_16x16x32_bf16 v[116:119], v[172:175], v[144:147], v[116:119]
  ds_read_b64_tr_b16 v[172:173], v32 offset:6208
  ds_read_b64_tr_b16 v[174:175], v32 offset:7744
  s_waitcnt lgkmcnt(10)
  v_mfma_f32_16x16x32_bf16 v[48:51], v[176:179], v[132:135], v[48:51]
  v_mfma_f32_16x16x32_bf16 v[72:75], v[176:179], v[136:139], v[72:75]
  v_mfma_f32_16x16x32_bf16 v[96:99], v[176:179], v[140:143], v[96:99]
  v_mfma_f32_16x16x32_bf16 v[120:123], v[176:179], v[144:147], v[120:123]
  ds_read_b64_tr_b16 v[176:177], v32 offset:6240
  ds_read_b64_tr_b16 v[178:179], v32 offset:7776
  s_waitcnt lgkmcnt(10)
  v_mfma_f32_16x16x32_bf16 v[52:55], v[180:183], v[132:135], v[52:55]
  v_mfma_f32_16x16x32_bf16 v[76:79], v[180:183], v[136:139], v[76:79]
  v_mfma_f32_16x16x32_bf16 v[100:103], v[180:183], v[140:143], v[100:103]
  v_mfma_f32_16x16x32_bf16 v[124:127], v[180:183], v[144:147], v[124:127]
  ds_read_b64_tr_b16 v[180:181], v32 offset:6272
  ds_read_b64_tr_b16 v[182:183], v32 offset:7808
  s_waitcnt lgkmcnt(10)
  s_add_u32 m0, s42, 0
  s_sub_u32 s37, s37, 165888
  buffer_load_dwordx4 v29, s[56:59], s37 offen offset:0 lds
  buffer_load_dwordx4 v30, s[56:59], s37 offen offset:1024 lds
  buffer_load_dwordx4 v31, s[56:59], s37 offen offset:2048 lds
  s_add_u32 s37, s37, 20736
  v_mfma_f32_16x16x32_bf16 v[56:59], v[184:187], v[132:135], v[56:59]
  v_mfma_f32_16x16x32_bf16 v[80:83], v[184:187], v[136:139], v[80:83]
  v_mfma_f32_16x16x32_bf16 v[104:107], v[184:187], v[140:143], v[104:107]
  v_mfma_f32_16x16x32_bf16 v[128:131], v[184:187], v[144:147], v[128:131]
  ds_read_b64_tr_b16 v[184:185], v32 offset:6304
  ds_read_b64_tr_b16 v[186:187], v32 offset:7840
  v_mov_b32 v24, s88
  buffer_load_dword v25, v24, s[16:19], 0 offen offset:128 sc1
  s_waitcnt vmcnt(4)
  s_waitcnt lgkmcnt(10)
  v_mfma_f32_16x16x32_bf16 v[36:39], v[164:167], v[148:151], v[36:39]
  v_mfma_f32_16x16x32_bf16 v[60:63], v[164:167], v[152:155], v[60:63]
  v_mfma_f32_16x16x32_bf16 v[84:87], v[164:167], v[156:159], v[84:87]
  v_mfma_f32_16x16x32_bf16 v[108:111], v[164:167], v[160:163], v[108:111]
  ds_read_b64_tr_b16 v[164:165], v32 offset:12288
  ds_read_b64_tr_b16 v[166:167], v32 offset:13824
  s_waitcnt lgkmcnt(10)
  v_mfma_f32_16x16x32_bf16 v[40:43], v[168:171], v[148:151], v[40:43]
  v_mfma_f32_16x16x32_bf16 v[64:67], v[168:171], v[152:155], v[64:67]
  v_mfma_f32_16x16x32_bf16 v[88:91], v[168:171], v[156:159], v[88:91]
  v_mfma_f32_16x16x32_bf16 v[112:115], v[168:171], v[160:163], v[112:115]
  ds_read_b64_tr_b16 v[168:169], v32 offset:12320
  ds_read_b64_tr_b16 v[170:171], v32 offset:13856
  s_waitcnt lgkmcnt(10)
  v_mfma_f32_16x16x32_bf16 v[44:47], v[172:175], v[148:151], v[44:47]
  v_mfma_f32_16x16x32_bf16 v[68:71], v[172:175], v[152:155], v[68:71]
  v_mfma_f32_16x16x32_bf16 v[92:95], v[172:175], v[156:159], v[92:95]
  v_mfma_f32_16x16x32_bf16 v[116:119], v[172:175], v[160:163], v[116:119]
  ds_read_b64_tr_b16 v[172:173], v32 offset:12352
  ds_read_b64_tr_b16 v[174:175], v32 offset:13888
  s_waitcnt lgkmcnt(10)
  v_mfma_f32_16x16x32_bf16 v[48:51], v[176:179], v[148:151], v[48:51]
  v_mfma_f32_16x16x32_bf16 v[72:75], v[176:179], v[152:155], v[72:75]
  v_mfma_f32_16x16x32_bf16 v[96:99], v[176:179], v[156:159], v[96:99]
  v_mfma_f32_16x16x32_bf16 v[120:123], v[176:179], v[160:163], v[120:123]
  ds_read_b64_tr_b16 v[176:177], v32 offset:12384
  ds_read_b64_tr_b16 v[178:179], v32 offset:13920
  s_waitcnt lgkmcnt(10)
  v_mfma_f32_16x16x32_bf16 v[52:55], v[180:183], v[148:151], v[52:55]
  v_mfma_f32_16x16x32_bf16 v[76:79], v[180:183], v[152:155], v[76:79]
  v_mfma_f32_16x16x32_bf16 v[100:103], v[180:183], v[156:159], v[100:103]
  v_mfma_f32_16x16x32_bf16 v[124:127], v[180:183], v[160:163], v[124:127]
  ds_read_b64_tr_b16 v[180:181], v32 offset:12416
  ds_read_b64_tr_b16 v[182:183], v32 offset:13952
  s_waitcnt lgkmcnt(10)
  v_mfma_f32_16x16x32_bf16 v[56:59], v[184:187], v[148:151], v[56:59]
  v_mfma_f32_16x16x32_bf16 v[80:83], v[184:187], v[152:155], v[80:83]
  v_mfma_f32_16x16x32_bf16 v[104:107], v[184:187], v[156:159], v[104:107]
  v_mfma_f32_16x16x32_bf16 v[128:131], v[184:187], v[160:163], v[128:131]
  ds_read_b64_tr_b16 v[184:185], v32 offset:12448
  ds_read_b64_tr_b16 v[186:187], v32 offset:13984
  s_waitcnt vmcnt(1)
  s_waitcnt lgkmcnt(10)
  v_mfma_f32_16x16x32_bf16 v[36:39], v[164:167], v[204:207], v[36:39]
  v_mfma_f32_16x16x32_bf16 v[60:63], v[164:167], v[208:211], v[60:63]
  v_mfma_f32_16x16x32_bf16 v[84:87], v[164:167], v[212:215], v[84:87]
  v_mfma_f32_16x16x32_bf16 v[108:111], v[164:167], v[216:219], v[108:111]
  ds_read_b64_tr_b16 v[164:165], v7 offset:0
  s_waitcnt lgkmcnt(9)
  v_mfma_f32_16x16x32_bf16 v[40:43], v[168:171], v[204:207], v[40:43]
  v_mfma_f32_16x16x32_bf16 v[64:67], v[168:171], v[208:211], v[64:67]
  v_mfma_f32_16x16x32_bf16 v[88:91], v[168:171], v[212:215], v[88:91]
  v_mfma_f32_16x16x32_bf16 v[112:115], v[168:171], v[216:219], v[112:115]
  ds_read_b64_tr_b16 v[168:169], v7 offset:32
  s_waitcnt lgkmcnt(8)
  v_mfma_f32_16x16x32_bf16 v[44:47], v[172:175], v[204:207], v[44:47]
  v_mfma_f32_16x16x32_bf16 v[68:71], v[172:175], v[208:211], v[68:71]
  v_mfma_f32_16x16x32_bf16 v[92:95], v[172:175], v[212:215], v[92:95]
  v_mfma_f32_16x16x32_bf16 v[116:119], v[172:175], v[216:219], v[116:119]
  ds_read_b64_tr_b16 v[172:173], v7 offset:64
  s_waitcnt lgkmcnt(7)
  v_mfma_f32_16x16x32_bf16 v[48:51], v[176:179], v[204:207], v[48:51]
  v_mfma_f32_16x16x32_bf16 v[72:75], v[176:179], v[208:211], v[72:75]
  v_mfma_f32_16x16x32_bf16 v[96:99], v[176:179], v[212:215], v[96:99]
  v_mfma_f32_16x16x32_bf16 v[120:123], v[176:179], v[216:219], v[120:123]
  ds_read_b64_tr_b16 v[176:177], v7 offset:96
  s_waitcnt lgkmcnt(6)
  v_mfma_f32_16x16x32_bf16 v[52:55], v[180:183], v[204:207], v[52:55]
  v_mfma_f32_16x16x32_bf16 v[76:79], v[180:183], v[208:211], v[76:79]
  v_mfma_f32_16x16x32_bf16 v[100:103], v[180:183], v[212:215], v[100:103]
  v_mfma_f32_16x16x32_bf16 v[124:127], v[180:183], v[216:219], v[124:127]
  ds_read_b64_tr_b16 v[180:181], v7 offset:128
  s_waitcnt lgkmcnt(5)
  v_mfma_f32_16x16x32_bf16 v[56:59], v[184:187], v[204:207], v[56:59]
  v_mfma_f32_16x16x32_bf16 v[80:83], v[184:187], v[208:211], v[80:83]
  v_mfma_f32_16x16x32_bf16 v[104:107], v[184:187], v[212:215], v[104:107]
  v_mfma_f32_16x16x32_bf16 v[128:131], v[184:187], v[216:219], v[128:131]
  ds_read_b64_tr_b16 v[184:185], v7 offset:160
  s_waitcnt vmcnt(0)
  v_cmp_ne_u32 vcc, 1, v25
  s_nop 4
  s_cbranch_vccnz G2SY_77
G2BY_78:
  s_mul_i32 s21, s20, 6144
  s_add_u32 s63, s63, s21
  s_add_u32 s21, s63, 4096
  buffer_load_dwordx4 v[236:239], v4, s[16:19], s63 offen offset:0 sc1
  buffer_load_dwordx4 v[240:243], v4, s[16:19], s63 offen offset:1024 sc1
  buffer_load_dwordx4 v[244:247], v4, s[16:19], s63 offen offset:2048 sc1
  buffer_load_dwordx4 v[248:251], v4, s[16:19], s63 offen offset:3072 sc1
  buffer_load_dwordx4 v[132:135], v4, s[16:19], s21 offen offset:0 sc1
  buffer_load_dwordx4 v[136:139], v4, s[16:19], s21 offen offset:1024 sc1
  s_waitcnt lgkmcnt(5)
  v_mfma_f32_16x16x32_bf16 v[36:39], v[164:167], v[188:191], v[36:39]
  v_mfma_f32_16x16x32_bf16 v[60:63], v[164:167], v[192:195], v[60:63]
  v_mfma_f32_16x16x32_bf16 v[84:87], v[164:167], v[196:199], v[84:87]
  v_mfma_f32_16x16x32_bf16 v[108:111], v[164:167], v[200:203], v[108:111]
  s_waitcnt lgkmcnt(4)
  v_mfma_f32_16x16x32_bf16 v[40:43], v[168:171], v[188:191], v[40:43]
  v_mfma_f32_16x16x32_bf16 v[64:67], v[168:171], v[192:195], v[64:67]
  v_mfma_f32_16x16x32_bf16 v[88:91], v[168:171], v[196:199], v[88:91]
  v_mfma_f32_16x16x32_bf16 v[112:115], v[168:171], v[200:203], v[112:115]
  s_waitcnt lgkmcnt(3)
  v_mfma_f32_16x16x32_bf16 v[44:47], v[172:175], v[188:191], v[44:47]
  v_mfma_f32_16x16x32_bf16 v[68:71], v[172:175], v[192:195], v[68:71]
  v_mfma_f32_16x16x32_bf16 v[92:95], v[172:175], v[196:199], v[92:95]
  v_mfma_f32_16x16x32_bf16 v[116:119], v[172:175], v[200:203], v[116:119]
  s_waitcnt lgkmcnt(2)
  v_mfma_f32_16x16x32_bf16 v[48:51], v[176:179], v[188:191], v[48:51]
  v_mfma_f32_16x16x32_bf16 v[72:75], v[176:179], v[192:195], v[72:75]
  v_mfma_f32_16x16x32_bf16 v[96:99], v[176:179], v[196:199], v[96:99]
  v_mfma_f32_16x16x32_bf16 v[120:123], v[176:179], v[200:203], v[120:123]
  s_waitcnt lgkmcnt(1)
  v_mfma_f32_16x16x32_bf16 v[52:55], v[180:183], v[188:191], v[52:55]
  v_mfma_f32_16x16x32_bf16 v[76:79], v[180:183], v[192:195], v[76:79]
  v_mfma_f32_16x16x32_bf16 v[100:103], v[180:183], v[196:199], v[100:103]
  v_mfma_f32_16x16x32_bf16 v[124:127], v[180:183], v[200:203], v[124:127]
  s_waitcnt lgkmcnt(0)
  v_mfma_f32_16x16x32_bf16 v[56:59], v[184:187], v[188:191], v[56:59]
  v_mfma_f32_16x16x32_bf16 v[80:83], v[184:187], v[192:195], v[80:83]
  v_mfma_f32_16x16x32_bf16 v[104:107], v[184:187], v[196:199], v[104:107]
  v_mfma_f32_16x16x32_bf16 v[128:131], v[184:187], v[200:203], v[128:131]
  v_add_u32 v164, s42, v4
  s_xor_b32 s21, s20, 1
  s_mul_i32 s21, s21, 20480
  s_add_u32 s21, s21, 0
  v_add_u32 v165, s21, v4
  s_xor_b32 s21, s20, 2
  s_mul_i32 s21, s21, 20480
  s_add_u32 s21, s21, 6144
  v_add_u32 v166, s21, v4
  s_xor_b32 s21, s20, 3
  s_mul_i32 s21, s21, 20480
  s_add_u32 s21, s21, 12288
  v_add_u32 v167, s21, v4
  ds_write_b128 v164, v[60:63] offset:0
  ds_write_b128 v164, v[84:87] offset:6144
  ds_write_b128 v164, v[108:111] offset:12288
  ds_write_b128 v164, v[64:67] offset:1024
  ds_write_b128 v164, v[88:91] offset:7168
  ds_write_b128 v164, v[112:115] offset:13312
  ds_write_b128 v164, v[68:71] offset:2048
  ds_write_b128 v164, v[92:95] offset:8192
  ds_write_b128 v164, v[116:119] offset:14336
  ds_write_b128 v164, v[72:75] offset:3072
  ds_write_b128 v164, v[96:99] offset:9216
  ds_write_b128 v164, v[120:123] offset:15360
  ds_write_b128 v164, v[76:79] offset:4096
  ds_write_b128 v164, v[100:103] offset:10240
  ds_write_b128 v164, v[124:127] offset:16384
  ds_write_b128 v164, v[80:83] offset:5120
  ds_write_b128 v164, v[104:107] offset:11264
  ds_write_b128 v164, v[128:131] offset:17408
  s_waitcnt vmcnt(0)
  v_lshlrev_b32 v17, 16, v17
  v_add_f32 v236, v236, v17
  v_add_f32 v237, v237, v17
  v_add_f32 v238, v238, v17
  v_add_f32 v239, v239, v17
  v_fmac_f32 v36, v236, v19
  v_fmac_f32 v37, v237, v19
  v_fmac_f32 v38, v238, v19
  v_fmac_f32 v39, v239, v19
  v_add_f32 v240, v240, v17
  v_add_f32 v241, v241, v17
  v_add_f32 v242, v242, v17
  v_add_f32 v243, v243, v17
  v_fmac_f32 v40, v240, v19
  v_fmac_f32 v41, v241, v19
  v_fmac_f32 v42, v242, v19
  v_fmac_f32 v43, v243, v19
  v_add_f32 v244, v244, v17
  v_add_f32 v245, v245, v17
  v_add_f32 v246, v246, v17
  v_add_f32 v247, v247, v17
  v_fmac_f32 v44, v244, v19
  v_fmac_f32 v45, v245, v19
  v_fmac_f32 v46, v246, v19
  v_fmac_f32 v47, v247, v19
  v_add_f32 v248, v248, v17
  v_add_f32 v249, v249, v17
  v_add_f32 v250, v250, v17
  v_add_f32 v251, v251, v17
  v_fmac_f32 v48, v248, v19
  v_fmac_f32 v49, v249, v19
  v_fmac_f32 v50, v250, v19
  v_fmac_f32 v51, v251, v19
  v_add_f32 v132, v132, v17
  v_add_f32 v133, v133, v17
  v_add_f32 v134, v134, v17
  v_add_f32 v135, v135, v17
  v_fmac_f32 v52, v132, v19
  v_fmac_f32 v53, v133, v19
  v_fmac_f32 v54, v134, v19
  v_fmac_f32 v55, v135, v19
  v_add_f32 v136, v136, v17
  v_add_f32 v137, v137, v17
  v_add_f32 v138, v138, v17
  v_add_f32 v139, v139, v17
  v_fmac_f32 v56, v136, v19
  v_fmac_f32 v57, v137, v19
  v_fmac_f32 v58, v138, v19
  v_fmac_f32 v59, v139, v19
  s_mul_i32 s21, s39, 192
  s_waitcnt lgkmcnt(0)
  s_barrier
  ds_read_b128 v[60:63], v165 offset:0
  ds_read_b128 v[84:87], v166 offset:0
  ds_read_b128 v[108:111], v167 offset:0
  ds_read_b128 v[64:67], v165 offset:1024
  ds_read_b128 v[88:91], v166 offset:1024
  ds_read_b128 v[112:115], v167 offset:1024
  ds_read_b128 v[68:71], v165 offset:2048
  ds_read_b128 v[92:95], v166 offset:2048
  ds_read_b128 v[116:119], v167 offset:2048
  ds_read_b128 v[72:75], v165 offset:3072
  ds_read_b128 v[96:99], v166 offset:3072
  ds_read_b128 v[120:123], v167 offset:3072
  s_waitcnt lgkmcnt(6)
  ds_read_b128 v[76:79], v165 offset:4096
  ds_read_b128 v[100:103], v166 offset:4096
  ds_read_b128 v[124:127], v167 offset:4096
  ds_read_b128 v[80:83], v165 offset:5120
  ds_read_b128 v[104:107], v166 offset:5120
  ds_read_b128 v[128:131], v167 offset:5120
  v_add_f32 v60, v60, v84
  v_add_f32 v36, v36, v108
  v_add_f32 v61, v61, v85
  v_add_f32 v37, v37, v109
  v_add_f32 v62, v62, v86
  v_add_f32 v38, v38, v110
  v_add_f32 v63, v63, v87
  v_add_f32 v39, v39, v111
  v_add_f32 v36, v36, v60
  v_add_f32 v37, v37, v61
  v_add_f32 v38, v38, v62
  v_add_f32 v39, v39, v63
  v_add_f32 v64, v64, v88
  v_add_f32 v40, v40, v112
  v_add_f32 v65, v65, v89
  v_add_f32 v41, v41, v113
  v_add_f32 v66, v66, v90
  v_add_f32 v42, v42, v114
  v_add_f32 v67, v67, v91
  v_add_f32 v43, v43, v115
  v_add_f32 v40, v40, v64
  v_add_f32 v41, v41, v65
  v_add_f32 v42, v42, v66
  v_add_f32 v43, v43, v67
  v_cvt_pk_bf16_f32 v204, v36, v37
  v_cvt_pk_bf16_f32 v205, v38, v39
  v_cvt_pk_bf16_f32 v206, v40, v41
  v_cvt_pk_bf16_f32 v207, v42, v43
  s_nop 0
  v_permlane16_swap_b32 v204, v206
  v_permlane16_swap_b32 v205, v207
  buffer_store_dwordx4 v[204:207], v23, s[48:51], s21 offen offset:0
  s_waitcnt lgkmcnt(6)
  v_add_f32 v68, v68, v92
  v_add_f32 v44, v44, v116
  v_add_f32 v69, v69, v93
  v_add_f32 v45, v45, v117
  v_add_f32 v70, v70, v94
  v_add_f32 v46, v46, v118
  v_add_f32 v71, v71, v95
  v_add_f32 v47, v47, v119
  v_add_f32 v44, v44, v68
  v_add_f32 v45, v45, v69
  v_add_f32 v46, v46, v70
  v_add_f32 v47, v47, v71
  v_add_f32 v72, v72, v96
  v_add_f32 v48, v48, v120
  v_add_f32 v73, v73, v97
  v_add_f32 v49, v49, v121
  v_add_f32 v74, v74, v98
  v_add_f32 v50, v50, v122
  v_add_f32 v75, v75, v99
  v_add_f32 v51, v51, v123
  v_add_f32 v48, v48, v72
  v_add_f32 v49, v49, v73
  v_add_f32 v50, v50, v74
  v_add_f32 v51, v51, v75
  v_cvt_pk_bf16_f32 v208, v44, v45
  v_cvt_pk_bf16_f32 v209, v46, v47
  v_cvt_pk_bf16_f32 v210, v48, v49
  v_cvt_pk_bf16_f32 v211, v50, v51
  s_nop 0
  v_permlane16_swap_b32 v208, v210
  v_permlane16_swap_b32 v209, v211
  buffer_store_dwordx4 v[208:211], v23, s[48:51], s21 offen offset:64
  s_waitcnt lgkmcnt(0)
  v_add_f32 v76, v76, v100
  v_add_f32 v52, v52, v124
  v_add_f32 v77, v77, v101
  v_add_f32 v53, v53, v125
  v_add_f32 v78, v78, v102
  v_add_f32 v54, v54, v126
  v_add_f32 v79, v79, v103
  v_add_f32 v55, v55, v127
  v_add_f32 v52, v52, v76
  v_add_f32 v53, v53, v77
  v_add_f32 v54, v54, v78
  v_add_f32 v55, v55, v79
  v_add_f32 v80, v80, v104
  v_add_f32 v56, v56, v128
  v_add_f32 v81, v81, v105
  v_add_f32 v57, v57, v129
  v_add_f32 v82, v82, v106
  v_add_f32 v58, v58, v130
  v_add_f32 v83, v83, v107
  v_add_f32 v59, v59, v131
  v_add_f32 v56, v56, v80
  v_add_f32 v57, v57, v81
  v_add_f32 v58, v58, v82
  v_add_f32 v59, v59, v83
  v_cvt_pk_bf16_f32 v212, v52, v53
  v_cvt_pk_bf16_f32 v213, v54, v55
  v_cvt_pk_bf16_f32 v214, v56, v57
  v_cvt_pk_bf16_f32 v215, v58, v59
  s_nop 0
  v_permlane16_swap_b32 v212, v214
  v_permlane16_swap_b32 v213, v215
  buffer_store_dwordx4 v[212:215], v23, s[48:51], s21 offen offset:128
FIN_7:
  s_endpgm
G2SLOW_75:
  s_mov_b32 s22, 0x20000
POLL_79:
  buffer_load_dword v25, v24, s[16:19], 0 offen offset:128 sc1
  s_waitcnt vmcnt(0)
  v_cmp_ne_u32 vcc, 1, v25
  s_nop 4
  s_cbranch_vccz POLLD_80
  s_sleep 2
  s_sub_u32 s22, s22, 1
  s_cmp_lg_u32 s22, 0
  s_cbranch_scc1 POLL_79
POLLD_80:
  s_branch G2BACK_76
G2SU_71:
  s_mov_b32 s22, 0x20000
POLL_81:
  buffer_load_dword v25, v5, s[16:19], s90 offen offset:128 sc1
  s_waitcnt vmcnt(0)
  v_cmp_ne_u32 vcc, 1, v25
  s_nop 4
  s_cbranch_vccz POLLD_82
  s_sleep 2
  s_sub_u32 s22, s22, 1
  s_cmp_lg_u32 s22, 0
  s_cbranch_scc1 POLL_81
POLLD_82:
  s_branch G2BU_72
G2SY_77:
  s_mov_b32 s22, 0x20000
POLL_83:
  buffer_load_dword v25, v24, s[16:19], 0 offen offset:128 sc1
  s_waitcnt vmcnt(0)
  v_cmp_ne_u32 vcc, 1, v25
  s_nop 4
  s_cbranch_vccz POLLD_84
  s_sleep 2
  s_sub_u32 s22, s22, 1
  s_cmp_lg_u32 s22, 0
  s_cbranch_scc1 POLL_83
POLLD_84:
  s_branch G2BY_78
G2XT_74:
  s_waitcnt lgkmcnt(0)
  v_mfma_f32_16x16x32_bf16 v[36:39], v[180:183], v[204:207], v[36:39]
  s_add_u32 m0, s42, 8192
  s_waitcnt vmcnt(13)
  v_mfma_f32_16x16x32_bf16 v[40:43], v[184:187], v[204:207], v[40:43]
  ds_read_b64_tr_b16 v[220:221], v13 offset:0
  ds_read_b64_tr_b16 v[222:223], v13 offset:1024
  v_mfma_f32_16x16x32_bf16 v[44:47], v[188:191], v[204:207], v[44:47]
  buffer_load_dwordx4 v11, s[52:55], s41 offen lds
  v_mfma_f32_16x16x32_bf16 v[60:63], v[180:183], v[208:211], v[60:63]
  ds_read_b64_tr_b16 v[224:225], v14 offset:0
  ds_read_b64_tr_b16 v[226:227], v14 offset:1024
  v_mfma_f32_16x16x32_bf16 v[64:67], v[184:187], v[208:211], v[64:67]
  buffer_load_dwordx4 v12, s[52:55], s41 offen offset:1024 lds
  s_add_u32 s41, s41, 65536
  v_mfma_f32_16x16x32_bf16 v[68:71], v[188:191], v[208:211], v[68:71]
  v_mfma_f32_16x16x32_bf16 v[84:87], v[180:183], v[212:215], v[84:87]
  buffer_load_dwordx4 v[168:171], v10, s[16:19], s40 offen offset:1280 sc1
  v_mfma_f32_16x16x32_bf16 v[88:91], v[184:187], v[212:215], v[88:91]
  v_mfma_f32_16x16x32_bf16 v[92:95], v[188:191], v[212:215], v[92:95]
  buffer_load_dwordx4 v[172:175], v10, s[16:19], s40 offen offset:2048 sc1
  v_mfma_f32_16x16x32_bf16 v[108:111], v[180:183], v[216:219], v[108:111]
  v_mfma_f32_16x16x32_bf16 v[112:115], v[184:187], v[216:219], v[112:115]
  buffer_load_dwordx4 v[176:179], v10, s[16:19], s40 offen offset:2304 sc1
  s_add_u32 s40, s40, 6144
  v_mfma_f32_16x16x32_bf16 v[116:119], v[188:191], v[216:219], v[116:119]
  v_mfma_f32_16x16x32_bf16 v[48:51], v[192:195], v[204:207], v[48:51]
  s_add_u32 m0, s42, 10240
  s_waitcnt vmcnt(15)
  v_mfma_f32_16x16x32_bf16 v[52:55], v[196:199], v[204:207], v[52:55]
  ds_read_b64_tr_b16 v[228:229], v15 offset:0
  ds_read_b64_tr_b16 v[230:231], v15 offset:1024
  v_mfma_f32_16x16x32_bf16 v[56:59], v[200:203], v[204:207], v[56:59]
  buffer_load_dwordx4 v11, s[52:55], s41 offen lds
  v_mfma_f32_16x16x32_bf16 v[72:75], v[192:195], v[208:211], v[72:75]
  ds_read_b64_tr_b16 v[232:233], v16 offset:0
  ds_read_b64_tr_b16 v[234:235], v16 offset:1024
  v_mfma_f32_16x16x32_bf16 v[76:79], v[196:199], v[208:211], v[76:79]
  buffer_load_dwordx4 v12, s[52:55], s41 offen offset:1024 lds
  s_add_u32 s41, s41, 65536
  v_mfma_f32_16x16x32_bf16 v[80:83], v[200:203], v[208:211], v[80:83]
  v_mfma_f32_16x16x32_bf16 v[96:99], v[192:195], v[212:215], v[96:99]
  buffer_load_dwordx4 v[180:183], v10, s[16:19], s40 offen offset:0 sc1
  v_mfma_f32_16x16x32_bf16 v[100:103], v[196:199], v[212:215], v[100:103]
  v_mfma_f32_16x16x32_bf16 v[104:107], v[200:203], v[212:215], v[104:107]
  buffer_load_dwordx4 v[184:187], v10, s[16:19], s40 offen offset:256 sc1
  v_mfma_f32_16x16x32_bf16 v[120:123], v[192:195], v[216:219], v[120:123]
  v_mfma_f32_16x16x32_bf16 v[124:127], v[196:199], v[216:219], v[124:127]
  buffer_load_dwordx4 v[188:191], v10, s[16:19], s40 offen offset:1024 sc1
  v_mfma_f32_16x16x32_bf16 v[128:131], v[200:203], v[216:219], v[128:131]
  s_waitcnt lgkmcnt(0)
  v_mfma_f32_16x16x32_bf16 v[36:39], v[132:135], v[220:223], v[36:39]
  s_waitcnt vmcnt(13)
  v_mfma_f32_16x16x32_bf16 v[40:43], v[136:139], v[220:223], v[40:43]
  ds_read_b64_tr_b16 v[204:205], v13 offset:4096
  ds_read_b64_tr_b16 v[206:207], v13 offset:5120
  v_mfma_f32_16x16x32_bf16 v[44:47], v[140:143], v[220:223], v[44:47]
  v_mfma_f32_16x16x32_bf16 v[60:63], v[132:135], v[224:227], v[60:63]
  ds_read_b64_tr_b16 v[208:209], v14 offset:4096
  ds_read_b64_tr_b16 v[210:211], v14 offset:5120
  v_mfma_f32_16x16x32_bf16 v[64:67], v[136:139], v[224:227], v[64:67]
  v_mfma_f32_16x16x32_bf16 v[68:71], v[140:143], v[224:227], v[68:71]
  v_mfma_f32_16x16x32_bf16 v[84:87], v[132:135], v[228:231], v[84:87]
  buffer_load_dwordx4 v[192:195], v10, s[16:19], s40 offen offset:1280 sc1
  v_mfma_f32_16x16x32_bf16 v[88:91], v[136:139], v[228:231], v[88:91]
  v_mfma_f32_16x16x32_bf16 v[92:95], v[140:143], v[228:231], v[92:95]
  buffer_load_dwordx4 v[196:199], v10, s[16:19], s40 offen offset:2048 sc1
  v_mfma_f32_16x16x32_bf16 v[108:111], v[132:135], v[232:235], v[108:111]
  v_mfma_f32_16x16x32_bf16 v[112:115], v[136:139], v[232:235], v[112:115]
  buffer_load_dwordx4 v[200:203], v10, s[16:19], s40 offen offset:2304 sc1
  s_add_u32 s40, s40, 6144
  v_mfma_f32_16x16x32_bf16 v[116:119], v[140:143], v[232:235], v[116:119]
  v_mfma_f32_16x16x32_bf16 v[48:51], v[144:147], v[220:223], v[48:51]
  s_waitcnt vmcnt(13)
  v_mfma_f32_16x16x32_bf16 v[52:55], v[148:151], v[220:223], v[52:55]
  ds_read_b64_tr_b16 v[212:213], v15 offset:4096
  ds_read_b64_tr_b16 v[214:215], v15 offset:5120
  v_mfma_f32_16x16x32_bf16 v[56:59], v[152:155], v[220:223], v[56:59]
  v_mfma_f32_16x16x32_bf16 v[72:75], v[144:147], v[224:227], v[72:75]
  ds_read_b64_tr_b16 v[216:217], v16 offset:4096
  ds_read_b64_tr_b16 v[218:219], v16 offset:5120
  v_mfma_f32_16x16x32_bf16 v[76:79], v[148:151], v[224:227], v[76:79]
  v_mfma_f32_16x16x32_bf16 v[80:83], v[152:155], v[224:227], v[80:83]
  v_mfma_f32_16x16x32_bf16 v[96:99], v[144:147], v[228:231], v[96:99]
  v_mfma_f32_16x16x32_bf16 v[100:103], v[148:151], v[228:231], v[100:103]
  v_mfma_f32_16x16x32_bf16 v[104:107], v[152:155], v[228:231], v[104:107]
  v_mfma_f32_16x16x32_bf16 v[120:123], v[144:147], v[232:235], v[120:123]
  v_mfma_f32_16x16x32_bf16 v[124:127], v[148:151], v[232:235], v[124:127]
  v_mfma_f32_16x16x32_bf16 v[128:131], v[152:155], v[232:235], v[128:131]
  s_waitcnt lgkmcnt(0)
  v_mfma_f32_16x16x32_bf16 v[36:39], v[156:159], v[204:207], v[36:39]
  s_waitcnt vmcnt(6)
  v_mfma_f32_16x16x32_bf16 v[40:43], v[160:163], v[204:207], v[40:43]
  ds_read_b64_tr_b16 v[220:221], v13 offset:8192
  ds_read_b64_tr_b16 v[222:223], v13 offset:9216
  v_mfma_f32_16x16x32_bf16 v[44:47], v[164:167], v[204:207], v[44:47]
  v_mfma_f32_16x16x32_bf16 v[60:63], v[156:159], v[208:211], v[60:63]
  ds_read_b64_tr_b16 v[224:225], v14 offset:8192
  ds_read_b64_tr_b16 v[226:227], v14 offset:9216
  v_mfma_f32_16x16x32_bf16 v[64:67], v[160:163], v[208:211], v[64:67]
  v_mfma_f32_16x16x32_bf16 v[68:71], v[164:167], v[208:211], v[68:71]
  v_mfma_f32_16x16x32_bf16 v[84:87], v[156:159], v[212:215], v[84:87]
  v_mfma_f32_16x16x32_bf16 v[88:91], v[160:163], v[212:215], v[88:91]
  v_mfma_f32_16x16x32_bf16 v[92:95], v[164:167], v[212:215], v[92:95]
  v_mfma_f32_16x16x32_bf16 v[108:111], v[156:159], v[216:219], v[108:111]
  v_mfma_f32_16x16x32_bf16 v[112:115], v[160:163], v[216:219], v[112:115]
  v_mfma_f32_16x16x32_bf16 v[116:119], v[164:167], v[216:219], v[116:119]
  v_mfma_f32_16x16x32_bf16 v[48:51], v[168:171], v[204:207], v[48:51]
  s_waitcnt vmcnt(3)
  v_mfma_f32_16x16x32_bf16 v[52:55], v[172:175], v[204:207], v[52:55]
  ds_read_b64_tr_b16 v[228:229], v15 offset:8192
  ds_read_b64_tr_b16 v[230:231], v15 offset:9216
  v_mfma_f32_16x16x32_bf16 v[56:59], v[176:179], v[204:207], v[56:59]
  v_mfma_f32_16x16x32_bf16 v[72:75], v[168:171], v[208:211], v[72:75]
  ds_read_b64_tr_b16 v[232:233], v16 offset:8192
  ds_read_b64_tr_b16 v[234:235], v16 offset:9216
  v_mfma_f32_16x16x32_bf16 v[76:79], v[172:175], v[208:211], v[76:79]
  v_mfma_f32_16x16x32_bf16 v[80:83], v[176:179], v[208:211], v[80:83]
  v_mfma_f32_16x16x32_bf16 v[96:99], v[168:171], v[212:215], v[96:99]
  v_mfma_f32_16x16x32_bf16 v[100:103], v[172:175], v[212:215], v[100:103]
  v_mfma_f32_16x16x32_bf16 v[104:107], v[176:179], v[212:215], v[104:107]
  v_mfma_f32_16x16x32_bf16 v[120:123], v[168:171], v[216:219], v[120:123]
  v_mfma_f32_16x16x32_bf16 v[124:127], v[172:175], v[216:219], v[124:127]
  v_mfma_f32_16x16x32_bf16 v[128:131], v[176:179], v[216:219], v[128:131]
  s_waitcnt lgkmcnt(0)
  v_mfma_f32_16x16x32_bf16 v[36:39], v[180:183], v[220:223], v[36:39]
  s_waitcnt vmcnt(0)
  v_mfma_f32_16x16x32_bf16 v[40:43], v[184:187], v[220:223], v[40:43]
  v_mfma_f32_16x16x32_bf16 v[44:47], v[188:191], v[220:223], v[44:47]
  v_mfma_f32_16x16x32_bf16 v[60:63], v[180:183], v[224:227], v[60:63]
  v_mfma_f32_16x16x32_bf16 v[64:67], v[184:187], v[224:227], v[64:67]
  v_mfma_f32_16x16x32_bf16 v[68:71], v[188:191], v[224:227], v[68:71]
  v_mfma_f32_16x16x32_bf16 v[84:87], v[180:183], v[228:231], v[84:87]
  v_mfma_f32_16x16x32_bf16 v[88:91], v[184:187], v[228:231], v[88:91]
  v_mfma_f32_16x16x32_bf16 v[92:95], v[188:191], v[228:231], v[92:95]
  v_mfma_f32_16x16x32_bf16 v[108:111], v[180:183], v[232:235], v[108:111]
  v_mfma_f32_16x16x32_bf16 v[112:115], v[184:187], v[232:235], v[112:115]
  v_mfma_f32_16x16x32_bf16 v[116:119], v[188:191], v[232:235], v[116:119]
  v_mfma_f32_16x16x32_bf16 v[48:51], v[192:195], v[220:223], v[48:51]
  v_mfma_f32_16x16x32_bf16 v[52:55], v[196:199], v[220:223], v[52:55]
  v_mfma_f32_16x16x32_bf16 v[56:59], v[200:203], v[220:223], v[56:59]
  v_mfma_f32_16x16x32_bf16 v[72:75], v[192:195], v[224:227], v[72:75]
  v_mfma_f32_16x16x32_bf16 v[76:79], v[196:199], v[224:227], v[76:79]
  v_mfma_f32_16x16x32_bf16 v[80:83], v[200:203], v[224:227], v[80:83]
  v_mfma_f32_16x16x32_bf16 v[96:99], v[192:195], v[228:231], v[96:99]
  v_mfma_f32_16x16x32_bf16 v[100:103], v[196:199], v[228:231], v[100:103]
  v_mfma_f32_16x16x32_bf16 v[104:107], v[200:203], v[228:231], v[104:107]
  v_mfma_f32_16x16x32_bf16 v[120:123], v[192:195], v[232:235], v[120:123]
  v_mfma_f32_16x16x32_bf16 v[124:127], v[196:199], v[232:235], v[124:127]
  v_mfma_f32_16x16x32_bf16 v[128:131], v[200:203], v[232:235], v[128:131]
  buffer_store_dwordx4 v[36:39], v4, s[16:19], s63 offen offset:0 sc1
  buffer_store_dwordx4 v[40:43], v4, s[16:19], s63 offen offset:1024 sc1
  buffer_store_dwordx4 v[44:47], v4, s[16:19], s63 offen offset:2048 sc1
  buffer_store_dwordx4 v[48:51], v4, s[16:19], s63 offen offset:3072 sc1
  s_add_u32 s63, s63, 4096
  buffer_store_dwordx4 v[52:55], v4, s[16:19], s63 offen offset:0 sc1
  buffer_store_dwordx4 v[56:59], v4, s[16:19], s63 offen offset:1024 sc1
  buffer_store_dwordx4 v[60:63], v4, s[16:19], s63 offen offset:2048 sc1
  buffer_store_dwordx4 v[64:67], v4, s[16:19], s63 offen offset:3072 sc1
  s_add_u32 s63, s63, 4096
  buffer_store_dwordx4 v[68:71], v4, s[16:19], s63 offen offset:0 sc1
  buffer_store_dwordx4 v[72:75], v4, s[16:19], s63 offen offset:1024 sc1
  buffer_store_dwordx4 v[76:79], v4, s[16:19], s63 offen offset:2048 sc1
  buffer_store_dwordx4 v[80:83], v4, s[16:19], s63 offen offset:3072 sc1
  s_add_u32 s63, s63, 4096
  buffer_store_dwordx4 v[84:87], v4, s[16:19], s63 offen offset:0 sc1
  buffer_store_dwordx4 v[88:91], v4, s[16:19], s63 offen offset:1024 sc1
  buffer_store_dwordx4 v[92:95], v4, s[16:19], s63 offen offset:2048 sc1
  buffer_store_dwordx4 v[96:99], v4, s[16:19], s63 offen offset:3072 sc1
  s_add_u32 s63, s63, 4096
  buffer_store_dwordx4 v[100:103], v4, s[16:19], s63 offen offset:0 sc1
  buffer_store_dwordx4 v[104:107], v4, s[16:19], s63 offen offset:1024 sc1
  buffer_store_dwordx4 v[108:111], v4, s[16:19], s63 offen offset:2048 sc1
  buffer_store_dwordx4 v[112:115], v4, s[16:19], s63 offen offset:3072 sc1
  s_add_u32 s63, s63, 4096
  buffer_store_dwordx4 v[116:119], v4, s[16:19], s63 offen offset:0 sc1
  buffer_store_dwordx4 v[120:123], v4, s[16:19], s63 offen offset:1024 sc1
  buffer_store_dwordx4 v[124:127], v4, s[16:19], s63 offen offset:2048 sc1
  buffer_store_dwordx4 v[128:131], v4, s[16:19], s63 offen offset:3072 sc1
  s_add_u32 s63, s63, 4096
  v_mov_b32 v5, 0
  v_mov_b32 v6, 1
  s_waitcnt vmcnt(0)
  s_mov_b64 exec, 1
  buffer_store_dword v6, v5, s[16:19], s88 offen offset:128 sc1
  s_mov_b64 exec, -1
  s_branch FIN_7
NOG2_8:
  s_mov_b32 s4, s76
  s_and_b32 s5, s77, 0xffff
  s_mov_b32 s6, 18874368
  s_mov_b32 s7, 0x20000
  s_sub_u32 s21, s2, 192
  s_lshr_b32 s21, s21, 3
  s_mul_i32 s22, s20, 52
  s_add_u32 s21, s21, s22
  s_add_u32 s21, s21, 43
  s_lshl_b32 s21, s21, 16
  s_and_b32 s22, s2, 7
  s_lshl_b32 s22, s22, 9
  s_add_u32 s21, s21, s22
  v_lshrrev_b32 v5, 2, v1
  v_lshlrev_b32 v5, 12, v5
  v_and_b32 v6, 3, v1
  v_lshl_add_u32 v5, v6, 7, v5
  buffer_load_dword v9, v5, s[4:7], s21 offen
  s_add_u32 s21, s21, 196608
  s_waitcnt vmcnt(0)
  buffer_load_dword v9, v5, s[4:7], s21 offen
  s_add_u32 s21, s21, 196608
  s_waitcnt vmcnt(0)
  buffer_load_dword v9, v5, s[4:7], s21 offen
  s_add_u32 s21, s21, 196608
  s_waitcnt vmcnt(0)
  s_cmp_eq_u32 s20, 3
  s_cbranch_scc1 FIN_7
G2X_63:
  s_mov_b32 s52, s76
  s_and_b32 s53, s77, 0xffff
  s_mov_b32 s54, 18874368
  s_mov_b32 s55, 0x20000
  s_mov_b32 s56, s68
  s_and_b32 s57, s69, 0xffff
  s_mov_b32 s58, 663552
  s_mov_b32 s59, 0x20000
  s_mov_b32 s48, s82
  s_and_b32 s49, s83, 0xffff
  s_mov_b32 s50, 2359296
  s_mov_b32 s51, 0x20000
  s_bfe_u32 s22, s2, 0x20004
  s_bfe_u32 s39, s2, 0x10003
  s_mul_i32 s39, s39, 3
  s_add_u32 s39, s39, s20
  s_mov_b32 s23, 208
  s_mov_b32 s62, 512
  s_mov_b32 s90, 512
  s_mov_b32 s89, 0
  s_mov_b32 s94, 0
  s_mov_b32 s33, 2
  s_and_b32 s38, s2, 7
  s_lshl_b32 s38, s38, 2
  s_add_u32 s38, s38, s22
  s_mul_i32 s21, s39, 288
  s_add_u32 s21, s21, s23
  s_mul_i32 s40, s21, 3072
  s_add_u32 s40, s40, 2363392
  s_lshl_b32 s41, s23, 16
  s_lshl_b32 s21, s38, 7
  s_add_u32 s41, s41, s21
  s_lshl_b32 s21, s39, 10
  s_add_u32 s21, s21, 17388544
  s_add_u32 s62, s62, s21
  s_add_u32 s90, s90, s21
  s_mul_i32 s91, s89, 3072
  s_lshl_b32 s89, s89, 16
  s_mul_i32 s63, s38, 6
  s_add_u32 s63, s63, s39
  s_mul_i32 s63, s63, 24576
  s_add_u32 s63, s63, 17453056
  s_cmp_ge_u32 s39, 3
  s_cselect_b32 s21, 3, 0
  s_cselect_b32 s22, 8, 0
  s_sub_u32 s21, s39, s21
  s_lshl_b32 s21, s21, 2
  s_and_b32 s88, s38, 3
  s_lshl_b32 s88, s88, 4
  s_add_u32 s88, s88, s22
  s_lshr_b32 s22, s38, 2
  s_add_u32 s88, s88, s22
  s_lshl_b32 s88, s88, 8
  s_add_u32 s88, s88, s21
  s_add_u32 s88, s88, 17387584
  s_mul_i32 s42, s20, 20480
  v_lshrrev_b32 v5, 3, v1
  v_lshrrev_b32 v6, 4, v1
  v_lshlrev_b32 v6, 1, v6
  v_and_b32 v7, 7, v1
  v_xor_b32 v6, v6, v7
  v_lshlrev_b32 v5, 12, v5
  v_lshl_add_u32 v11, v6, 4, v5
  v_add_u32 v12, 31744, v11
  v_and_b32 v5, 15, v1
  v_bfe_u32 v6, v1, 4, 1
  v_lshlrev_b32 v6, 9, v6
  v_lshl_add_u32 v8, v5, 4, v6
  v_mul_u32_u24 v10, 3072, v2
  v_add_u32 v10, v10, v8
  v_lshl_add_u32 v33, v2, 10, v8
  v_bfe_u32 v5, v1, 2, 3
  v_lshl_add_u32 v6, v2, 4, v5
  v_and_b32 v7, 3, v1
  v_lshlrev_b32 v7, 3, v7
  v_add_u32 v7, s42, v7
  v_mul_u32_u24 v32, 192, v6
  v_add_u32 v32, v32, v7
  v_lshl_add_u32 v6, v6, 7, v7
  v_lshrrev_b32 v5, 1, v5
  v_xor_b32 v5, 0, v5
  v_xor_b32 v7, 0, v5
  v_lshl_add_u32 v13, v7, 5, v6
  v_xor_b32 v7, 1, v5
  v_lshl_add_u32 v14, v7, 5, v6
  v_xor_b32 v7, 2, v5
  v_lshl_add_u32 v15, v7, 5, v6
  v_xor_b32 v7, 3, v5
  v_lshl_add_u32 v16, v7, 5, v6
  v_mov_b32 v18, 1073741824
  v_mov_b32 v23, 1073741824
  v_mov_b32 v24, 1073741824
  v_mov_b32 v26, 1073741824
  v_mov_b32 v27, 1073741824
  v_mov_b32 v28, 1073741824
  v_mov_b32 v29, 1073741824
  v_mov_b32 v30, 1073741824
  v_mov_b32 v31, 1073741824
  s_add_u32 m0, s42, 0
  s_nop 0
  buffer_load_dwordx4 v11, s[52:55], s41 offen lds
  buffer_load_dwordx4 v12, s[52:55], s41 offen offset:1024 lds
  s_add_u32 s41, s41, 65536
  s_add_u32 m0, s42, 2048
  s_nop 0
  buffer_load_dwordx4 v11, s[52:55], s41 offen lds
  buffer_load_dwordx4 v12, s[52:55], s41 offen offset:1024 lds
  s_add_u32 s41, s41, 65536
  s_add_u32 m0, s42, 4096
  s_nop 0
  buffer_load_dwordx4 v11, s[52:55], s41 offen lds
  buffer_load_dwordx4 v12, s[52:55], s41 offen offset:1024 lds
  s_add_u32 s41, s41, 65536
  s_add_u32 m0, s42, 6144
  s_nop 0
  buffer_load_dwordx4 v11, s[52:55], s41 offen lds
  buffer_load_dwordx4 v12, s[52:55], s41 offen offset:1024 lds
  s_add_u32 s41, s41, 65536
  s_add_u32 m0, s42, 8192
  s_nop 0
  buffer_load_dwordx4 v11, s[52:55], s41 offen lds
  buffer_load_dwordx4 v12, s[52:55], s41 offen offset:1024 lds
  s_add_u32 s41, s41, 65536
  s_add_u32 m0, s42, 10240
  s_nop 0
  buffer_load_dwordx4 v11, s[52:55], s41 offen lds
  buffer_load_dwordx4 v12, s[52:55], s41 offen offset:1024 lds
  s_add_u32 s41, s41, 65536
  s_branch G2M_64
LN_3:
  s_sub_u32 s26, s2, 192
  s_lshl_b32 s21, s20, 3
  v_lshrrev_b32 v50, 3, v1
  v_add_u32 v50, s21, v50
  v_mul_u32_u24 v48, 1152, v50
  v_and_b32 v49, 7, v1
  v_lshlrev_b32 v49, 4, v49
  v_add_u32 v48, v48, v49
  s_mul_i32 s22, s26, 36864
  s_waitcnt lgkmcnt(0)
  s_mov_b32 s4, s64
  s_and_b32 s5, s65, 0xffff
  s_mov_b32 s6, 2359296
  s_mov_b32 s7, 0x20000
  buffer_load_dwordx4 v[12:15], v48, s[4:7], s22 offen offset:0
  buffer_load_dwordx4 v[16:19], v48, s[4:7], s22 offen offset:128
  buffer_load_dwordx4 v[20:23], v48, s[4:7], s22 offen offset:256
  buffer_load_dwordx4 v[24:27], v48, s[4:7], s22 offen offset:384
  buffer_load_dwordx4 v[28:31], v48, s[4:7], s22 offen offset:512
  buffer_load_dwordx4 v[32:35], v48, s[4:7], s22 offen offset:640
  buffer_load_dwordx4 v[36:39], v48, s[4:7], s22 offen offset:768
  buffer_load_dwordx4 v[40:43], v48, s[4:7], s22 offen offset:896
  buffer_load_dwordx4 v[44:47], v48, s[4:7], s22 offen offset:1024
  s_mov_b32 s16, s86
  s_and_b32 s17, s87, 0xffff
  s_mov_b32 s18, 22171648
  s_mov_b32 s19, 0x20000
  s_mov_b32 s12, s84
  s_and_b32 s13, s85, 0xffff
  s_mov_b32 s14, 256
  s_mov_b32 s15, 0x20000
  v_mul_u32_u24 v240, 1216, v50
  v_add_u32 v240, v240, v49
  v_bfe_u32 v6, v1, 2, 2
  v_lshl_add_u32 v6, v2, 3, v6
  v_mul_u32_u24 v241, 1216, v6
  v_bfe_u32 v6, v1, 4, 1
  v_lshl_add_u32 v241, v6, 5, v241
  v_and_b32 v6, 3, v1
  v_lshl_add_u32 v241, v6, 3, v241
  s_and_b32 s21, s20, 1
  s_mul_i32 s22, s21, 19456
  s_lshr_b32 s24, s20, 1
  s_lshl_b32 s25, s24, 6
  s_add_u32 s22, s22, s25
  v_add_u32 v241, s22, v241
  s_lshl_b32 s23, s26, 1
  s_add_u32 s23, s23, s21
  s_mul_i32 s23, s23, 3072
  s_add_u32 s23, s23, 4096
  s_cmp_eq_u32 s24, 0
  s_mov_b32 s27, 1024
  s_cselect_b32 s27, 0, s27
  s_add_u32 s28, s27, s23
  s_cmp_eq_u32 s24, 0
  s_mov_b32 s27, 393216
  s_cselect_b32 s27, 2048, s27
  s_add_u32 s29, s27, s23
  s_cmp_eq_u32 s24, 0
  s_mov_b32 s27, 395264
  s_cselect_b32 s27, 394240, s27
  s_add_u32 s30, s27, s23
  s_cmp_eq_u32 s24, 0
  s_mov_b32 s27, 787456
  s_cselect_b32 s27, 786432, s27
  s_add_u32 s31, s27, s23
  s_cmp_eq_u32 s24, 0
  s_mov_b32 s27, 1179648
  s_cselect_b32 s27, 788480, s27
  s_add_u32 s32, s27, s23
  s_cmp_eq_u32 s24, 0
  s_mov_b32 s27, 1181696
  s_cselect_b32 s27, 1180672, s27
  s_add_u32 s33, s27, s23
  s_cmp_eq_u32 s24, 0
  s_mov_b32 s27, 1573888
  s_cselect_b32 s27, 1572864, s27
  s_add_u32 s34, s27, s23
  s_cmp_eq_u32 s24, 0
  s_mov_b32 s27, 1966080
  s_cselect_b32 s27, 1574912, s27
  s_add_u32 s35, s27, s23
  s_cmp_eq_u32 s24, 0
  s_mov_b32 s27, 1968128
  s_cselect_b32 s27, 1967104, s27
  s_add_u32 s36, s27, s23
  s_waitcnt vmcnt(0)
  v_lshlrev_b32 v52, 16, v12
  v_and_b32 v53, 0xffff0000, v12
  v_lshlrev_b32 v54, 16, v13
  v_and_b32 v55, 0xffff0000, v13
  v_lshlrev_b32 v56, 16, v14
  v_and_b32 v57, 0xffff0000, v14
  v_lshlrev_b32 v58, 16, v15
  v_and_b32 v59, 0xffff0000, v15
  v_lshlrev_b32 v60, 16, v16
  v_and_b32 v61, 0xffff0000, v16
  v_lshlrev_b32 v62, 16, v17
  v_and_b32 v63, 0xffff0000, v17
  v_lshlrev_b32 v64, 16, v18
  v_and_b32 v65, 0xffff0000, v18
  v_lshlrev_b32 v66, 16, v19
  v_and_b32 v67, 0xffff0000, v19
  v_lshlrev_b32 v68, 16, v20
  v_and_b32 v69, 0xffff0000, v20
  v_lshlrev_b32 v70, 16, v21
  v_and_b32 v71, 0xffff0000, v21
  v_lshlrev_b32 v72, 16, v22
  v_and_b32 v73, 0xffff0000, v22
  v_lshlrev_b32 v74, 16, v23
  v_and_b32 v75, 0xffff0000, v23
  v_lshlrev_b32 v76, 16, v24
  v_and_b32 v77, 0xffff0000, v24
  v_lshlrev_b32 v78, 16, v25
  v_and_b32 v79, 0xffff0000, v25
  v_lshlrev_b32 v80, 16, v26
  v_and_b32 v81, 0xffff0000, v26
  v_lshlrev_b32 v82, 16, v27
  v_and_b32 v83, 0xffff0000, v27
  v_lshlrev_b32 v84, 16, v28
  v_and_b32 v85, 0xffff0000, v28
  v_lshlrev_b32 v86, 16, v29
  v_and_b32 v87, 0xffff0000, v29
  v_lshlrev_b32 v88, 16, v30
  v_and_b32 v89, 0xffff0000, v30
  v_lshlrev_b32 v90, 16, v31
  v_and_b32 v91, 0xffff0000, v31
  v_lshlrev_b32 v92, 16, v32
  v_and_b32 v93, 0xffff0000, v32
  v_lshlrev_b32 v94, 16, v33
  v_and_b32 v95, 0xffff0000, v33
  v_lshlrev_b32 v96, 16, v34
  v_and_b32 v97, 0xffff0000, v34
  v_lshlrev_b32 v98, 16, v35
  v_and_b32 v99, 0xffff0000, v35
  v_lshlrev_b32 v100, 16, v36
  v_and_b32 v101, 0xffff0000, v36
  v_lshlrev_b32 v102, 16, v37
  v_and_b32 v103, 0xffff0000, v37
  v_lshlrev_b32 v104, 16, v38
  v_and_b32 v105, 0xffff0000, v38
  v_lshlrev_b32 v106, 16, v39
  v_and_b32 v107, 0xffff0000, v39
  v_lshlrev_b32 v108, 16, v40
  v_and_b32 v109, 0xffff0000, v40
  v_lshlrev_b32 v110, 16, v41
  v_and_b32 v111, 0xffff0000, v41
  v_lshlrev_b32 v112, 16, v42
  v_and_b32 v113, 0xffff0000, v42
  v_lshlrev_b32 v114, 16, v43
  v_and_b32 v115, 0xffff0000, v43
  v_lshlrev_b32 v116, 16, v44
  v_and_b32 v117, 0xffff0000, v44
  v_lshlrev_b32 v118, 16, v45
  v_and_b32 v119, 0xffff0000, v45
  v_lshlrev_b32 v120, 16, v46
  v_and_b32 v121, 0xffff0000, v46
  v_lshlrev_b32 v122, 16, v47
  v_and_b32 v123, 0xffff0000, v47
  v_pk_add_f32 v[196:197], v[52:53], v[54:55]
  v_pk_add_f32 v[198:199], v[56:57], v[58:59]
  v_pk_add_f32 v[196:197], v[196:197], v[60:61]
  v_pk_add_f32 v[198:199], v[198:199], v[62:63]
  v_pk_add_f32 v[196:197], v[196:197], v[64:65]
  v_pk_add_f32 v[198:199], v[198:199], v[66:67]
  v_pk_add_f32 v[196:197], v[196:197], v[68:69]
  v_pk_add_f32 v[198:199], v[198:199], v[70:71]
  v_pk_add_f32 v[196:197], v[196:197], v[72:73]
  v_pk_add_f32 v[198:199], v[198:199], v[74:75]
  v_pk_add_f32 v[196:197], v[196:197], v[76:77]
  v_pk_add_f32 v[198:199], v[198:199], v[78:79]
  v_pk_add_f32 v[196:197], v[196:197], v[80:81]
  v_pk_add_f32 v[198:199], v[198:199], v[82:83]
  v_pk_add_f32 v[196:197], v[196:197], v[84:85]
  v_pk_add_f32 v[198:199], v[198:199], v[86:87]
  v_pk_add_f32 v[196:197], v[196:197], v[88:89]
  v_pk_add_f32 v[198:199], v[198:199], v[90:91]
  v_pk_add_f32 v[196:197], v[196:197], v[92:93]
  v_pk_add_f32 v[198:199], v[198:199], v[94:95]
  v_pk_add_f32 v[196:197], v[196:197], v[96:97]
  v_pk_add_f32 v[198:199], v[198:199], v[98:99]
  v_pk_add_f32 v[196:197], v[196:197], v[100:101]
  v_pk_add_f32 v[198:199], v[198:199], v[102:103]
  v_pk_add_f32 v[196:197], v[196:197], v[104:105]
  v_pk_add_f32 v[198:199], v[198:199], v[106:107]
  v_pk_add_f32 v[196:197], v[196:197], v[108:109]
  v_pk_add_f32 v[198:199], v[198:199], v[110:111]
  v_pk_add_f32 v[196:197], v[196:197], v[112:113]
  v_pk_add_f32 v[198:199], v[198:199], v[114:115]
  v_pk_add_f32 v[196:197], v[196:197], v[116:117]
  v_pk_add_f32 v[198:199], v[198:199], v[118:119]
  v_pk_add_f32 v[196:197], v[196:197], v[120:121]
  v_pk_add_f32 v[198:199], v[198:199], v[122:123]
  v_pk_add_f32 v[196:197], v[196:197], v[198:199]
  v_add_f32 v196, v196, v197
  s_nop 1
  v_add_f32_dpp v196, v196, v196 quad_perm:[1,0,3,2] row_mask:0xf bank_mask:0xf
  s_nop 1
  v_add_f32_dpp v196, v196, v196 quad_perm:[2,3,0,1] row_mask:0xf bank_mask:0xf
  s_nop 1
  v_add_f32_dpp v196, v196, v196 row_half_mirror row_mask:0xf bank_mask:0xf
  v_mul_f32 v200, 0xbae38e39, v196
  v_mov_b32 v201, v200
  v_pk_add_f32 v[124:125], v[52:53], v[200:201]
  v_pk_add_f32 v[126:127], v[54:55], v[200:201]
  v_pk_add_f32 v[128:129], v[56:57], v[200:201]
  v_pk_add_f32 v[130:131], v[58:59], v[200:201]
  v_pk_add_f32 v[132:133], v[60:61], v[200:201]
  v_pk_add_f32 v[134:135], v[62:63], v[200:201]
  v_pk_add_f32 v[136:137], v[64:65], v[200:201]
  v_pk_add_f32 v[138:139], v[66:67], v[200:201]
  v_pk_add_f32 v[140:141], v[68:69], v[200:201]
  v_pk_add_f32 v[142:143], v[70:71], v[200:201]
  v_pk_add_f32 v[144:145], v[72:73], v[200:201]
  v_pk_add_f32 v[146:147], v[74:75], v[200:201]
  v_pk_add_f32 v[148:149], v[76:77], v[200:201]
  v_pk_add_f32 v[150:151], v[78:79], v[200:201]
  v_pk_add_f32 v[152:153], v[80:81], v[200:201]
  v_pk_add_f32 v[154:155], v[82:83], v[200:201]
  v_pk_add_f32 v[156:157], v[84:85], v[200:201]
  v_pk_add_f32 v[158:159], v[86:87], v[200:201]
  v_pk_add_f32 v[160:161], v[88:89], v[200:201]
  v_pk_add_f32 v[162:163], v[90:91], v[200:201]
  v_pk_add_f32 v[164:165], v[92:93], v[200:201]
  v_pk_add_f32 v[166:167], v[94:95], v[200:201]
  v_pk_add_f32 v[168:169], v[96:97], v[200:201]
  v_pk_add_f32 v[170:171], v[98:99], v[200:201]
  v_pk_add_f32 v[172:173], v[100:101], v[200:201]
  v_pk_add_f32 v[174:175], v[102:103], v[200:201]
  v_pk_add_f32 v[176:177], v[104:105], v[200:201]
  v_pk_add_f32 v[178:179], v[106:107], v[200:201]
  v_pk_add_f32 v[180:181], v[108:109], v[200:201]
  v_pk_add_f32 v[182:183], v[110:111], v[200:201]
  v_pk_add_f32 v[184:185], v[112:113], v[200:201]
  v_pk_add_f32 v[186:187], v[114:115], v[200:201]
  v_pk_add_f32 v[188:189], v[116:117], v[200:201]
  v_pk_add_f32 v[190:191], v[118:119], v[200:201]
  v_pk_add_f32 v[192:193], v[120:121], v[200:201]
  v_pk_add_f32 v[194:195], v[122:123], v[200:201]
  v_pk_mul_f32 v[196:197], v[124:125], v[124:125]
  v_pk_mul_f32 v[198:199], v[126:127], v[126:127]
  v_pk_fma_f32 v[196:197], v[128:129], v[128:129], v[196:197]
  v_pk_fma_f32 v[198:199], v[130:131], v[130:131], v[198:199]
  v_pk_fma_f32 v[196:197], v[132:133], v[132:133], v[196:197]
  v_pk_fma_f32 v[198:199], v[134:135], v[134:135], v[198:199]
  v_pk_fma_f32 v[196:197], v[136:137], v[136:137], v[196:197]
  v_pk_fma_f32 v[198:199], v[138:139], v[138:139], v[198:199]
  v_pk_fma_f32 v[196:197], v[140:141], v[140:141], v[196:197]
  v_pk_fma_f32 v[198:199], v[142:143], v[142:143], v[198:199]
  v_pk_fma_f32 v[196:197], v[144:145], v[144:145], v[196:197]
  v_pk_fma_f32 v[198:199], v[146:147], v[146:147], v[198:199]
  v_pk_fma_f32 v[196:197], v[148:149], v[148:149], v[196:197]
  v_pk_fma_f32 v[198:199], v[150:151], v[150:151], v[198:199]
  v_pk_fma_f32 v[196:197], v[152:153], v[152:153], v[196:197]
  v_pk_fma_f32 v[198:199], v[154:155], v[154:155], v[198:199]
  v_pk_fma_f32 v[196:197], v[156:157], v[156:157], v[196:197]
  v_pk_fma_f32 v[198:199], v[158:159], v[158:159], v[198:199]
  v_pk_fma_f32 v[196:197], v[160:161], v[160:161], v[196:197]
  v_pk_fma_f32 v[198:199], v[162:163], v[162:163], v[198:199]
  v_pk_fma_f32 v[196:197], v[164:165], v[164:165], v[196:197]
  v_pk_fma_f32 v[198:199], v[166:167], v[166:167], v[198:199]
  v_pk_fma_f32 v[196:197], v[168:169], v[168:169], v[196:197]
  v_pk_fma_f32 v[198:199], v[170:171], v[170:171], v[198:199]
  v_pk_fma_f32 v[196:197], v[172:173], v[172:173], v[196:197]
  v_pk_fma_f32 v[198:199], v[174:175], v[174:175], v[198:199]
  v_pk_fma_f32 v[196:197], v[176:177], v[176:177], v[196:197]
  v_pk_fma_f32 v[198:199], v[178:179], v[178:179], v[198:199]
  v_pk_fma_f32 v[196:197], v[180:181], v[180:181], v[196:197]
  v_pk_fma_f32 v[198:199], v[182:183], v[182:183], v[198:199]
  v_pk_fma_f32 v[196:197], v[184:185], v[184:185], v[196:197]
  v_pk_fma_f32 v[198:199], v[186:187], v[186:187], v[198:199]
  v_pk_fma_f32 v[196:197], v[188:189], v[188:189], v[196:197]
  v_pk_fma_f32 v[198:199], v[190:191], v[190:191], v[198:199]
  v_pk_fma_f32 v[196:197], v[192:193], v[192:193], v[196:197]
  v_pk_fma_f32 v[198:199], v[194:195], v[194:195], v[198:199]
  v_cvt_pk_bf16_f32 v200, v200, v200
  v_and_b32 v200, 0xffff0000, v200
  v_pk_add_f32 v[196:197], v[196:197], v[198:199]
  v_add_f32 v196, v196, v197
  s_nop 1
  v_add_f32_dpp v196, v196, v196 quad_perm:[1,0,3,2] row_mask:0xf bank_mask:0xf
  s_nop 1
  v_add_f32_dpp v196, v196, v196 quad_perm:[2,3,0,1] row_mask:0xf bank_mask:0xf
  s_nop 1
  v_add_f32_dpp v196, v196, v196 row_half_mirror row_mask:0xf bank_mask:0xf
  v_mul_f32 v196, 0x3ae38e39, v196
  v_cvt_pk_bf16_f32 v196, v196, v196
  v_and_b32 v196, 0xffff0000, v196
  v_add_f32 v196, 0x3727c5ac, v196
  v_cvt_pk_bf16_f32 v196, v196, v196
  v_and_b32 v196, 0xffff0000, v196
  v_sqrt_f32 v196, v196
  s_nop 0
  v_cvt_pk_bf16_f32 v196, v196, v196
  v_and_b32 v196, 0xffff0000, v196
  v_rcp_f32 v202, v196
  s_nop 0
  v_mul_f32 v200, v200, v202
  v_mov_b32 v203, v202
  v_mov_b32 v201, v200
  v_pk_fma_f32 v[124:125], v[52:53], v[202:203], v[200:201]
  v_pk_fma_f32 v[126:127], v[54:55], v[202:203], v[200:201]
  v_pk_fma_f32 v[128:129], v[56:57], v[202:203], v[200:201]
  v_pk_fma_f32 v[130:131], v[58:59], v[202:203], v[200:201]
  v_cvt_pk_bf16_f32 v204, v124, v125
  v_cvt_pk_bf16_f32 v205, v126, v127
  v_cvt_pk_bf16_f32 v206, v128, v129
  v_cvt_pk_bf16_f32 v207, v130, v131
  ds_write_b128 v240, v[204:207] offset:0
  v_pk_fma_f32 v[132:133], v[60:61], v[202:203], v[200:201]
  v_pk_fma_f32 v[134:135], v[62:63], v[202:203], v[200:201]
  v_pk_fma_f32 v[136:137], v[64:65], v[202:203], v[200:201]
  v_pk_fma_f32 v[138:139], v[66:67], v[202:203], v[200:201]
  v_cvt_pk_bf16_f32 v208, v132, v133
  v_cvt_pk_bf16_f32 v209, v134, v135
  v_cvt_pk_bf16_f32 v210, v136, v137
  v_cvt_pk_bf16_f32 v211, v138, v139
  ds_write_b128 v240, v[208:211] offset:128
  v_pk_fma_f32 v[140:141], v[68:69], v[202:203], v[200:201]
  v_pk_fma_f32 v[142:143], v[70:71], v[202:203], v[200:201]
  v_pk_fma_f32 v[144:145], v[72:73], v[202:203], v[200:201]
  v_pk_fma_f32 v[146:147], v[74:75], v[202:203], v[200:201]
  v_cvt_pk_bf16_f32 v212, v140, v141
  v_cvt_pk_bf16_f32 v213, v142, v143
  v_cvt_pk_bf16_f32 v214, v144, v145
  v_cvt_pk_bf16_f32 v215, v146, v147
  ds_write_b128 v240, v[212:215] offset:256
  v_pk_fma_f32 v[148:149], v[76:77], v[202:203], v[200:201]
  v_pk_fma_f32 v[150:151], v[78:79], v[202:203], v[200:201]
  v_pk_fma_f32 v[152:153], v[80:81], v[202:203], v[200:201]
  v_pk_fma_f32 v[154:155], v[82:83], v[202:203], v[200:201]
  v_cvt_pk_bf16_f32 v216, v148, v149
  v_cvt_pk_bf16_f32 v217, v150, v151
  v_cvt_pk_bf16_f32 v218, v152, v153
  v_cvt_pk_bf16_f32 v219, v154, v155
  ds_write_b128 v240, v[216:219] offset:384
  v_pk_fma_f32 v[156:157], v[84:85], v[202:203], v[200:201]
  v_pk_fma_f32 v[158:159], v[86:87], v[202:203], v[200:201]
  v_pk_fma_f32 v[160:161], v[88:89], v[202:203], v[200:201]
  v_pk_fma_f32 v[162:163], v[90:91], v[202:203], v[200:201]
  v_cvt_pk_bf16_f32 v220, v156, v157
  v_cvt_pk_bf16_f32 v221, v158, v159
  v_cvt_pk_bf16_f32 v222, v160, v161
  v_cvt_pk_bf16_f32 v223, v162, v163
  ds_write_b128 v240, v[220:223] offset:512
  v_pk_fma_f32 v[164:165], v[92:93], v[202:203], v[200:201]
  v_pk_fma_f32 v[166:167], v[94:95], v[202:203], v[200:201]
  v_pk_fma_f32 v[168:169], v[96:97], v[202:203], v[200:201]
  v_pk_fma_f32 v[170:171], v[98:99], v[202:203], v[200:201]
  v_cvt_pk_bf16_f32 v224, v164, v165
  v_cvt_pk_bf16_f32 v225, v166, v167
  v_cvt_pk_bf16_f32 v226, v168, v169
  v_cvt_pk_bf16_f32 v227, v170, v171
  ds_write_b128 v240, v[224:227] offset:640
  v_pk_fma_f32 v[172:173], v[100:101], v[202:203], v[200:201]
  v_pk_fma_f32 v[174:175], v[102:103], v[202:203], v[200:201]
  v_pk_fma_f32 v[176:177], v[104:105], v[202:203], v[200:201]
  v_pk_fma_f32 v[178:179], v[106:107], v[202:203], v[200:201]
  v_cvt_pk_bf16_f32 v228, v172, v173
  v_cvt_pk_bf16_f32 v229, v174, v175
  v_cvt_pk_bf16_f32 v230, v176, v177
  v_cvt_pk_bf16_f32 v231, v178, v179
  ds_write_b128 v240, v[228:231] offset:768
  v_pk_fma_f32 v[180:181], v[108:109], v[202:203], v[200:201]
  v_pk_fma_f32 v[182:183], v[110:111], v[202:203], v[200:201]
  v_pk_fma_f32 v[184:185], v[112:113], v[202:203], v[200:201]
  v_pk_fma_f32 v[186:187], v[114:115], v[202:203], v[200:201]
  v_cvt_pk_bf16_f32 v232, v180, v181
  v_cvt_pk_bf16_f32 v233, v182, v183
  v_cvt_pk_bf16_f32 v234, v184, v185
  v_cvt_pk_bf16_f32 v235, v186, v187
  ds_write_b128 v240, v[232:235] offset:896
  v_pk_fma_f32 v[188:189], v[116:117], v[202:203], v[200:201]
  v_pk_fma_f32 v[190:191], v[118:119], v[202:203], v[200:201]
  v_pk_fma_f32 v[192:193], v[120:121], v[202:203], v[200:201]
  v_pk_fma_f32 v[194:195], v[122:123], v[202:203], v[200:201]
  v_cvt_pk_bf16_f32 v236, v188, v189
  v_cvt_pk_bf16_f32 v237, v190, v191
  v_cvt_pk_bf16_f32 v238, v192, v193
  v_cvt_pk_bf16_f32 v239, v194, v195
  ds_write_b128 v240, v[236:239] offset:1024
  s_waitcnt lgkmcnt(0)
  s_barrier
  ds_read_b64_tr_b16 v[52:53], v241 offset:0
  ds_read_b64_tr_b16 v[54:55], v241 offset:4864
  ds_read_b64_tr_b16 v[56:57], v241 offset:128
  ds_read_b64_tr_b16 v[58:59], v241 offset:4992
  ds_read_b64_tr_b16 v[60:61], v241 offset:256
  ds_read_b64_tr_b16 v[62:63], v241 offset:5120
  ds_read_b64_tr_b16 v[64:65], v241 offset:384
  ds_read_b64_tr_b16 v[66:67], v241 offset:5248
  ds_read_b64_tr_b16 v[68:69], v241 offset:512
  ds_read_b64_tr_b16 v[70:71], v241 offset:5376
  ds_read_b64_tr_b16 v[72:73], v241 offset:640
  ds_read_b64_tr_b16 v[74:75], v241 offset:5504
  ds_read_b64_tr_b16 v[76:77], v241 offset:768
  ds_read_b64_tr_b16 v[78:79], v241 offset:5632
  s_waitcnt lgkmcnt(12)
  buffer_store_dwordx4 v[52:55], v4, s[16:19], s28 offen sc1
  ds_read_b64_tr_b16 v[80:81], v241 offset:896
  ds_read_b64_tr_b16 v[82:83], v241 offset:5760
  s_waitcnt lgkmcnt(12)
  buffer_store_dwordx4 v[56:59], v4, s[16:19], s29 offen sc1
  ds_read_b64_tr_b16 v[84:85], v241 offset:1024
  ds_read_b64_tr_b16 v[86:87], v241 offset:5888
  s_waitcnt lgkmcnt(12)
  buffer_store_dwordx4 v[60:63], v4, s[16:19], s30 offen sc1
  s_waitcnt lgkmcnt(10)
  buffer_store_dwordx4 v[64:67], v4, s[16:19], s31 offen sc1
  s_waitcnt lgkmcnt(8)
  buffer_store_dwordx4 v[68:71], v4, s[16:19], s32 offen sc1
  s_waitcnt lgkmcnt(6)
  buffer_store_dwordx4 v[72:75], v4, s[16:19], s33 offen sc1
  s_waitcnt lgkmcnt(4)
  buffer_store_dwordx4 v[76:79], v4, s[16:19], s34 offen sc1
  s_waitcnt lgkmcnt(2)
  buffer_store_dwordx4 v[80:83], v4, s[16:19], s35 offen sc1
  s_waitcnt lgkmcnt(0)
  buffer_store_dwordx4 v[84:87], v4, s[16:19], s36 offen sc1
  s_waitcnt vmcnt(0)
  s_barrier
  s_cmp_lg_u32 s20, 0
  s_cbranch_scc1 SIG_87
  v_mov_b32 v5, 0
  v_mov_b32 v6, 1
  v_mov_b32 v7, 1
  s_mov_b64 exec, 1
  buffer_atomic_add v6, v5, s[12:15], 0 offen sc0 sc1
  s_waitcnt vmcnt(0)
  v_readfirstlane_b32 s43, v6
  s_nop 0
  s_cmp_lg_u32 s43, 63
  s_cbranch_scc1 SIGR_88
  buffer_store_dword v7, v5, s[12:15], 0 offen offset:128 sc1
SIGR_88:
  s_mov_b64 exec, -1
SIG_87:
  s_cmp_lt_u32 s2, 216
  s_cbranch_scc1 G1_4
HELP_6:
  s_sub_u32 s23, s2, 216
  s_lshr_b32 s23, s23, 3
  s_cmp_eq_u32 s20, 3
  s_cbranch_scc1 HW3_89
  s_mul_i32 s23, s23, 3
  s_add_u32 s23, s23, s20
  s_mov_b32 s4, s72
  s_and_b32 s5, s73, 0xffff
  s_mov_b32 s6, 18874368
  s_mov_b32 s7, 0x20000
  s_and_b32 s24, s2, 7
  s_lshl_b32 s24, s24, 10
  s_bfe_u32 s28, s2, 0x20001
  s_lshl_b32 s28, s28, 8
  s_add_u32 s28, s28, 8192
  v_lshrrev_b32 v5, 1, v1
  v_mul_u32_u24 v5, 9216, v5
  v_and_b32 v6, 1, v1
  v_lshl_add_u32 v5, v6, 7, v5
  s_mov_b32 s8, s76
  s_and_b32 s9, s77, 0xffff
  s_mov_b32 s10, 18874368
  s_mov_b32 s11, 0x20000
  v_lshrrev_b32 v7, 2, v1
  v_lshlrev_b32 v7, 12, v7
  v_and_b32 v6, 3, v1
  v_lshl_add_u32 v7, v6, 7, v7
  s_and_b32 s26, s2, 7
  s_lshl_b32 s26, s26, 9
  s_mul_i32 s21, s23, 205
  s_lshr_b32 s21, s21, 10
  s_mul_i32 s22, s21, 5
  s_sub_u32 s22, s23, s22
  s_mul_i32 s22, s22, 52
  s_add_u32 s21, s21, s22
  s_lshl_b32 s21, s21, 16
  s_add_u32 s30, s21, s26
  s_mov_b32 s31, 11
  s_add_u32 s25, s23, 64
HW1_90:
  s_mul_i32 s21, s25, 205
  s_lshr_b32 s21, s21, 10
  s_mul_i32 s22, s21, 5
  s_sub_u32 s22, s25, s22
  s_lshl_b32 s22, s22, 8
  s_add_u32 s29, s22, s24
  s_cmp_eq_u32 s22, 1024
  s_cselect_b32 s22, s28, s29
  s_mul_i32 s21, s21, 294912
  s_add_u32 s21, s21, s22
  buffer_load_dword v9, v5, s[4:7], s21 offen
  s_waitcnt vmcnt(1)
  s_add_u32 s25, s25, 15
  s_cmp_lt_u32 s25, 320
  s_cbranch_scc1 HW1_90
  s_add_u32 s21, s23, 273
  s_lshl_b32 s21, s21, 16
  s_add_u32 s21, s21, s26
  buffer_load_dword v9, v7, s[8:11], s21 offen
  s_waitcnt vmcnt(1)
  s_add_u32 s21, s23, 258
  s_lshl_b32 s21, s21, 16
  s_add_u32 s21, s21, s26
  buffer_load_dword v9, v7, s[8:11], s21 offen
  s_waitcnt vmcnt(1)
  s_add_u32 s21, s23, 243
  s_lshl_b32 s21, s21, 16
  s_add_u32 s21, s21, s26
  buffer_load_dword v9, v7, s[8:11], s21 offen
  s_waitcnt vmcnt(1)
  s_add_u32 s21, s23, 228
  s_lshl_b32 s21, s21, 16
  s_add_u32 s21, s21, s26
  buffer_load_dword v9, v7, s[8:11], s21 offen
  s_waitcnt vmcnt(1)
  s_cmp_eq_u32 s31, 0
  s_cbranch_scc1 HW2E_93
HW2_91:
  buffer_load_dword v9, v7, s[8:11], s30 offen
  s_add_u32 s30, s30, 196608
  s_waitcnt vmcnt(1)
  s_sub_u32 s31, s31, 1
  s_cmp_lg_u32 s31, 0
  s_cbranch_scc1 HW2_91
HW2E_93:
  v_mov_b32 v7, 4
  s_mov_b32 s22, 0x20000
POLL_94:
  buffer_load_dword v8, v7, s[12:15], 0 offen offset:128 sc1
  s_waitcnt vmcnt(0)
  v_cmp_ne_u32 vcc, 1, v8
  s_nop 4
  s_cbranch_vccz POLLD_95
  s_sleep 2
  s_sub_u32 s22, s22, 1
  s_cmp_lg_u32 s22, 0
  s_cbranch_scc1 POLL_94
POLLD_95:
  s_branch G2X_63
HW3_89:
  s_mov_b32 s8, s68
  s_and_b32 s9, s69, 0xffff
  s_mov_b32 s10, 663552
  s_mov_b32 s11, 0x20000
  s_sub_u32 s21, s2, 216
  s_lshl_b32 s21, s21, 13
  v_lshlrev_b32 v5, 7, v1
  buffer_load_dword v9, v5, s[8:11], s21 offen
  s_add_u32 s21, s21, 327680
  s_waitcnt vmcnt(0)
  buffer_load_dword v9, v5, s[8:11], s21 offen
  s_add_u32 s21, s21, 327680
  s_waitcnt vmcnt(0)
  buffer_load_dword v9, v5, s[8:11], s21 offen
  s_add_u32 s21, s21, 327680
  s_waitcnt vmcnt(0)
  s_branch FIN_7
ROLEA_2:
  s_cmp_lt_u32 s2, 192
  s_cbranch_scc1 QKV_96
  s_sub_u32 s26, s2, 192
  s_setprio 1
  s_lshl_b32 s21, s20, 3
  v_lshrrev_b32 v50, 3, v1
  v_add_u32 v50, s21, v50
  v_mul_u32_u24 v48, 1152, v50
  v_and_b32 v49, 7, v1
  v_lshlrev_b32 v49, 4, v49
  v_add_u32 v48, v48, v49
  s_mul_i32 s22, s26, 36864
  s_waitcnt lgkmcnt(0)
  s_mov_b32 s4, s64
  s_and_b32 s5, s65, 0xffff
  s_mov_b32 s6, 2359296
  s_mov_b32 s7, 0x20000
  buffer_load_dwordx4 v[12:15], v48, s[4:7], s22 offen offset:0
  buffer_load_dwordx4 v[16:19], v48, s[4:7], s22 offen offset:128
  buffer_load_dwordx4 v[20:23], v48, s[4:7], s22 offen offset:256
  buffer_load_dwordx4 v[24:27], v48, s[4:7], s22 offen offset:384
  buffer_load_dwordx4 v[28:31], v48, s[4:7], s22 offen offset:512
  buffer_load_dwordx4 v[32:35], v48, s[4:7], s22 offen offset:640
  buffer_load_dwordx4 v[36:39], v48, s[4:7], s22 offen offset:768
  buffer_load_dwordx4 v[40:43], v48, s[4:7], s22 offen offset:896
  buffer_load_dwordx4 v[44:47], v48, s[4:7], s22 offen offset:1024
  s_mov_b32 s16, s86
  s_and_b32 s17, s87, 0xffff
  s_mov_b32 s18, 22171648
  s_mov_b32 s19, 0x20000
  s_mov_b32 s12, s84
  s_and_b32 s13, s85, 0xffff
  s_mov_b32 s14, 256
  s_mov_b32 s15, 0x20000
  s_mov_b32 s8, s80
  s_and_b32 s9, s81, 0xffff
  s_mov_b32 s10, 1152
  s_mov_b32 s11, 0x20000
  buffer_load_dwordx4 v[52:55], v49, s[8:11], 0 offen offset:0
  buffer_load_dwordx4 v[56:59], v49, s[8:11], 0 offen offset:128
  buffer_load_dwordx4 v[60:63], v49, s[8:11], 0 offen offset:256
  buffer_load_dwordx4 v[64:67], v49, s[8:11], 0 offen offset:384
  buffer_load_dwordx4 v[68:71], v49, s[8:11], 0 offen offset:512
  buffer_load_dwordx4 v[72:75], v49, s[8:11], 0 offen offset:640
  buffer_load_dwordx4 v[76:79], v49, s[8:11], 0 offen offset:768
  buffer_load_dwordx4 v[80:83], v49, s[8:11], 0 offen offset:896
  buffer_load_dwordx4 v[84:87], v49, s[8:11], 0 offen offset:1024
  v_lshlrev_b32 v8, 3, v50
  s_lshl_b32 s27, s26, 8
  s_add_u32 s27, s27, 15011840
  s_waitcnt vmcnt(0)
  s_mov_b32 s4, s72
  s_and_b32 s5, s73, 0xffff
  s_mov_b32 s6, 18874368
  s_mov_b32 s7, 0x20000
  s_and_b32 s24, s2, 7
  s_lshl_b32 s24, s24, 10
  s_bfe_u32 s28, s2, 0x20001
  s_lshl_b32 s28, s28, 8
  s_add_u32 s28, s28, 8192
  v_lshrrev_b32 v5, 1, v1
  v_mul_u32_u24 v5, 9216, v5
  v_and_b32 v6, 1, v1
  v_lshl_add_u32 v5, v6, 7, v5
  s_lshr_b32 s25, s26, 3
  s_lshl_b32 s25, s25, 2
  s_add_u32 s25, s25, s20
  s_add_u32 s25, s25, 0
  s_mul_i32 s21, s25, 205
  s_lshr_b32 s21, s21, 10
  s_mul_i32 s22, s21, 5
  s_sub_u32 s22, s25, s22
  s_lshl_b32 s22, s22, 8
  s_add_u32 s29, s22, s24
  s_cmp_eq_u32 s22, 1024
  s_cselect_b32 s22, s28, s29
  s_mul_i32 s21, s21, 294912
  s_add_u32 s21, s21, s22
  buffer_load_dword v9, v5, s[4:7], s21 offen
  s_add_u32 s25, s25, 32
  s_waitcnt vmcnt(0)
  v_lshlrev_b32 v160, 16, v52
  v_and_b32 v161, 0xffff0000, v52
  v_lshlrev_b32 v162, 16, v53
  v_and_b32 v163, 0xffff0000, v53
  v_lshlrev_b32 v164, 16, v54
  v_and_b32 v165, 0xffff0000, v54
  v_lshlrev_b32 v166, 16, v55
  v_and_b32 v167, 0xffff0000, v55
  v_lshlrev_b32 v168, 16, v56
  v_and_b32 v169, 0xffff0000, v56
  v_lshlrev_b32 v170, 16, v57
  v_and_b32 v171, 0xffff0000, v57
  v_lshlrev_b32 v172, 16, v58
  v_and_b32 v173, 0xffff0000, v58
  v_lshlrev_b32 v174, 16, v59
  v_and_b32 v175, 0xffff0000, v59
  v_lshlrev_b32 v176, 16, v60
  v_and_b32 v177, 0xffff0000, v60
  v_lshlrev_b32 v178, 16, v61
  v_and_b32 v179, 0xffff0000, v61
  v_lshlrev_b32 v180, 16, v62
  v_and_b32 v181, 0xffff0000, v62
  v_lshlrev_b32 v182, 16, v63
  v_and_b32 v183, 0xffff0000, v63
  v_lshlrev_b32 v184, 16, v64
  v_and_b32 v185, 0xffff0000, v64
  v_lshlrev_b32 v186, 16, v65
  v_and_b32 v187, 0xffff0000, v65
  v_lshlrev_b32 v188, 16, v66
  v_and_b32 v189, 0xffff0000, v66
  v_lshlrev_b32 v190, 16, v67
  v_and_b32 v191, 0xffff0000, v67
  v_lshlrev_b32 v192, 16, v68
  v_and_b32 v193, 0xffff0000, v68
  v_lshlrev_b32 v194, 16, v69
  v_and_b32 v195, 0xffff0000, v69
  v_lshlrev_b32 v196, 16, v70
  v_and_b32 v197, 0xffff0000, v70
  v_lshlrev_b32 v198, 16, v71
  v_and_b32 v199, 0xffff0000, v71
  v_lshlrev_b32 v200, 16, v72
  v_and_b32 v201, 0xffff0000, v72
  v_lshlrev_b32 v202, 16, v73
  v_and_b32 v203, 0xffff0000, v73
  v_lshlrev_b32 v204, 16, v74
  v_and_b32 v205, 0xffff0000, v74
  v_lshlrev_b32 v206, 16, v75
  v_and_b32 v207, 0xffff0000, v75
  v_lshlrev_b32 v208, 16, v76
  v_and_b32 v209, 0xffff0000, v76
  v_lshlrev_b32 v210, 16, v77
  v_and_b32 v211, 0xffff0000, v77
  v_lshlrev_b32 v212, 16, v78
  v_and_b32 v213, 0xffff0000, v78
  v_lshlrev_b32 v214, 16, v79
  v_and_b32 v215, 0xffff0000, v79
  v_lshlrev_b32 v216, 16, v80
  v_and_b32 v217, 0xffff0000, v80
  v_lshlrev_b32 v218, 16, v81
  v_and_b32 v219, 0xffff0000, v81
  v_lshlrev_b32 v220, 16, v82
  v_and_b32 v221, 0xffff0000, v82
  v_lshlrev_b32 v222, 16, v83
  v_and_b32 v223, 0xffff0000, v83
  v_lshlrev_b32 v224, 16, v84
  v_and_b32 v225, 0xffff0000, v84
  v_lshlrev_b32 v226, 16, v85
  v_and_b32 v227, 0xffff0000, v85
  v_lshlrev_b32 v228, 16, v86
  v_and_b32 v229, 0xffff0000, v86
  v_lshlrev_b32 v230, 16, v87
  v_and_b32 v231, 0xffff0000, v87
  v_lshlrev_b32 v88, 16, v12
  v_and_b32 v89, 0xffff0000, v12
  v_lshlrev_b32 v90, 16, v13
  v_and_b32 v91, 0xffff0000, v13
  v_lshlrev_b32 v92, 16, v14
  v_and_b32 v93, 0xffff0000, v14
  v_lshlrev_b32 v94, 16, v15
  v_and_b32 v95, 0xffff0000, v15
  v_lshlrev_b32 v96, 16, v16
  v_and_b32 v97, 0xffff0000, v16
  v_lshlrev_b32 v98, 16, v17
  v_and_b32 v99, 0xffff0000, v17
  v_lshlrev_b32 v100, 16, v18
  v_and_b32 v101, 0xffff0000, v18
  v_lshlrev_b32 v102, 16, v19
  v_and_b32 v103, 0xffff0000, v19
  v_lshlrev_b32 v104, 16, v20
  v_and_b32 v105, 0xffff0000, v20
  v_lshlrev_b32 v106, 16, v21
  v_and_b32 v107, 0xffff0000, v21
  v_lshlrev_b32 v108, 16, v22
  v_and_b32 v109, 0xffff0000, v22
  v_lshlrev_b32 v110, 16, v23
  v_and_b32 v111, 0xffff0000, v23
  v_lshlrev_b32 v112, 16, v24
  v_and_b32 v113, 0xffff0000, v24
  v_lshlrev_b32 v114, 16, v25
  v_and_b32 v115, 0xffff0000, v25
  v_lshlrev_b32 v116, 16, v26
  v_and_b32 v117, 0xffff0000, v26
  v_lshlrev_b32 v118, 16, v27
  v_and_b32 v119, 0xffff0000, v27
  v_lshlrev_b32 v120, 16, v28
  v_and_b32 v121, 0xffff0000, v28
  v_lshlrev_b32 v122, 16, v29
  v_and_b32 v123, 0xffff0000, v29
  v_lshlrev_b32 v124, 16, v30
  v_and_b32 v125, 0xffff0000, v30
  v_lshlrev_b32 v126, 16, v31
  v_and_b32 v127, 0xffff0000, v31
  v_lshlrev_b32 v128, 16, v32
  v_and_b32 v129, 0xffff0000, v32
  v_lshlrev_b32 v130, 16, v33
  v_and_b32 v131, 0xffff0000, v33
  v_lshlrev_b32 v132, 16, v34
  v_and_b32 v133, 0xffff0000, v34
  v_lshlrev_b32 v134, 16, v35
  v_and_b32 v135, 0xffff0000, v35
  v_lshlrev_b32 v136, 16, v36
  v_and_b32 v137, 0xffff0000, v36
  v_lshlrev_b32 v138, 16, v37
  v_and_b32 v139, 0xffff0000, v37
  v_lshlrev_b32 v140, 16, v38
  v_and_b32 v141, 0xffff0000, v38
  v_lshlrev_b32 v142, 16, v39
  v_and_b32 v143, 0xffff0000, v39
  v_lshlrev_b32 v144, 16, v40
  v_and_b32 v145, 0xffff0000, v40
  v_lshlrev_b32 v146, 16, v41
  v_and_b32 v147, 0xffff0000, v41
  v_lshlrev_b32 v148, 16, v42
  v_and_b32 v149, 0xffff0000, v42
  v_lshlrev_b32 v150, 16, v43
  v_and_b32 v151, 0xffff0000, v43
  v_lshlrev_b32 v152, 16, v44
  v_and_b32 v153, 0xffff0000, v44
  v_lshlrev_b32 v154, 16, v45
  v_and_b32 v155, 0xffff0000, v45
  v_lshlrev_b32 v156, 16, v46
  v_and_b32 v157, 0xffff0000, v46
  v_lshlrev_b32 v158, 16, v47
  v_and_b32 v159, 0xffff0000, v47
  v_pk_mul_f32 v[88:89], v[88:89], v[160:161]
  v_pk_mul_f32 v[90:91], v[90:91], v[162:163]
  v_pk_mul_f32 v[92:93], v[92:93], v[164:165]
  v_pk_mul_f32 v[94:95], v[94:95], v[166:167]
  v_pk_mul_f32 v[96:97], v[96:97], v[168:169]
  v_pk_mul_f32 v[98:99], v[98:99], v[170:171]
  v_pk_mul_f32 v[100:101], v[100:101], v[172:173]
  v_pk_mul_f32 v[102:103], v[102:103], v[174:175]
  v_pk_mul_f32 v[104:105], v[104:105], v[176:177]
  v_pk_mul_f32 v[106:107], v[106:107], v[178:179]
  v_pk_mul_f32 v[108:109], v[108:109], v[180:181]
  v_pk_mul_f32 v[110:111], v[110:111], v[182:183]
  v_pk_mul_f32 v[112:113], v[112:113], v[184:185]
  v_pk_mul_f32 v[114:115], v[114:115], v[186:187]
  v_pk_mul_f32 v[116:117], v[116:117], v[188:189]
  v_pk_mul_f32 v[118:119], v[118:119], v[190:191]
  v_pk_mul_f32 v[120:121], v[120:121], v[192:193]
  v_pk_mul_f32 v[122:123], v[122:123], v[194:195]
  v_pk_mul_f32 v[124:125], v[124:125], v[196:197]
  v_pk_mul_f32 v[126:127], v[126:127], v[198:199]
  v_pk_mul_f32 v[128:129], v[128:129], v[200:201]
  v_pk_mul_f32 v[130:131], v[130:131], v[202:203]
  v_pk_mul_f32 v[132:133], v[132:133], v[204:205]
  v_pk_mul_f32 v[134:135], v[134:135], v[206:207]
  v_pk_mul_f32 v[136:137], v[136:137], v[208:209]
  v_pk_mul_f32 v[138:139], v[138:139], v[210:211]
  v_pk_mul_f32 v[140:141], v[140:141], v[212:213]
  v_pk_mul_f32 v[142:143], v[142:143], v[214:215]
  v_pk_mul_f32 v[144:145], v[144:145], v[216:217]
  v_pk_mul_f32 v[146:147], v[146:147], v[218:219]
  v_pk_mul_f32 v[148:149], v[148:149], v[220:221]
  v_pk_mul_f32 v[150:151], v[150:151], v[222:223]
  v_pk_mul_f32 v[152:153], v[152:153], v[224:225]
  v_pk_mul_f32 v[154:155], v[154:155], v[226:227]
  v_pk_mul_f32 v[156:157], v[156:157], v[228:229]
  v_pk_mul_f32 v[158:159], v[158:159], v[230:231]
  v_cvt_pk_bf16_f32 v12, v88, v89
  v_cvt_pk_bf16_f32 v13, v90, v91
  v_cvt_pk_bf16_f32 v14, v92, v93
  v_cvt_pk_bf16_f32 v15, v94, v95
  v_cvt_pk_bf16_f32 v16, v96, v97
  v_cvt_pk_bf16_f32 v17, v98, v99
  v_cvt_pk_bf16_f32 v18, v100, v101
  v_cvt_pk_bf16_f32 v19, v102, v103
  v_cvt_pk_bf16_f32 v20, v104, v105
  v_cvt_pk_bf16_f32 v21, v106, v107
  v_cvt_pk_bf16_f32 v22, v108, v109
  v_cvt_pk_bf16_f32 v23, v110, v111
  v_cvt_pk_bf16_f32 v24, v112, v113
  v_cvt_pk_bf16_f32 v25, v114, v115
  v_cvt_pk_bf16_f32 v26, v116, v117
  v_cvt_pk_bf16_f32 v27, v118, v119
  v_cvt_pk_bf16_f32 v28, v120, v121
  v_cvt_pk_bf16_f32 v29, v122, v123
  v_cvt_pk_bf16_f32 v30, v124, v125
  v_cvt_pk_bf16_f32 v31, v126, v127
  v_cvt_pk_bf16_f32 v32, v128, v129
  v_cvt_pk_bf16_f32 v33, v130, v131
  v_cvt_pk_bf16_f32 v34, v132, v133
  v_cvt_pk_bf16_f32 v35, v134, v135
  v_cvt_pk_bf16_f32 v36, v136, v137
  v_cvt_pk_bf16_f32 v37, v138, v139
  v_cvt_pk_bf16_f32 v38, v140, v141
  v_cvt_pk_bf16_f32 v39, v142, v143
  v_cvt_pk_bf16_f32 v40, v144, v145
  v_cvt_pk_bf16_f32 v41, v146, v147
  v_cvt_pk_bf16_f32 v42, v148, v149
  v_cvt_pk_bf16_f32 v43, v150, v151
  v_cvt_pk_bf16_f32 v44, v152, v153
  v_cvt_pk_bf16_f32 v45, v154, v155
  v_cvt_pk_bf16_f32 v46, v156, v157
  v_cvt_pk_bf16_f32 v47, v158, v159
  v_lshlrev_b32 v88, 16, v12
  v_and_b32 v89, 0xffff0000, v12
  v_lshlrev_b32 v90, 16, v13
  v_and_b32 v91, 0xffff0000, v13
  v_lshlrev_b32 v92, 16, v14
  v_and_b32 v93, 0xffff0000, v14
  v_lshlrev_b32 v94, 16, v15
  v_and_b32 v95, 0xffff0000, v15
  v_lshlrev_b32 v96, 16, v16
  v_and_b32 v97, 0xffff0000, v16
  v_lshlrev_b32 v98, 16, v17
  v_and_b32 v99, 0xffff0000, v17
  v_lshlrev_b32 v100, 16, v18
  v_and_b32 v101, 0xffff0000, v18
  v_lshlrev_b32 v102, 16, v19
  v_and_b32 v103, 0xffff0000, v19
  v_lshlrev_b32 v104, 16, v20
  v_and_b32 v105, 0xffff0000, v20
  v_lshlrev_b32 v106, 16, v21
  v_and_b32 v107, 0xffff0000, v21
  v_lshlrev_b32 v108, 16, v22
  v_and_b32 v109, 0xffff0000, v22
  v_lshlrev_b32 v110, 16, v23
  v_and_b32 v111, 0xffff0000, v23
  v_lshlrev_b32 v112, 16, v24
  v_and_b32 v113, 0xffff0000, v24
  v_lshlrev_b32 v114, 16, v25
  v_and_b32 v115, 0xffff0000, v25
  v_lshlrev_b32 v116, 16, v26
  v_and_b32 v117, 0xffff0000, v26
  v_lshlrev_b32 v118, 16, v27
  v_and_b32 v119, 0xffff0000, v27
  v_lshlrev_b32 v120, 16, v28
  v_and_b32 v121, 0xffff0000, v28
  v_lshlrev_b32 v122, 16, v29
  v_and_b32 v123, 0xffff0000, v29
  v_lshlrev_b32 v124, 16, v30
  v_and_b32 v125, 0xffff0000, v30
  v_lshlrev_b32 v126, 16, v31
  v_and_b32 v127, 0xffff0000, v31
  v_lshlrev_b32 v128, 16, v32
  v_and_b32 v129, 0xffff0000, v32
  v_lshlrev_b32 v130, 16, v33
  v_and_b32 v131, 0xffff0000, v33
  v_lshlrev_b32 v132, 16, v34
  v_and_b32 v133, 0xffff0000, v34
  v_lshlrev_b32 v134, 16, v35
  v_and_b32 v135, 0xffff0000, v35
  v_lshlrev_b32 v136, 16, v36
  v_and_b32 v137, 0xffff0000, v36
  v_lshlrev_b32 v138, 16, v37
  v_and_b32 v139, 0xffff0000, v37
  v_lshlrev_b32 v140, 16, v38
  v_and_b32 v141, 0xffff0000, v38
  v_lshlrev_b32 v142, 16, v39
  v_and_b32 v143, 0xffff0000, v39
  v_lshlrev_b32 v144, 16, v40
  v_and_b32 v145, 0xffff0000, v40
  v_lshlrev_b32 v146, 16, v41
  v_and_b32 v147, 0xffff0000, v41
  v_lshlrev_b32 v148, 16, v42
  v_and_b32 v149, 0xffff0000, v42
  v_lshlrev_b32 v150, 16, v43
  v_and_b32 v151, 0xffff0000, v43
  v_lshlrev_b32 v152, 16, v44
  v_and_b32 v153, 0xffff0000, v44
  v_lshlrev_b32 v154, 16, v45
  v_and_b32 v155, 0xffff0000, v45
  v_lshlrev_b32 v156, 16, v46
  v_and_b32 v157, 0xffff0000, v46
  v_lshlrev_b32 v158, 16, v47
  v_and_b32 v159, 0xffff0000, v47
  v_pk_add_f32 v[232:233], v[88:89], v[90:91]
  v_pk_add_f32 v[234:235], v[92:93], v[94:95]
  v_pk_add_f32 v[232:233], v[232:233], v[96:97]
  v_pk_add_f32 v[234:235], v[234:235], v[98:99]
  v_pk_add_f32 v[232:233], v[232:233], v[100:101]
  v_pk_add_f32 v[234:235], v[234:235], v[102:103]
  v_pk_add_f32 v[232:233], v[232:233], v[104:105]
  v_pk_add_f32 v[234:235], v[234:235], v[106:107]
  v_pk_add_f32 v[232:233], v[232:233], v[108:109]
  v_pk_add_f32 v[234:235], v[234:235], v[110:111]
  v_pk_add_f32 v[232:233], v[232:233], v[112:113]
  v_pk_add_f32 v[234:235], v[234:235], v[114:115]
  v_pk_add_f32 v[232:233], v[232:233], v[116:117]
  v_pk_add_f32 v[234:235], v[234:235], v[118:119]
  v_pk_add_f32 v[232:233], v[232:233], v[120:121]
  v_pk_add_f32 v[234:235], v[234:235], v[122:123]
  v_pk_add_f32 v[232:233], v[232:233], v[124:125]
  v_pk_add_f32 v[234:235], v[234:235], v[126:127]
  v_pk_add_f32 v[232:233], v[232:233], v[128:129]
  v_pk_add_f32 v[234:235], v[234:235], v[130:131]
  v_pk_add_f32 v[232:233], v[232:233], v[132:133]
  v_pk_add_f32 v[234:235], v[234:235], v[134:135]
  v_pk_add_f32 v[232:233], v[232:233], v[136:137]
  v_pk_add_f32 v[234:235], v[234:235], v[138:139]
  v_pk_add_f32 v[232:233], v[232:233], v[140:141]
  v_pk_add_f32 v[234:235], v[234:235], v[142:143]
  v_pk_add_f32 v[232:233], v[232:233], v[144:145]
  v_pk_add_f32 v[234:235], v[234:235], v[146:147]
  v_pk_add_f32 v[232:233], v[232:233], v[148:149]
  v_pk_add_f32 v[234:235], v[234:235], v[150:151]
  v_pk_add_f32 v[232:233], v[232:233], v[152:153]
  v_pk_add_f32 v[234:235], v[234:235], v[154:155]
  v_pk_add_f32 v[232:233], v[232:233], v[156:157]
  v_pk_add_f32 v[234:235], v[234:235], v[158:159]
  v_pk_add_f32 v[232:233], v[232:233], v[234:235]
  v_add_f32 v232, v232, v233
  s_nop 1
  v_add_f32_dpp v232, v232, v232 quad_perm:[1,0,3,2] row_mask:0xf bank_mask:0xf
  s_nop 1
  v_add_f32_dpp v232, v232, v232 quad_perm:[2,3,0,1] row_mask:0xf bank_mask:0xf
  s_nop 1
  v_add_f32_dpp v232, v232, v232 row_half_mirror row_mask:0xf bank_mask:0xf
  v_cvt_pk_bf16_f32 v232, v232, v232
  v_and_b32 v232, 0xffff0000, v232
  v_mul_f32 v232, 0xbfb8aa3b, v232
  v_exp_f32 v232, v232
  s_nop 0
  v_add_f32 v232, 1.0, v232
  v_rcp_f32 v232, v232
  s_nop 0
  v_cvt_pk_bf16_f32 v236, v232, v232
  v_and_b32 v236, 0xffff0000, v236
  v_sub_f32 v237, 1.0, v236
  v_cvt_pk_bf16_f32 v237, v237, v237
  v_and_b32 v237, 0xffff0000, v237
  s_mov_b32 exec_lo, 0x01010101
  s_mov_b32 exec_hi, 0x01010101
  buffer_store_dwordx2 v[236:237], v8, s[16:19], s27 offen sc1
  s_mov_b64 exec, -1
  s_waitcnt vmcnt(0)
  v_mov_b32 v10, v5
  s_cmp_lg_u32 s20, 0
  s_cbranch_scc1 PF0_97
  v_mov_b32 v5, 4
  s_mov_b32 s22, 0x20000
POLL_98:
  buffer_load_dword v6, v5, s[12:15], 0 offen offset:128 sc1
  s_waitcnt vmcnt(0)
  v_cmp_ne_u32 vcc, 1, v6
  s_nop 4
  s_cbranch_vccz POLLD_99
  s_sleep 2
  s_sub_u32 s22, s22, 1
  s_cmp_lg_u32 s22, 0
  s_cbranch_scc1 POLL_98
POLLD_99:
PF0_97:
  s_mov_b32 s21, 17402880
  s_waitcnt vmcnt(0)
  s_barrier
  s_cmp_lg_u32 s20, 0
  s_cbranch_scc1 SIG_100
  v_mov_b32 v5, 0
  v_mov_b32 v6, 1
  v_mov_b32 v7, 1
  s_mov_b64 exec, 1
  buffer_atomic_add v6, v5, s[16:19], s21 offen sc0 sc1
  s_waitcnt vmcnt(0)
  v_readfirstlane_b32 s43, v6
  s_nop 0
  s_cmp_lg_u32 s43, 63
  s_cbranch_scc1 SIGR_101
  buffer_store_dword v7, v5, s[16:19], s21 offen offset:128 sc1
SIGR_101:
  s_mov_b64 exec, -1
SIG_100:
  v_mov_b32 v5, v10
  s_mul_i32 s21, s25, 205
  s_lshr_b32 s21, s21, 10
  s_mul_i32 s22, s21, 5
  s_sub_u32 s22, s25, s22
  s_lshl_b32 s22, s22, 8
  s_add_u32 s29, s22, s24
  s_cmp_eq_u32 s22, 1024
  s_cselect_b32 s22, s28, s29
  s_mul_i32 s21, s21, 294912
  s_add_u32 s21, s21, s22
  buffer_load_dword v9, v5, s[4:7], s21 offen
  s_add_u32 s25, s25, 32
  s_branch ATT0_5
QKV_96:
  s_setprio 3
  s_and_b32 s29, s2, 3
  s_lshl_b32 s29, s29, 2
  s_bfe_u32 s30, s2, 0x20003
  s_add_u32 s21, s29, s30
  s_bfe_u32 s29, s2, 0x10002
  s_mul_i32 s29, s29, 6
  s_lshr_b32 s30, s2, 5
  s_add_u32 s22, s29, s30
  s_lshr_b32 s27, s22, 2
  s_and_b32 s28, s22, 3
  s_and_b32 s36, s22, 1
  s_mul_i32 s23, s21, 147456
  s_mul_i32 s24, s22, 288
  s_lshl_b32 s25, s20, 11
  s_mul_i32 s39, s20, 3
  s_min_u32 s39, s39, 8
  s_lshl_b32 s26, s39, 10
  s_add_u32 s26, s26, 8192
  s_lshr_b32 s29, s2, 5
  s_mul_i32 s38, s29, 3
  s_bfe_u32 s30, s2, 0x20003
  s_mul_i32 s30, s30, 9
  s_add_u32 s30, s30, 1
  s_lshr_b32 s30, s30, 1
  s_add_u32 s38, s38, s30
  s_sub_u32 s29, s38, 18
  s_cmp_ge_u32 s38, 18
  s_cselect_b32 s38, s29, s38
  s_lshl_b32 s29, s20, 5
  v_lshrrev_b32 v6, 2, v1
  v_add_u32 v6, s29, v6
  v_mul_u32_u24 v6, 1152, v6
  v_lshrrev_b32 v7, 4, v1
  v_and_b32 v8, 3, v1
  v_xor_b32 v7, v7, v8
  v_lshl_add_u32 v11, v7, 4, v6
  v_add_u32 v12, 17408, v11
  s_lshl_b32 s29, s39, 6
  s_cmp_eq_u32 s36, 1
  s_cselect_b32 s30, 2, 16
  s_add_u32 s31, s30, 2
  v_add_u32 v6, s29, v1
  v_mul_u32_u24 v7, 3277, v6
  v_lshrrev_b32 v7, 16, v7
  v_mul_u32_u24 v8, 20, v7
  v_sub_u32 v8, v6, v8
  v_mul_u32_u24 v7, 3456, v7
  v_lshl_add_u32 v7, v8, 4, v7
  v_cmp_le_u32 vcc, s30, v8
  v_mov_b32 v6, 1073741824
  s_nop 0
  v_cndmask_b32 v6, v7, v6, vcc
  v_cmp_le_u32 vcc, s31, v8
  v_subrev_u32 v7, 32, v7
  s_nop 0
  v_cndmask_b32 v13, v6, v7, vcc
  v_add_u32 v6, s29, v1
  v_add_u32 v6, 64, v6
  v_mul_u32_u24 v7, 3277, v6
  v_lshrrev_b32 v7, 16, v7
  v_mul_u32_u24 v8, 20, v7
  v_sub_u32 v8, v6, v8
  v_mul_u32_u24 v7, 3456, v7
  v_lshl_add_u32 v7, v8, 4, v7
  v_subrev_u32 v7, 1024, v7
  v_cmp_le_u32 vcc, s30, v8
  v_mov_b32 v6, 1073741824
  s_nop 0
  v_cndmask_b32 v6, v7, v6, vcc
  v_cmp_le_u32 vcc, s31, v8
  v_subrev_u32 v7, 32, v7
  s_nop 0
  v_cndmask_b32 v14, v6, v7, vcc
  v_add_u32 v6, s29, v1
  v_add_u32 v6, 128, v6
  v_mul_u32_u24 v7, 3277, v6
  v_lshrrev_b32 v7, 16, v7
  v_mul_u32_u24 v8, 20, v7
  v_sub_u32 v8, v6, v8
  v_mul_u32_u24 v7, 3456, v7
  v_lshl_add_u32 v7, v8, 4, v7
  v_subrev_u32 v7, 2048, v7
  v_cmp_le_u32 vcc, s30, v8
  v_mov_b32 v6, 1073741824
  s_nop 0
  v_cndmask_b32 v6, v7, v6, vcc
  v_cmp_le_u32 vcc, s31, v8
  v_subrev_u32 v7, 32, v7
  s_nop 0
  v_cndmask_b32 v15, v6, v7, vcc
  s_lshl_b32 s44, s38, 6
  s_add_u32 s44, s44, s23
  s_mul_i32 s45, s38, 110592
  s_add_u32 s45, s45, s24
  s_cmp_lt_u32 s20, 2
  s_cselect_b32 s46, 1, 0
  s_mov_b32 s47, 0
  s_waitcnt lgkmcnt(0)
  s_mov_b32 s16, s86
  s_and_b32 s17, s87, 0xffff
  s_mov_b32 s18, 22171648
  s_mov_b32 s19, 0x20000
  s_mov_b32 s12, s84
  s_and_b32 s13, s85, 0xffff
  s_mov_b32 s14, 256
  s_mov_b32 s15, 0x20000
  s_mov_b32 s4, s64
  s_and_b32 s5, s65, 0xffff
  s_mov_b32 s6, 2359296
  s_mov_b32 s7, 0x20000
  s_mov_b32 s8, s66
  s_and_b32 s9, s67, 0xffff
  s_mov_b32 s10, 1990656
  s_mov_b32 s11, 0x20000
  s_add_u32 m0, s25, 0
  s_add_u32 s38, s38, 1
  buffer_load_dwordx4 v11, s[4:7], s44 offen lds
  buffer_load_dwordx4 v12, s[4:7], s44 offen offset:1024 lds
  s_add_u32 m0, s26, 0
  s_add_u32 s44, s44, 64
  buffer_load_dwordx4 v13, s[8:11], s45 offen lds
  buffer_load_dwordx4 v14, s[8:11], s45 offen offset:1024 lds
  s_cmp_eq_u32 s46, 0
  s_cbranch_scc1 QS_104
  buffer_load_dwordx4 v15, s[8:11], s45 offen offset:2048 lds
QS_104:
  s_add_u32 s45, s45, 110592
  s_cmp_eq_u32 s38, 18
  s_cselect_b32 s44, s23, s44
  s_cselect_b32 s45, s24, s45
  s_add_u32 s47, s47, 1
  s_cmp_eq_u32 s47, 18
  s_cselect_b32 s44, 1073741824, s44
  s_cselect_b32 s45, 1073741824, s45
  s_add_u32 m0, s25, 18432
  s_add_u32 s38, s38, 1
  buffer_load_dwordx4 v11, s[4:7], s44 offen lds
  buffer_load_dwordx4 v12, s[4:7], s44 offen offset:1024 lds
  s_add_u32 m0, s26, 18432
  s_add_u32 s44, s44, 64
  buffer_load_dwordx4 v13, s[8:11], s45 offen lds
  buffer_load_dwordx4 v14, s[8:11], s45 offen offset:1024 lds
  s_cmp_eq_u32 s46, 0
  s_cbranch_scc1 QS_105
  buffer_load_dwordx4 v15, s[8:11], s45 offen offset:2048 lds
QS_105:
  s_add_u32 s45, s45, 110592
  s_cmp_eq_u32 s38, 18
  s_cselect_b32 s44, s23, s44
  s_cselect_b32 s45, s24, s45
  s_add_u32 s47, s47, 1
  s_cmp_eq_u32 s47, 18
  s_cselect_b32 s44, 1073741824, s44
  s_cselect_b32 s45, 1073741824, s45
  s_add_u32 m0, s25, 36864
  s_add_u32 s38, s38, 1
  buffer_load_dwordx4 v11, s[4:7], s44 offen lds
  buffer_load_dwordx4 v12, s[4:7], s44 offen offset:1024 lds
  s_add_u32 m0, s26, 36864
  s_add_u32 s44, s44, 64
  buffer_load_dwordx4 v13, s[8:11], s45 offen lds
  buffer_load_dwordx4 v14, s[8:11], s45 offen offset:1024 lds
  s_cmp_eq_u32 s46, 0
  s_cbranch_scc1 QS_106
  buffer_load_dwordx4 v15, s[8:11], s45 offen offset:2048 lds
QS_106:
  s_add_u32 s45, s45, 110592
  s_cmp_eq_u32 s38, 18
  s_cselect_b32 s44, s23, s44
  s_cselect_b32 s45, s24, s45
  s_add_u32 s47, s47, 1
  s_cmp_eq_u32 s47, 18
  s_cselect_b32 s44, 1073741824, s44
  s_cselect_b32 s45, 1073741824, s45
  v_bfe_u32 v6, v3, 2, 2
  v_lshlrev_b32 v7, 6, v3
  v_add_u32 v7, s25, v7
  v_add_u32 v8, 0, v2
  v_xor_b32 v8, v8, v6
  v_lshl_add_u32 v16, v8, 4, v7
  v_add_u32 v8, 2, v2
  v_xor_b32 v8, v8, v6
  v_lshl_add_u32 v17, v8, 4, v7
  v_bfe_u32 v6, v1, 2, 2
  v_lshl_add_u32 v6, v2, 3, v6
  v_mul_u32_u24 v6, 320, v6
  v_add_u32 v6, 8192, v6
  v_bfe_u32 v7, v1, 4, 1
  v_and_b32 v8, 3, v1
  v_mul_u32_u24 v18, 288, v7
  v_lshl_add_u32 v18, v8, 3, v18
  v_add_u32 v18, v18, v6
  s_lshl_b32 s29, s36, 5
  s_add_u32 s29, s29, 32
  v_add_u32 v6, s29, v6
  v_lshl_add_u32 v19, v7, 5, v6
  v_lshl_add_u32 v19, v8, 3, v19
  v_add_u32 v19, 8, v19
  v_lshl_add_u32 v7, v7, 2, v8
  v_lshrrev_b32 v7, 1, v7
  s_cmp_eq_u32 s27, 2
  s_cselect_b64 vcc, -1, 0
  v_cndmask_b32 v8, v8, v7, vcc
  v_mul_u32_u24 v20, 72, v8
  v_add_u32 v20, v20, v6
  v_mov_b32 v163, 0
  s_lshl_b32 s31, s21, 2
  s_add_u32 s31, s31, s20
  v_mov_b32 v24, 0
  v_mov_b32 v25, 0
  v_mov_b32 v26, 0
  v_mov_b32 v27, 0
  v_mov_b32 v28, 0
  v_mov_b32 v29, 0
  v_mov_b32 v30, 0
  v_mov_b32 v31, 0
  v_mov_b32 v32, 0
  v_mov_b32 v33, 0
  v_mov_b32 v34, 0
  v_mov_b32 v35, 0
  v_mov_b32 v36, 0
  v_mov_b32 v37, 0
  v_mov_b32 v38, 0
  v_mov_b32 v39, 0
  v_mov_b32 v40, 0
  v_mov_b32 v41, 0
  v_mov_b32 v42, 0
  v_mov_b32 v43, 0
  v_mov_b32 v44, 0
  v_mov_b32 v45, 0
  v_mov_b32 v46, 0
  v_mov_b32 v47, 0
  v_mov_b32 v48, 0
  v_mov_b32 v49, 0
  v_mov_b32 v50, 0
  v_mov_b32 v51, 0
  v_mov_b32 v52, 0
  v_mov_b32 v53, 0
  v_mov_b32 v54, 0
  v_mov_b32 v55, 0
  v_mov_b32 v56, 0
  v_mov_b32 v57, 0
  v_mov_b32 v58, 0
  v_mov_b32 v59, 0
  v_mov_b32 v60, 0
  v_mov_b32 v61, 0
  v_mov_b32 v62, 0
  v_mov_b32 v63, 0
  v_mov_b32 v64, 0
  v_mov_b32 v65, 0
  v_mov_b32 v66, 0
  v_mov_b32 v67, 0
  v_mov_b32 v68, 0
  v_mov_b32 v69, 0
  v_mov_b32 v70, 0
  v_mov_b32 v71, 0
  v_mov_b32 v72, 0
  v_mov_b32 v73, 0
  v_mov_b32 v74, 0
  v_mov_b32 v75, 0
  v_mov_b32 v76, 0
  v_mov_b32 v77, 0
  v_mov_b32 v78, 0
  v_mov_b32 v79, 0
  v_mov_b32 v80, 0
  v_mov_b32 v81, 0
  v_mov_b32 v82, 0
  v_mov_b32 v83, 0
  v_mov_b32 v84, 0
  v_mov_b32 v85, 0
  v_mov_b32 v86, 0
  v_mov_b32 v87, 0
  v_mov_b32 v88, 0
  v_mov_b32 v89, 0
  v_mov_b32 v90, 0
  v_mov_b32 v91, 0
  v_mov_b32 v92, 0
  v_mov_b32 v93, 0
  v_mov_b32 v94, 0
  v_mov_b32 v95, 0
  v_mov_b32 v96, 0
  v_mov_b32 v97, 0
  v_mov_b32 v98, 0
  v_mov_b32 v99, 0
  v_mov_b32 v100, 0
  v_mov_b32 v101, 0
  v_mov_b32 v102, 0
  v_mov_b32 v103, 0
  s_cmp_eq_u32 s27, 2
  s_cbranch_scc1 QV_102
  s_cmp_eq_u32 s27, 1
  s_cbranch_scc1 QK_107
  s_lshl_b32 s32, s28, 19
  s_lshl_b32 s29, s31, 10
  s_add_u32 s32, s32, s29
  s_add_u32 s32, s32, 7671808
  s_mov_b32 s33, 65536
  s_mov_b32 s35, 8192
  s_lshl_b32 s34, s28, 16
  s_lshl_b32 s29, s31, 7
  s_add_u32 s34, s34, s29
  s_add_u32 s34, s34, 9768960
  s_mov_b32 s37, 0x3eae1a93
  s_branch QQK_108
QK_107:
  s_mul_i32 s32, s28, 1245184
  s_lshr_b32 s29, s31, 3
  s_mul_i32 s29, s29, 19456
  s_add_u32 s32, s32, s29
  s_add_u32 s32, s32, 10031104
  s_and_b32 s29, s31, 7
  s_lshl_b32 s30, s29, 7
  s_add_u32 s34, s32, s30
  s_add_u32 s34, s34, 8192
  s_lshl_b32 s29, s29, 10
  s_add_u32 s32, s32, s29
  s_mov_b32 s33, 155648
  s_mov_b32 s35, 155648
  s_mov_b32 s37, 1.0
QQK_108:
  v_mul_lo_u32 v161, v2, s35
  v_lshlrev_b32 v161, 1, v161
  v_lshl_add_u32 v161, v3, 2, v161
  s_waitcnt vmcnt(8)
  s_barrier
  ds_read_b128 v[104:107], v16 offset:0
  ds_read_b64_tr_b16 v[112:113], v18 offset:0
  ds_read_b64_tr_b16 v[114:115], v18 offset:1280
  ds_read_b64_tr_b16 v[116:117], v19 offset:0
  ds_read_b64_tr_b16 v[118:119], v19 offset:1280
  ds_read_b64_tr_b16 v[120:121], v19 offset:72
  ds_read_b64_tr_b16 v[122:123], v19 offset:1352
  ds_read_b64_tr_b16 v[124:125], v19 offset:144
  ds_read_b64_tr_b16 v[126:127], v19 offset:1424
  ds_read_b64_tr_b16 v[128:129], v20 offset:0
  ds_read_b64_tr_b16 v[130:131], v20 offset:1280
  s_waitcnt lgkmcnt(0)
  v_mfma_f32_32x32x16_bf16 v[24:39], v[112:115], v[104:107], v[24:39]
  ds_read_b128 v[108:111], v17 offset:0
  ds_read_b64_tr_b16 v[132:133], v18 offset:5120
  ds_read_b64_tr_b16 v[134:135], v18 offset:6400
  s_add_u32 m0, s25, 55296
  s_add_u32 s38, s38, 1
  buffer_load_dwordx4 v11, s[4:7], s44 offen lds
  v_mfma_f32_32x32x16_bf16 v[40:55], v[116:119], v[104:107], v[40:55]
  ds_read_b64_tr_b16 v[136:137], v19 offset:5120
  ds_read_b64_tr_b16 v[138:139], v19 offset:6400
  ds_read_b64_tr_b16 v[140:141], v19 offset:5192
  ds_read_b64_tr_b16 v[142:143], v19 offset:6472
  buffer_load_dwordx4 v12, s[4:7], s44 offen offset:1024 lds
  s_add_u32 m0, s26, 55296
  s_add_u32 s44, s44, 64
  v_mfma_f32_32x32x16_bf16 v[56:71], v[120:123], v[104:107], v[56:71]
  ds_read_b64_tr_b16 v[144:145], v19 offset:5264
  ds_read_b64_tr_b16 v[146:147], v19 offset:6544
  ds_read_b64_tr_b16 v[148:149], v20 offset:5120
  ds_read_b64_tr_b16 v[150:151], v20 offset:6400
  buffer_load_dwordx4 v13, s[8:11], s45 offen lds
  v_mfma_f32_32x32x16_bf16 v[72:87], v[124:127], v[104:107], v[72:87]
  buffer_load_dwordx4 v14, s[8:11], s45 offen offset:1024 lds
  s_cmp_eq_u32 s46, 0
  v_mfma_f32_32x32x16_bf16 v[88:103], v[128:131], v[104:107], v[88:103]
  s_cbranch_scc1 QS_109
  buffer_load_dwordx4 v15, s[8:11], s45 offen offset:2048 lds
QS_109:
  s_add_u32 s45, s45, 110592
  s_cmp_eq_u32 s38, 18
  s_cselect_b32 s44, s23, s44
  s_cselect_b32 s45, s24, s45
  s_add_u32 s47, s47, 1
  s_cmp_eq_u32 s47, 18
  s_cselect_b32 s44, 1073741824, s44
  s_cselect_b32 s45, 1073741824, s45
  s_mov_b32 s48, 4
.p2align 4
QL_110:
  s_cmp_eq_u32 s46, 1
  s_waitcnt vmcnt(10) lgkmcnt(0)
  v_mfma_f32_32x32x16_bf16 v[24:39], v[132:135], v[108:111], v[24:39]
  s_cbranch_scc1 QW_111
  s_waitcnt vmcnt(8)
QW_111:
  s_barrier
  ds_read_b128 v[104:107], v16 offset:18432
  ds_read_b64_tr_b16 v[112:113], v18 offset:18432
  ds_read_b64_tr_b16 v[114:115], v18 offset:19712
  s_add_u32 m0, s25, 0
  s_add_u32 s38, s38, 1
  buffer_load_dwordx4 v11, s[4:7], s44 offen lds
  v_mfma_f32_32x32x16_bf16 v[40:55], v[136:139], v[108:111], v[40:55]
  ds_read_b64_tr_b16 v[116:117], v19 offset:18432
  ds_read_b64_tr_b16 v[118:119], v19 offset:19712
  ds_read_b64_tr_b16 v[120:121], v19 offset:18504
  ds_read_b64_tr_b16 v[122:123], v19 offset:19784
  v_mfma_f32_32x32x16_bf16 v[56:71], v[140:143], v[108:111], v[56:71]
  ds_read_b64_tr_b16 v[124:125], v19 offset:18576
  ds_read_b64_tr_b16 v[126:127], v19 offset:19856
  ds_read_b64_tr_b16 v[128:129], v20 offset:18432
  ds_read_b64_tr_b16 v[130:131], v20 offset:19712
  v_mfma_f32_32x32x16_bf16 v[72:87], v[144:147], v[108:111], v[72:87]
  buffer_load_dwordx4 v12, s[4:7], s44 offen offset:1024 lds
  s_add_u32 m0, s26, 0
  s_add_u32 s44, s44, 64
  v_mfma_f32_32x32x16_bf16 v[88:103], v[148:151], v[108:111], v[88:103]
  buffer_load_dwordx4 v13, s[8:11], s45 offen lds
  s_waitcnt lgkmcnt(0)
  v_mfma_f32_32x32x16_bf16 v[24:39], v[112:115], v[104:107], v[24:39]
  ds_read_b128 v[108:111], v17 offset:18432
  ds_read_b64_tr_b16 v[132:133], v18 offset:23552
  ds_read_b64_tr_b16 v[134:135], v18 offset:24832
  v_mfma_f32_32x32x16_bf16 v[40:55], v[116:119], v[104:107], v[40:55]
  ds_read_b64_tr_b16 v[136:137], v19 offset:23552
  ds_read_b64_tr_b16 v[138:139], v19 offset:24832
  ds_read_b64_tr_b16 v[140:141], v19 offset:23624
  ds_read_b64_tr_b16 v[142:143], v19 offset:24904
  v_mfma_f32_32x32x16_bf16 v[56:71], v[120:123], v[104:107], v[56:71]
  ds_read_b64_tr_b16 v[144:145], v19 offset:23696
  ds_read_b64_tr_b16 v[146:147], v19 offset:24976
  ds_read_b64_tr_b16 v[148:149], v20 offset:23552
  ds_read_b64_tr_b16 v[150:151], v20 offset:24832
  buffer_load_dwordx4 v14, s[8:11], s45 offen offset:1024 lds
  s_cmp_eq_u32 s46, 0
  v_mfma_f32_32x32x16_bf16 v[72:87], v[124:127], v[104:107], v[72:87]
  s_cbranch_scc1 QS_112
  buffer_load_dwordx4 v15, s[8:11], s45 offen offset:2048 lds
QS_112:
  s_add_u32 s45, s45, 110592
  s_cmp_eq_u32 s38, 18
  s_cselect_b32 s44, s23, s44
  s_cselect_b32 s45, s24, s45
  s_add_u32 s47, s47, 1
  s_cmp_eq_u32 s47, 18
  s_cselect_b32 s44, 1073741824, s44
  s_cselect_b32 s45, 1073741824, s45
  v_mfma_f32_32x32x16_bf16 v[88:103], v[128:131], v[104:107], v[88:103]
  s_cmp_eq_u32 s46, 1
  s_waitcnt vmcnt(10) lgkmcnt(0)
  v_mfma_f32_32x32x16_bf16 v[24:39], v[132:135], v[108:111], v[24:39]
  s_cbranch_scc1 QW_113
  s_waitcnt vmcnt(8)
QW_113:
  s_barrier
  ds_read_b128 v[104:107], v16 offset:36864
  ds_read_b64_tr_b16 v[112:113], v18 offset:36864
  ds_read_b64_tr_b16 v[114:115], v18 offset:38144
  s_add_u32 m0, s25, 18432
  s_add_u32 s38, s38, 1
  buffer_load_dwordx4 v11, s[4:7], s44 offen lds
  v_mfma_f32_32x32x16_bf16 v[40:55], v[136:139], v[108:111], v[40:55]
  ds_read_b64_tr_b16 v[116:117], v19 offset:36864
  ds_read_b64_tr_b16 v[118:119], v19 offset:38144
  ds_read_b64_tr_b16 v[120:121], v19 offset:36936
  ds_read_b64_tr_b16 v[122:123], v19 offset:38216
  v_mfma_f32_32x32x16_bf16 v[56:71], v[140:143], v[108:111], v[56:71]
  ds_read_b64_tr_b16 v[124:125], v19 offset:37008
  ds_read_b64_tr_b16 v[126:127], v19 offset:38288
  ds_read_b64_tr_b16 v[128:129], v20 offset:36864
  ds_read_b64_tr_b16 v[130:131], v20 offset:38144
  v_mfma_f32_32x32x16_bf16 v[72:87], v[144:147], v[108:111], v[72:87]
  buffer_load_dwordx4 v12, s[4:7], s44 offen offset:1024 lds
  s_add_u32 m0, s26, 18432
  s_add_u32 s44, s44, 64
  v_mfma_f32_32x32x16_bf16 v[88:103], v[148:151], v[108:111], v[88:103]
  buffer_load_dwordx4 v13, s[8:11], s45 offen lds
  s_waitcnt lgkmcnt(0)
  v_mfma_f32_32x32x16_bf16 v[24:39], v[112:115], v[104:107], v[24:39]
  ds_read_b128 v[108:111], v17 offset:36864
  ds_read_b64_tr_b16 v[132:133], v18 offset:41984
  ds_read_b64_tr_b16 v[134:135], v18 offset:43264
  v_mfma_f32_32x32x16_bf16 v[40:55], v[116:119], v[104:107], v[40:55]
  ds_read_b64_tr_b16 v[136:137], v19 offset:41984
  ds_read_b64_tr_b16 v[138:139], v19 offset:43264
  ds_read_b64_tr_b16 v[140:141], v19 offset:42056
  ds_read_b64_tr_b16 v[142:143], v19 offset:43336
  v_mfma_f32_32x32x16_bf16 v[56:71], v[120:123], v[104:107], v[56:71]
  ds_read_b64_tr_b16 v[144:145], v19 offset:42128
  ds_read_b64_tr_b16 v[146:147], v19 offset:43408
  ds_read_b64_tr_b16 v[148:149], v20 offset:41984
  ds_read_b64_tr_b16 v[150:151], v20 offset:43264
  buffer_load_dwordx4 v14, s[8:11], s45 offen offset:1024 lds
  s_cmp_eq_u32 s46, 0
  v_mfma_f32_32x32x16_bf16 v[72:87], v[124:127], v[104:107], v[72:87]
  s_cbranch_scc1 QS_114
  buffer_load_dwordx4 v15, s[8:11], s45 offen offset:2048 lds
QS_114:
  s_add_u32 s45, s45, 110592
  s_cmp_eq_u32 s38, 18
  s_cselect_b32 s44, s23, s44
  s_cselect_b32 s45, s24, s45
  s_add_u32 s47, s47, 1
  s_cmp_eq_u32 s47, 18
  s_cselect_b32 s44, 1073741824, s44
  s_cselect_b32 s45, 1073741824, s45
  v_mfma_f32_32x32x16_bf16 v[88:103], v[128:131], v[104:107], v[88:103]
  s_cmp_eq_u32 s46, 1
  s_waitcnt vmcnt(10) lgkmcnt(0)
  v_mfma_f32_32x32x16_bf16 v[24:39], v[132:135], v[108:111], v[24:39]
  s_cbranch_scc1 QW_115
  s_waitcnt vmcnt(8)
QW_115:
  s_barrier
  ds_read_b128 v[104:107], v16 offset:55296
  ds_read_b64_tr_b16 v[112:113], v18 offset:55296
  ds_read_b64_tr_b16 v[114:115], v18 offset:56576
  s_add_u32 m0, s25, 36864
  s_add_u32 s38, s38, 1
  buffer_load_dwordx4 v11, s[4:7], s44 offen lds
  v_mfma_f32_32x32x16_bf16 v[40:55], v[136:139], v[108:111], v[40:55]
  ds_read_b64_tr_b16 v[116:117], v19 offset:55296
  ds_read_b64_tr_b16 v[118:119], v19 offset:56576
  ds_read_b64_tr_b16 v[120:121], v19 offset:55368
  ds_read_b64_tr_b16 v[122:123], v19 offset:56648
  v_mfma_f32_32x32x16_bf16 v[56:71], v[140:143], v[108:111], v[56:71]
  ds_read_b64_tr_b16 v[124:125], v19 offset:55440
  ds_read_b64_tr_b16 v[126:127], v19 offset:56720
  ds_read_b64_tr_b16 v[128:129], v20 offset:55296
  ds_read_b64_tr_b16 v[130:131], v20 offset:56576
  v_mfma_f32_32x32x16_bf16 v[72:87], v[144:147], v[108:111], v[72:87]
  buffer_load_dwordx4 v12, s[4:7], s44 offen offset:1024 lds
  s_add_u32 m0, s26, 36864
  s_add_u32 s44, s44, 64
  v_mfma_f32_32x32x16_bf16 v[88:103], v[148:151], v[108:111], v[88:103]
  buffer_load_dwordx4 v13, s[8:11], s45 offen lds
  s_waitcnt lgkmcnt(0)
  v_mfma_f32_32x32x16_bf16 v[24:39], v[112:115], v[104:107], v[24:39]
  ds_read_b128 v[108:111], v17 offset:55296
  ds_read_b64_tr_b16 v[132:133], v18 offset:60416
  ds_read_b64_tr_b16 v[134:135], v18 offset:61696
  v_mfma_f32_32x32x16_bf16 v[40:55], v[116:119], v[104:107], v[40:55]
  ds_read_b64_tr_b16 v[136:137], v19 offset:60416
  ds_read_b64_tr_b16 v[138:139], v19 offset:61696
  ds_read_b64_tr_b16 v[140:141], v19 offset:60488
  ds_read_b64_tr_b16 v[142:143], v19 offset:61768
  v_mfma_f32_32x32x16_bf16 v[56:71], v[120:123], v[104:107], v[56:71]
  ds_read_b64_tr_b16 v[144:145], v19 offset:60560
  ds_read_b64_tr_b16 v[146:147], v19 offset:61840
  ds_read_b64_tr_b16 v[148:149], v20 offset:60416
  ds_read_b64_tr_b16 v[150:151], v20 offset:61696
  buffer_load_dwordx4 v14, s[8:11], s45 offen offset:1024 lds
  s_cmp_eq_u32 s46, 0
  v_mfma_f32_32x32x16_bf16 v[72:87], v[124:127], v[104:107], v[72:87]
  s_cbranch_scc1 QS_116
  buffer_load_dwordx4 v15, s[8:11], s45 offen offset:2048 lds
QS_116:
  s_add_u32 s45, s45, 110592
  s_cmp_eq_u32 s38, 18
  s_cselect_b32 s44, s23, s44
  s_cselect_b32 s45, s24, s45
  s_add_u32 s47, s47, 1
  s_cmp_eq_u32 s47, 18
  s_cselect_b32 s44, 1073741824, s44
  s_cselect_b32 s45, 1073741824, s45
  v_mfma_f32_32x32x16_bf16 v[88:103], v[128:131], v[104:107], v[88:103]
  s_cmp_eq_u32 s46, 1
  s_waitcnt vmcnt(10) lgkmcnt(0)
  v_mfma_f32_32x32x16_bf16 v[24:39], v[132:135], v[108:111], v[24:39]
  s_cbranch_scc1 QW_117
  s_waitcnt vmcnt(8)
QW_117:
  s_barrier
  ds_read_b128 v[104:107], v16 offset:0
  ds_read_b64_tr_b16 v[112:113], v18 offset:0
  ds_read_b64_tr_b16 v[114:115], v18 offset:1280
  s_add_u32 m0, s25, 55296
  s_add_u32 s38, s38, 1
  buffer_load_dwordx4 v11, s[4:7], s44 offen lds
  v_mfma_f32_32x32x16_bf16 v[40:55], v[136:139], v[108:111], v[40:55]
  ds_read_b64_tr_b16 v[116:117], v19 offset:0
  ds_read_b64_tr_b16 v[118:119], v19 offset:1280
  ds_read_b64_tr_b16 v[120:121], v19 offset:72
  ds_read_b64_tr_b16 v[122:123], v19 offset:1352
  v_mfma_f32_32x32x16_bf16 v[56:71], v[140:143], v[108:111], v[56:71]
  ds_read_b64_tr_b16 v[124:125], v19 offset:144
  ds_read_b64_tr_b16 v[126:127], v19 offset:1424
  ds_read_b64_tr_b16 v[128:129], v20 offset:0
  ds_read_b64_tr_b16 v[130:131], v20 offset:1280
  v_mfma_f32_32x32x16_bf16 v[72:87], v[144:147], v[108:111], v[72:87]
  buffer_load_dwordx4 v12, s[4:7], s44 offen offset:1024 lds
  s_add_u32 m0, s26, 55296
  s_add_u32 s44, s44, 64
  v_mfma_f32_32x32x16_bf16 v[88:103], v[148:151], v[108:111], v[88:103]
  buffer_load_dwordx4 v13, s[8:11], s45 offen lds
  s_waitcnt lgkmcnt(0)
  v_mfma_f32_32x32x16_bf16 v[24:39], v[112:115], v[104:107], v[24:39]
  ds_read_b128 v[108:111], v17 offset:0
  ds_read_b64_tr_b16 v[132:133], v18 offset:5120
  ds_read_b64_tr_b16 v[134:135], v18 offset:6400
  v_mfma_f32_32x32x16_bf16 v[40:55], v[116:119], v[104:107], v[40:55]
  ds_read_b64_tr_b16 v[136:137], v19 offset:5120
  ds_read_b64_tr_b16 v[138:139], v19 offset:6400
  ds_read_b64_tr_b16 v[140:141], v19 offset:5192
  ds_read_b64_tr_b16 v[142:143], v19 offset:6472
  v_mfma_f32_32x32x16_bf16 v[56:71], v[120:123], v[104:107], v[56:71]
  ds_read_b64_tr_b16 v[144:145], v19 offset:5264
  ds_read_b64_tr_b16 v[146:147], v19 offset:6544
  ds_read_b64_tr_b16 v[148:149], v20 offset:5120
  ds_read_b64_tr_b16 v[150:151], v20 offset:6400
  buffer_load_dwordx4 v14, s[8:11], s45 offen offset:1024 lds
  s_cmp_eq_u32 s46, 0
  v_mfma_f32_32x32x16_bf16 v[72:87], v[124:127], v[104:107], v[72:87]
  s_cbranch_scc1 QS_118
  buffer_load_dwordx4 v15, s[8:11], s45 offen offset:2048 lds
QS_118:
  s_add_u32 s45, s45, 110592
  s_cmp_eq_u32 s38, 18
  s_cselect_b32 s44, s23, s44
  s_cselect_b32 s45, s24, s45
  s_add_u32 s47, s47, 1
  s_cmp_eq_u32 s47, 18
  s_cselect_b32 s44, 1073741824, s44
  s_cselect_b32 s45, 1073741824, s45
  v_mfma_f32_32x32x16_bf16 v[88:103], v[128:131], v[104:107], v[88:103]
  s_sub_u32 s48, s48, 1
  s_cmp_lg_u32 s48, 0
  s_cbranch_scc1 QL_110
  s_cmp_eq_u32 s46, 1
  s_waitcnt vmcnt(10) lgkmcnt(0)
  v_mfma_f32_32x32x16_bf16 v[24:39], v[132:135], v[108:111], v[24:39]
  s_cbranch_scc1 QW_119
  s_waitcnt vmcnt(8)
QW_119:
  s_barrier
  buffer_load_dword v164, v163, s[12:15], 0 offen offset:132 sc1
  ds_read_b128 v[104:107], v16 offset:18432
  ds_read_b64_tr_b16 v[112:113], v18 offset:18432
  ds_read_b64_tr_b16 v[114:115], v18 offset:19712
  v_mfma_f32_32x32x16_bf16 v[40:55], v[136:139], v[108:111], v[40:55]
  ds_read_b64_tr_b16 v[116:117], v19 offset:18432
  ds_read_b64_tr_b16 v[118:119], v19 offset:19712
  ds_read_b64_tr_b16 v[120:121], v19 offset:18504
  ds_read_b64_tr_b16 v[122:123], v19 offset:19784
  v_mfma_f32_32x32x16_bf16 v[56:71], v[140:143], v[108:111], v[56:71]
  ds_read_b64_tr_b16 v[124:125], v19 offset:18576
  ds_read_b64_tr_b16 v[126:127], v19 offset:19856
  ds_read_b64_tr_b16 v[128:129], v20 offset:18432
  ds_read_b64_tr_b16 v[130:131], v20 offset:19712
  v_mfma_f32_32x32x16_bf16 v[72:87], v[144:147], v[108:111], v[72:87]
  v_mfma_f32_32x32x16_bf16 v[88:103], v[148:151], v[108:111], v[88:103]
  s_waitcnt lgkmcnt(0)
  v_mfma_f32_32x32x16_bf16 v[24:39], v[112:115], v[104:107], v[24:39]
  ds_read_b128 v[108:111], v17 offset:18432
  ds_read_b64_tr_b16 v[132:133], v18 offset:23552
  ds_read_b64_tr_b16 v[134:135], v18 offset:24832
  v_mfma_f32_32x32x16_bf16 v[40:55], v[116:119], v[104:107], v[40:55]
  ds_read_b64_tr_b16 v[136:137], v19 offset:23552
  ds_read_b64_tr_b16 v[138:139], v19 offset:24832
  ds_read_b64_tr_b16 v[140:141], v19 offset:23624
  ds_read_b64_tr_b16 v[142:143], v19 offset:24904
  v_mfma_f32_32x32x16_bf16 v[56:71], v[120:123], v[104:107], v[56:71]
  ds_read_b64_tr_b16 v[144:145], v19 offset:23696
  ds_read_b64_tr_b16 v[146:147], v19 offset:24976
  ds_read_b64_tr_b16 v[148:149], v20 offset:23552
  ds_read_b64_tr_b16 v[150:151], v20 offset:24832
  v_mfma_f32_32x32x16_bf16 v[72:87], v[124:127], v[104:107], v[72:87]
  v_mfma_f32_32x32x16_bf16 v[88:103], v[128:131], v[104:107], v[88:103]
  s_waitcnt lgkmcnt(0)
  v_mfma_f32_32x32x16_bf16 v[24:39], v[132:135], v[108:111], v[24:39]
  v_mfma_f32_32x32x16_bf16 v[40:55], v[136:139], v[108:111], v[40:55]
  v_mfma_f32_32x32x16_bf16 v[56:71], v[140:143], v[108:111], v[56:71]
  v_mfma_f32_32x32x16_bf16 v[72:87], v[144:147], v[108:111], v[72:87]
  v_mfma_f32_32x32x16_bf16 v[88:103], v[148:151], v[108:111], v[88:103]
  s_mul_i32 s29, s33, 0
  s_add_u32 s29, s29, s32
  s_nop 5
  v_mul_f32 v24, s37, v24
  v_mul_f32 v25, s37, v25
  v_mul_f32 v26, s37, v26
  v_mul_f32 v27, s37, v27
  v_mul_f32 v28, s37, v28
  v_mul_f32 v29, s37, v29
  v_mul_f32 v30, s37, v30
  v_mul_f32 v31, s37, v31
  v_cvt_pk_bf16_f32 v152, v24, v25
  v_cvt_pk_bf16_f32 v153, v26, v27
  v_cvt_pk_bf16_f32 v154, v28, v29
  v_cvt_pk_bf16_f32 v155, v30, v31
  buffer_store_dwordx4 v[152:155], v4, s[16:19], s29 offen sc1
  s_mul_i32 s29, s33, 7
  s_add_u32 s29, s29, s32
  v_mul_f32 v32, s37, v32
  v_mul_f32 v33, s37, v33
  v_mul_f32 v34, s37, v34
  v_mul_f32 v35, s37, v35
  v_mul_f32 v36, s37, v36
  v_mul_f32 v37, s37, v37
  v_mul_f32 v38, s37, v38
  v_mul_f32 v39, s37, v39
  v_cvt_pk_bf16_f32 v156, v32, v33
  v_cvt_pk_bf16_f32 v157, v34, v35
  v_cvt_pk_bf16_f32 v158, v36, v37
  v_cvt_pk_bf16_f32 v159, v38, v39
  buffer_store_dwordx4 v[156:159], v4, s[16:19], s29 offen sc1
  s_mul_i32 s29, s33, 1
  s_add_u32 s29, s29, s32
  v_mul_f32 v40, s37, v40
  v_mul_f32 v41, s37, v41
  v_mul_f32 v42, s37, v42
  v_mul_f32 v43, s37, v43
  v_mul_f32 v44, s37, v44
  v_mul_f32 v45, s37, v45
  v_mul_f32 v46, s37, v46
  v_mul_f32 v47, s37, v47
  v_cvt_pk_bf16_f32 v152, v40, v41
  v_cvt_pk_bf16_f32 v153, v42, v43
  v_cvt_pk_bf16_f32 v154, v44, v45
  v_cvt_pk_bf16_f32 v155, v46, v47
  buffer_store_dwordx4 v[152:155], v4, s[16:19], s29 offen sc1
  s_mul_i32 s29, s33, 2
  s_add_u32 s29, s29, s32
  v_mul_f32 v48, s37, v48
  v_mul_f32 v49, s37, v49
  v_mul_f32 v50, s37, v50
  v_mul_f32 v51, s37, v51
  v_mul_f32 v52, s37, v52
  v_mul_f32 v53, s37, v53
  v_mul_f32 v54, s37, v54
  v_mul_f32 v55, s37, v55
  v_cvt_pk_bf16_f32 v156, v48, v49
  v_cvt_pk_bf16_f32 v157, v50, v51
  v_cvt_pk_bf16_f32 v158, v52, v53
  v_cvt_pk_bf16_f32 v159, v54, v55
  buffer_store_dwordx4 v[156:159], v4, s[16:19], s29 offen sc1
  s_mul_i32 s29, s33, 3
  s_add_u32 s29, s29, s32
  v_mul_f32 v56, s37, v56
  v_mul_f32 v57, s37, v57
  v_mul_f32 v58, s37, v58
  v_mul_f32 v59, s37, v59
  v_mul_f32 v60, s37, v60
  v_mul_f32 v61, s37, v61
  v_mul_f32 v62, s37, v62
  v_mul_f32 v63, s37, v63
  v_cvt_pk_bf16_f32 v152, v56, v57
  v_cvt_pk_bf16_f32 v153, v58, v59
  v_cvt_pk_bf16_f32 v154, v60, v61
  v_cvt_pk_bf16_f32 v155, v62, v63
  buffer_store_dwordx4 v[152:155], v4, s[16:19], s29 offen sc1
  s_mul_i32 s29, s33, 4
  s_add_u32 s29, s29, s32
  v_mul_f32 v64, s37, v64
  v_mul_f32 v65, s37, v65
  v_mul_f32 v66, s37, v66
  v_mul_f32 v67, s37, v67
  v_mul_f32 v68, s37, v68
  v_mul_f32 v69, s37, v69
  v_mul_f32 v70, s37, v70
  v_mul_f32 v71, s37, v71
  v_cvt_pk_bf16_f32 v156, v64, v65
  v_cvt_pk_bf16_f32 v157, v66, v67
  v_cvt_pk_bf16_f32 v158, v68, v69
  v_cvt_pk_bf16_f32 v159, v70, v71
  buffer_store_dwordx4 v[156:159], v4, s[16:19], s29 offen sc1
  s_mul_i32 s29, s33, 5
  s_add_u32 s29, s29, s32
  v_mul_f32 v72, s37, v72
  v_mul_f32 v73, s37, v73
  v_mul_f32 v74, s37, v74
  v_mul_f32 v75, s37, v75
  v_mul_f32 v76, s37, v76
  v_mul_f32 v77, s37, v77
  v_mul_f32 v78, s37, v78
  v_mul_f32 v79, s37, v79
  v_cvt_pk_bf16_f32 v152, v72, v73
  v_cvt_pk_bf16_f32 v153, v74, v75
  v_cvt_pk_bf16_f32 v154, v76, v77
  v_cvt_pk_bf16_f32 v155, v78, v79
  buffer_store_dwordx4 v[152:155], v4, s[16:19], s29 offen sc1
  s_mul_i32 s29, s33, 6
  s_add_u32 s29, s29, s32
  v_mul_f32 v80, s37, v80
  v_mul_f32 v81, s37, v81
  v_mul_f32 v82, s37, v82
  v_mul_f32 v83, s37, v83
  v_mul_f32 v84, s37, v84
  v_mul_f32 v85, s37, v85
  v_mul_f32 v86, s37, v86
  v_mul_f32 v87, s37, v87
  v_cvt_pk_bf16_f32 v156, v80, v81
  v_cvt_pk_bf16_f32 v157, v82, v83
  v_cvt_pk_bf16_f32 v158, v84, v85
  v_cvt_pk_bf16_f32 v159, v86, v87
  buffer_store_dwordx4 v[156:159], v4, s[16:19], s29 offen sc1
  v_mul_f32 v88, s37, v88
  v_mul_f32 v89, s37, v89
  v_mul_f32 v90, s37, v90
  v_mul_f32 v91, s37, v91
  v_mul_f32 v92, s37, v92
  v_mul_f32 v93, s37, v93
  v_mul_f32 v94, s37, v94
  v_mul_f32 v95, s37, v95
  v_cvt_pk_bf16_f32 v96, v88, v89
  v_cvt_pk_bf16_f32 v97, v90, v91
  v_cvt_pk_bf16_f32 v98, v92, v93
  v_cvt_pk_bf16_f32 v99, v94, v95
  s_mul_i32 s29, s35, 0
  s_add_u32 s29, s29, s34
  buffer_store_dword v96, v161, s[16:19], s29 offen sc1
  s_mul_i32 s29, s35, 1
  s_add_u32 s29, s29, s34
  buffer_store_dword v97, v161, s[16:19], s29 offen sc1
  s_mul_i32 s29, s35, 4
  s_add_u32 s29, s29, s34
  buffer_store_dword v98, v161, s[16:19], s29 offen sc1
  s_mul_i32 s29, s35, 5
  s_add_u32 s29, s29, s34
  buffer_store_dword v99, v161, s[16:19], s29 offen sc1
  s_branch QDONE_103
QV_102:
  s_mul_i32 s32, s28, 1245184
  s_lshr_b32 s29, s31, 3
  s_mul_i32 s29, s29, 19456
  s_add_u32 s32, s32, s29
  s_and_b32 s29, s31, 7
  s_mul_i32 s29, s29, 1280
  s_add_u32 s32, s32, s29
  s_add_u32 s32, s32, 10040320
  v_bfe_u32 v6, v1, 4, 1
  v_lshlrev_b32 v7, 8, v2
  v_and_b32 v8, 15, v1
  v_lshl_add_u32 v5, v8, 4, v7
  v_mul_u32_u24 v160, 1089536, v6
  v_add_u32 v160, v160, v5
  v_mul_u32_u24 v162, 155648, v6
  v_add_u32 v162, v162, v5
  v_lshrrev_b32 v6, 2, v3
  v_mul_u32_u24 v161, 155648, v6
  v_lshl_add_u32 v161, v2, 6, v161
  v_and_b32 v6, 1, v6
  v_lshlrev_b32 v6, 1, v6
  v_and_b32 v8, 3, v1
  v_xor_b32 v6, v6, v8
  v_lshl_add_u32 v161, v6, 4, v161
  v_add_u32 v161, 512, v161
  v_mov_b32 v7, 0x3f803f80
  v_cmp_eq_u32 vcc, 3, v6
  s_nop 1
  v_cndmask_b32 v5, v7, 0, vcc
  v_cmp_lt_u32 vcc, 1, v6
  s_waitcnt vmcnt(8)
  s_barrier
  ds_read_b128 v[104:107], v16 offset:0
  ds_read_b64_tr_b16 v[112:113], v18 offset:0
  ds_read_b64_tr_b16 v[114:115], v18 offset:1280
  ds_read_b64_tr_b16 v[116:117], v19 offset:0
  ds_read_b64_tr_b16 v[118:119], v19 offset:1280
  ds_read_b64_tr_b16 v[120:121], v19 offset:72
  ds_read_b64_tr_b16 v[122:123], v19 offset:1352
  ds_read_b64_tr_b16 v[124:125], v19 offset:144
  ds_read_b64_tr_b16 v[126:127], v19 offset:1424
  ds_read_b64_tr_b16 v[128:129], v20 offset:0
  ds_read_b64_tr_b16 v[130:131], v20 offset:1280
  s_waitcnt lgkmcnt(0)
  v_mfma_f32_32x32x16_bf16 v[24:39], v[104:107], v[112:115], v[24:39]
  ds_read_b128 v[108:111], v17 offset:0
  ds_read_b64_tr_b16 v[132:133], v18 offset:5120
  ds_read_b64_tr_b16 v[134:135], v18 offset:6400
  s_add_u32 m0, s25, 55296
  s_add_u32 s38, s38, 1
  buffer_load_dwordx4 v11, s[4:7], s44 offen lds
  v_mfma_f32_32x32x16_bf16 v[40:55], v[104:107], v[116:119], v[40:55]
  ds_read_b64_tr_b16 v[136:137], v19 offset:5120
  ds_read_b64_tr_b16 v[138:139], v19 offset:6400
  ds_read_b64_tr_b16 v[140:141], v19 offset:5192
  ds_read_b64_tr_b16 v[142:143], v19 offset:6472
  buffer_load_dwordx4 v12, s[4:7], s44 offen offset:1024 lds
  s_add_u32 m0, s26, 55296
  s_add_u32 s44, s44, 64
  v_mfma_f32_32x32x16_bf16 v[56:71], v[104:107], v[120:123], v[56:71]
  ds_read_b64_tr_b16 v[144:145], v19 offset:5264
  ds_read_b64_tr_b16 v[146:147], v19 offset:6544
  ds_read_b64_tr_b16 v[148:149], v20 offset:5120
  ds_read_b64_tr_b16 v[150:151], v20 offset:6400
  buffer_load_dwordx4 v13, s[8:11], s45 offen lds
  v_mfma_f32_32x32x16_bf16 v[72:87], v[104:107], v[124:127], v[72:87]
  buffer_load_dwordx4 v14, s[8:11], s45 offen offset:1024 lds
  s_cmp_eq_u32 s46, 0
  v_mfma_f32_32x32x16_bf16 v[88:103], v[104:107], v[128:131], v[88:103]
  s_cbranch_scc1 QS_120
  buffer_load_dwordx4 v15, s[8:11], s45 offen offset:2048 lds
QS_120:
  s_add_u32 s45, s45, 110592
  s_cmp_eq_u32 s38, 18
  s_cselect_b32 s44, s23, s44
  s_cselect_b32 s45, s24, s45
  s_add_u32 s47, s47, 1
  s_cmp_eq_u32 s47, 18
  s_cselect_b32 s44, 1073741824, s44
  s_cselect_b32 s45, 1073741824, s45
  s_mov_b32 s48, 4
.p2align 4
QL_121:
  s_cmp_eq_u32 s46, 1
  s_waitcnt vmcnt(10) lgkmcnt(0)
  v_mfma_f32_32x32x16_bf16 v[24:39], v[108:111], v[132:135], v[24:39]
  s_cbranch_scc1 QW_122
  s_waitcnt vmcnt(8)
QW_122:
  s_barrier
  ds_read_b128 v[104:107], v16 offset:18432
  ds_read_b64_tr_b16 v[112:113], v18 offset:18432
  ds_read_b64_tr_b16 v[114:115], v18 offset:19712
  s_add_u32 m0, s25, 0
  s_add_u32 s38, s38, 1
  buffer_load_dwordx4 v11, s[4:7], s44 offen lds
  v_mfma_f32_32x32x16_bf16 v[40:55], v[108:111], v[136:139], v[40:55]
  ds_read_b64_tr_b16 v[116:117], v19 offset:18432
  ds_read_b64_tr_b16 v[118:119], v19 offset:19712
  ds_read_b64_tr_b16 v[120:121], v19 offset:18504
  ds_read_b64_tr_b16 v[122:123], v19 offset:19784
  v_mfma_f32_32x32x16_bf16 v[56:71], v[108:111], v[140:143], v[56:71]
  ds_read_b64_tr_b16 v[124:125], v19 offset:18576
  ds_read_b64_tr_b16 v[126:127], v19 offset:19856
  ds_read_b64_tr_b16 v[128:129], v20 offset:18432
  ds_read_b64_tr_b16 v[130:131], v20 offset:19712
  v_mfma_f32_32x32x16_bf16 v[72:87], v[108:111], v[144:147], v[72:87]
  buffer_load_dwordx4 v12, s[4:7], s44 offen offset:1024 lds
  s_add_u32 m0, s26, 0
  s_add_u32 s44, s44, 64
  v_mfma_f32_32x32x16_bf16 v[88:103], v[108:111], v[148:151], v[88:103]
  buffer_load_dwordx4 v13, s[8:11], s45 offen lds
  s_waitcnt lgkmcnt(0)
  v_mfma_f32_32x32x16_bf16 v[24:39], v[104:107], v[112:115], v[24:39]
  ds_read_b128 v[108:111], v17 offset:18432
  ds_read_b64_tr_b16 v[132:133], v18 offset:23552
  ds_read_b64_tr_b16 v[134:135], v18 offset:24832
  v_mfma_f32_32x32x16_bf16 v[40:55], v[104:107], v[116:119], v[40:55]
  ds_read_b64_tr_b16 v[136:137], v19 offset:23552
  ds_read_b64_tr_b16 v[138:139], v19 offset:24832
  ds_read_b64_tr_b16 v[140:141], v19 offset:23624
  ds_read_b64_tr_b16 v[142:143], v19 offset:24904
  v_mfma_f32_32x32x16_bf16 v[56:71], v[104:107], v[120:123], v[56:71]
  ds_read_b64_tr_b16 v[144:145], v19 offset:23696
  ds_read_b64_tr_b16 v[146:147], v19 offset:24976
  ds_read_b64_tr_b16 v[148:149], v20 offset:23552
  ds_read_b64_tr_b16 v[150:151], v20 offset:24832
  buffer_load_dwordx4 v14, s[8:11], s45 offen offset:1024 lds
  s_cmp_eq_u32 s46, 0
  v_mfma_f32_32x32x16_bf16 v[72:87], v[104:107], v[124:127], v[72:87]
  s_cbranch_scc1 QS_123
  buffer_load_dwordx4 v15, s[8:11], s45 offen offset:2048 lds
QS_123:
  s_add_u32 s45, s45, 110592
  s_cmp_eq_u32 s38, 18
  s_cselect_b32 s44, s23, s44
  s_cselect_b32 s45, s24, s45
  s_add_u32 s47, s47, 1
  s_cmp_eq_u32 s47, 18
  s_cselect_b32 s44, 1073741824, s44
  s_cselect_b32 s45, 1073741824, s45
  v_mfma_f32_32x32x16_bf16 v[88:103], v[104:107], v[128:131], v[88:103]
  s_cmp_eq_u32 s46, 1
  s_waitcnt vmcnt(10) lgkmcnt(0)
  v_mfma_f32_32x32x16_bf16 v[24:39], v[108:111], v[132:135], v[24:39]
  s_cbranch_scc1 QW_124
  s_waitcnt vmcnt(8)
QW_124:
  s_barrier
  ds_read_b128 v[104:107], v16 offset:36864
  ds_read_b64_tr_b16 v[112:113], v18 offset:36864
  ds_read_b64_tr_b16 v[114:115], v18 offset:38144
  s_add_u32 m0, s25, 18432
  s_add_u32 s38, s38, 1
  buffer_load_dwordx4 v11, s[4:7], s44 offen lds
  v_mfma_f32_32x32x16_bf16 v[40:55], v[108:111], v[136:139], v[40:55]
  ds_read_b64_tr_b16 v[116:117], v19 offset:36864
  ds_read_b64_tr_b16 v[118:119], v19 offset:38144
  ds_read_b64_tr_b16 v[120:121], v19 offset:36936
  ds_read_b64_tr_b16 v[122:123], v19 offset:38216
  v_mfma_f32_32x32x16_bf16 v[56:71], v[108:111], v[140:143], v[56:71]
  ds_read_b64_tr_b16 v[124:125], v19 offset:37008
  ds_read_b64_tr_b16 v[126:127], v19 offset:38288
  ds_read_b64_tr_b16 v[128:129], v20 offset:36864
  ds_read_b64_tr_b16 v[130:131], v20 offset:38144
  v_mfma_f32_32x32x16_bf16 v[72:87], v[108:111], v[144:147], v[72:87]
  buffer_load_dwordx4 v12, s[4:7], s44 offen offset:1024 lds
  s_add_u32 m0, s26, 18432
  s_add_u32 s44, s44, 64
  v_mfma_f32_32x32x16_bf16 v[88:103], v[108:111], v[148:151], v[88:103]
  buffer_load_dwordx4 v13, s[8:11], s45 offen lds
  s_waitcnt lgkmcnt(0)
  v_mfma_f32_32x32x16_bf16 v[24:39], v[104:107], v[112:115], v[24:39]
  ds_read_b128 v[108:111], v17 offset:36864
  ds_read_b64_tr_b16 v[132:133], v18 offset:41984
  ds_read_b64_tr_b16 v[134:135], v18 offset:43264
  v_mfma_f32_32x32x16_bf16 v[40:55], v[104:107], v[116:119], v[40:55]
  ds_read_b64_tr_b16 v[136:137], v19 offset:41984
  ds_read_b64_tr_b16 v[138:139], v19 offset:43264
  ds_read_b64_tr_b16 v[140:141], v19 offset:42056
  ds_read_b64_tr_b16 v[142:143], v19 offset:43336
  v_mfma_f32_32x32x16_bf16 v[56:71], v[104:107], v[120:123], v[56:71]
  ds_read_b64_tr_b16 v[144:145], v19 offset:42128
  ds_read_b64_tr_b16 v[146:147], v19 offset:43408
  ds_read_b64_tr_b16 v[148:149], v20 offset:41984
  ds_read_b64_tr_b16 v[150:151], v20 offset:43264
  buffer_load_dwordx4 v14, s[8:11], s45 offen offset:1024 lds
  s_cmp_eq_u32 s46, 0
  v_mfma_f32_32x32x16_bf16 v[72:87], v[104:107], v[124:127], v[72:87]
  s_cbranch_scc1 QS_125
  buffer_load_dwordx4 v15, s[8:11], s45 offen offset:2048 lds
QS_125:
  s_add_u32 s45, s45, 110592
  s_cmp_eq_u32 s38, 18
  s_cselect_b32 s44, s23, s44
  s_cselect_b32 s45, s24, s45
  s_add_u32 s47, s47, 1
  s_cmp_eq_u32 s47, 18
  s_cselect_b32 s44, 1073741824, s44
  s_cselect_b32 s45, 1073741824, s45
  v_mfma_f32_32x32x16_bf16 v[88:103], v[104:107], v[128:131], v[88:103]
  s_cmp_eq_u32 s46, 1
  s_waitcnt vmcnt(10) lgkmcnt(0)
  v_mfma_f32_32x32x16_bf16 v[24:39], v[108:111], v[132:135], v[24:39]
  s_cbranch_scc1 QW_126
  s_waitcnt vmcnt(8)
QW_126:
  s_barrier
  ds_read_b128 v[104:107], v16 offset:55296
  ds_read_b64_tr_b16 v[112:113], v18 offset:55296
  ds_read_b64_tr_b16 v[114:115], v18 offset:56576
  s_add_u32 m0, s25, 36864
  s_add_u32 s38, s38, 1
  buffer_load_dwordx4 v11, s[4:7], s44 offen lds
  v_mfma_f32_32x32x16_bf16 v[40:55], v[108:111], v[136:139], v[40:55]
  ds_read_b64_tr_b16 v[116:117], v19 offset:55296
  ds_read_b64_tr_b16 v[118:119], v19 offset:56576
  ds_read_b64_tr_b16 v[120:121], v19 offset:55368
  ds_read_b64_tr_b16 v[122:123], v19 offset:56648
  v_mfma_f32_32x32x16_bf16 v[56:71], v[108:111], v[140:143], v[56:71]
  ds_read_b64_tr_b16 v[124:125], v19 offset:55440
  ds_read_b64_tr_b16 v[126:127], v19 offset:56720
  ds_read_b64_tr_b16 v[128:129], v20 offset:55296
  ds_read_b64_tr_b16 v[130:131], v20 offset:56576
  v_mfma_f32_32x32x16_bf16 v[72:87], v[108:111], v[144:147], v[72:87]
  buffer_load_dwordx4 v12, s[4:7], s44 offen offset:1024 lds
  s_add_u32 m0, s26, 36864
  s_add_u32 s44, s44, 64
  v_mfma_f32_32x32x16_bf16 v[88:103], v[108:111], v[148:151], v[88:103]
  buffer_load_dwordx4 v13, s[8:11], s45 offen lds
  s_waitcnt lgkmcnt(0)
  v_mfma_f32_32x32x16_bf16 v[24:39], v[104:107], v[112:115], v[24:39]
  ds_read_b128 v[108:111], v17 offset:55296
  ds_read_b64_tr_b16 v[132:133], v18 offset:60416
  ds_read_b64_tr_b16 v[134:135], v18 offset:61696
  v_mfma_f32_32x32x16_bf16 v[40:55], v[104:107], v[116:119], v[40:55]
  ds_read_b64_tr_b16 v[136:137], v19 offset:60416
  ds_read_b64_tr_b16 v[138:139], v19 offset:61696
  ds_read_b64_tr_b16 v[140:141], v19 offset:60488
  ds_read_b64_tr_b16 v[142:143], v19 offset:61768
  v_mfma_f32_32x32x16_bf16 v[56:71], v[104:107], v[120:123], v[56:71]
  ds_read_b64_tr_b16 v[144:145], v19 offset:60560
  ds_read_b64_tr_b16 v[146:147], v19 offset:61840
  ds_read_b64_tr_b16 v[148:149], v20 offset:60416
  ds_read_b64_tr_b16 v[150:151], v20 offset:61696
  buffer_load_dwordx4 v14, s[8:11], s45 offen offset:1024 lds
  s_cmp_eq_u32 s46, 0
  v_mfma_f32_32x32x16_bf16 v[72:87], v[104:107], v[124:127], v[72:87]
  s_cbranch_scc1 QS_127
  buffer_load_dwordx4 v15, s[8:11], s45 offen offset:2048 lds
QS_127:
  s_add_u32 s45, s45, 110592
  s_cmp_eq_u32 s38, 18
  s_cselect_b32 s44, s23, s44
  s_cselect_b32 s45, s24, s45
  s_add_u32 s47, s47, 1
  s_cmp_eq_u32 s47, 18
  s_cselect_b32 s44, 1073741824, s44
  s_cselect_b32 s45, 1073741824, s45
  v_mfma_f32_32x32x16_bf16 v[88:103], v[104:107], v[128:131], v[88:103]
  s_cmp_eq_u32 s46, 1
  s_waitcnt vmcnt(10) lgkmcnt(0)
  v_mfma_f32_32x32x16_bf16 v[24:39], v[108:111], v[132:135], v[24:39]
  s_cbranch_scc1 QW_128
  s_waitcnt vmcnt(8)
QW_128:
  s_barrier
  ds_read_b128 v[104:107], v16 offset:0
  ds_read_b64_tr_b16 v[112:113], v18 offset:0
  ds_read_b64_tr_b16 v[114:115], v18 offset:1280
  s_add_u32 m0, s25, 55296
  s_add_u32 s38, s38, 1
  buffer_load_dwordx4 v11, s[4:7], s44 offen lds
  v_mfma_f32_32x32x16_bf16 v[40:55], v[108:111], v[136:139], v[40:55]
  ds_read_b64_tr_b16 v[116:117], v19 offset:0
  ds_read_b64_tr_b16 v[118:119], v19 offset:1280
  ds_read_b64_tr_b16 v[120:121], v19 offset:72
  ds_read_b64_tr_b16 v[122:123], v19 offset:1352
  v_mfma_f32_32x32x16_bf16 v[56:71], v[108:111], v[140:143], v[56:71]
  ds_read_b64_tr_b16 v[124:125], v19 offset:144
  ds_read_b64_tr_b16 v[126:127], v19 offset:1424
  ds_read_b64_tr_b16 v[128:129], v20 offset:0
  ds_read_b64_tr_b16 v[130:131], v20 offset:1280
  v_mfma_f32_32x32x16_bf16 v[72:87], v[108:111], v[144:147], v[72:87]
  buffer_load_dwordx4 v12, s[4:7], s44 offen offset:1024 lds
  s_add_u32 m0, s26, 55296
  s_add_u32 s44, s44, 64
  v_mfma_f32_32x32x16_bf16 v[88:103], v[108:111], v[148:151], v[88:103]
  buffer_load_dwordx4 v13, s[8:11], s45 offen lds
  s_waitcnt lgkmcnt(0)
  v_mfma_f32_32x32x16_bf16 v[24:39], v[104:107], v[112:115], v[24:39]
  ds_read_b128 v[108:111], v17 offset:0
  ds_read_b64_tr_b16 v[132:133], v18 offset:5120
  ds_read_b64_tr_b16 v[134:135], v18 offset:6400
  v_mfma_f32_32x32x16_bf16 v[40:55], v[104:107], v[116:119], v[40:55]
  ds_read_b64_tr_b16 v[136:137], v19 offset:5120
  ds_read_b64_tr_b16 v[138:139], v19 offset:6400
  ds_read_b64_tr_b16 v[140:141], v19 offset:5192
  ds_read_b64_tr_b16 v[142:143], v19 offset:6472
  v_mfma_f32_32x32x16_bf16 v[56:71], v[104:107], v[120:123], v[56:71]
  ds_read_b64_tr_b16 v[144:145], v19 offset:5264
  ds_read_b64_tr_b16 v[146:147], v19 offset:6544
  ds_read_b64_tr_b16 v[148:149], v20 offset:5120
  ds_read_b64_tr_b16 v[150:151], v20 offset:6400
  buffer_load_dwordx4 v14, s[8:11], s45 offen offset:1024 lds
  s_cmp_eq_u32 s46, 0
  v_mfma_f32_32x32x16_bf16 v[72:87], v[104:107], v[124:127], v[72:87]
  s_cbranch_scc1 QS_129
  buffer_load_dwordx4 v15, s[8:11], s45 offen offset:2048 lds
QS_129:
  s_add_u32 s45, s45, 110592
  s_cmp_eq_u32 s38, 18
  s_cselect_b32 s44, s23, s44
  s_cselect_b32 s45, s24, s45
  s_add_u32 s47, s47, 1
  s_cmp_eq_u32 s47, 18
  s_cselect_b32 s44, 1073741824, s44
  s_cselect_b32 s45, 1073741824, s45
  v_mfma_f32_32x32x16_bf16 v[88:103], v[104:107], v[128:131], v[88:103]
  s_sub_u32 s48, s48, 1
  s_cmp_lg_u32 s48, 0
  s_cbranch_scc1 QL_121
  s_cmp_eq_u32 s46, 1
  s_waitcnt vmcnt(10) lgkmcnt(0)
  v_mfma_f32_32x32x16_bf16 v[24:39], v[108:111], v[132:135], v[24:39]
  s_cbranch_scc1 QW_130
  s_waitcnt vmcnt(8)
QW_130:
  s_barrier
  buffer_load_dword v164, v163, s[12:15], 0 offen offset:132 sc1
  ds_read_b128 v[104:107], v16 offset:18432
  ds_read_b64_tr_b16 v[112:113], v18 offset:18432
  ds_read_b64_tr_b16 v[114:115], v18 offset:19712
  v_mfma_f32_32x32x16_bf16 v[40:55], v[108:111], v[136:139], v[40:55]
  ds_read_b64_tr_b16 v[116:117], v19 offset:18432
  ds_read_b64_tr_b16 v[118:119], v19 offset:19712
  ds_read_b64_tr_b16 v[120:121], v19 offset:18504
  ds_read_b64_tr_b16 v[122:123], v19 offset:19784
  v_mfma_f32_32x32x16_bf16 v[56:71], v[108:111], v[140:143], v[56:71]
  ds_read_b64_tr_b16 v[124:125], v19 offset:18576
  ds_read_b64_tr_b16 v[126:127], v19 offset:19856
  ds_read_b64_tr_b16 v[128:129], v20 offset:18432
  ds_read_b64_tr_b16 v[130:131], v20 offset:19712
  v_mfma_f32_32x32x16_bf16 v[72:87], v[108:111], v[144:147], v[72:87]
  v_mfma_f32_32x32x16_bf16 v[88:103], v[108:111], v[148:151], v[88:103]
  s_waitcnt lgkmcnt(0)
  v_mfma_f32_32x32x16_bf16 v[24:39], v[104:107], v[112:115], v[24:39]
  ds_read_b128 v[108:111], v17 offset:18432
  ds_read_b64_tr_b16 v[132:133], v18 offset:23552
  ds_read_b64_tr_b16 v[134:135], v18 offset:24832
  v_mfma_f32_32x32x16_bf16 v[40:55], v[104:107], v[116:119], v[40:55]
  ds_read_b64_tr_b16 v[136:137], v19 offset:23552
  ds_read_b64_tr_b16 v[138:139], v19 offset:24832
  ds_read_b64_tr_b16 v[140:141], v19 offset:23624
  ds_read_b64_tr_b16 v[142:143], v19 offset:24904
  v_mfma_f32_32x32x16_bf16 v[56:71], v[104:107], v[120:123], v[56:71]
  ds_read_b64_tr_b16 v[144:145], v19 offset:23696
  ds_read_b64_tr_b16 v[146:147], v19 offset:24976
  ds_read_b64_tr_b16 v[148:149], v20 offset:23552
  ds_read_b64_tr_b16 v[150:151], v20 offset:24832
  v_mfma_f32_32x32x16_bf16 v[72:87], v[104:107], v[124:127], v[72:87]
  v_mfma_f32_32x32x16_bf16 v[88:103], v[104:107], v[128:131], v[88:103]
  s_waitcnt lgkmcnt(0)
  v_mfma_f32_32x32x16_bf16 v[24:39], v[108:111], v[132:135], v[24:39]
  v_mfma_f32_32x32x16_bf16 v[40:55], v[108:111], v[136:139], v[40:55]
  v_mfma_f32_32x32x16_bf16 v[56:71], v[108:111], v[140:143], v[56:71]
  v_mfma_f32_32x32x16_bf16 v[72:87], v[108:111], v[144:147], v[72:87]
  v_mfma_f32_32x32x16_bf16 v[88:103], v[108:111], v[148:151], v[88:103]
  s_add_u32 s29, s32, 0
  s_nop 6
  v_cvt_pk_bf16_f32 v152, v24, v25
  v_cvt_pk_bf16_f32 v153, v26, v27
  v_cvt_pk_bf16_f32 v154, v28, v29
  v_cvt_pk_bf16_f32 v155, v30, v31
  buffer_store_dwordx4 v[152:155], v160, s[16:19], s29 offen offset:0 sc1
  v_cvt_pk_bf16_f32 v156, v32, v33
  v_cvt_pk_bf16_f32 v157, v34, v35
  v_cvt_pk_bf16_f32 v158, v36, v37
  v_cvt_pk_bf16_f32 v159, v38, v39
  buffer_store_dwordx4 v[156:159], v160, s[16:19], s29 offen offset:640 sc1
  s_add_u32 s29, s32, 155648
  v_cvt_pk_bf16_f32 v152, v40, v41
  v_cvt_pk_bf16_f32 v153, v42, v43
  v_cvt_pk_bf16_f32 v154, v44, v45
  v_cvt_pk_bf16_f32 v155, v46, v47
  buffer_store_dwordx4 v[152:155], v162, s[16:19], s29 offen offset:0 sc1
  v_cvt_pk_bf16_f32 v156, v48, v49
  v_cvt_pk_bf16_f32 v157, v50, v51
  v_cvt_pk_bf16_f32 v158, v52, v53
  v_cvt_pk_bf16_f32 v159, v54, v55
  buffer_store_dwordx4 v[156:159], v162, s[16:19], s29 offen offset:640 sc1
  s_add_u32 s29, s32, 466944
  v_cvt_pk_bf16_f32 v152, v56, v57
  v_cvt_pk_bf16_f32 v153, v58, v59
  v_cvt_pk_bf16_f32 v154, v60, v61
  v_cvt_pk_bf16_f32 v155, v62, v63
  buffer_store_dwordx4 v[152:155], v162, s[16:19], s29 offen offset:0 sc1
  v_cvt_pk_bf16_f32 v156, v64, v65
  v_cvt_pk_bf16_f32 v157, v66, v67
  v_cvt_pk_bf16_f32 v158, v68, v69
  v_cvt_pk_bf16_f32 v159, v70, v71
  buffer_store_dwordx4 v[156:159], v162, s[16:19], s29 offen offset:640 sc1
  s_add_u32 s29, s32, 778240
  v_cvt_pk_bf16_f32 v152, v72, v73
  v_cvt_pk_bf16_f32 v153, v74, v75
  v_cvt_pk_bf16_f32 v154, v76, v77
  v_cvt_pk_bf16_f32 v155, v78, v79
  buffer_store_dwordx4 v[152:155], v162, s[16:19], s29 offen offset:0 sc1
  v_cvt_pk_bf16_f32 v156, v80, v81
  v_cvt_pk_bf16_f32 v157, v82, v83
  v_cvt_pk_bf16_f32 v158, v84, v85
  v_cvt_pk_bf16_f32 v159, v86, v87
  buffer_store_dwordx4 v[156:159], v162, s[16:19], s29 offen offset:640 sc1
  v_cvt_pk_bf16_f32 v152, v88, v89
  v_cndmask_b32 v152, v152, v5, vcc
  v_cvt_pk_bf16_f32 v153, v90, v91
  v_cndmask_b32 v153, v153, v5, vcc
  v_cvt_pk_bf16_f32 v154, v92, v93
  v_cndmask_b32 v154, v154, v5, vcc
  v_cvt_pk_bf16_f32 v155, v94, v95
  v_cndmask_b32 v155, v155, v5, vcc
  buffer_store_dwordx4 v[152:155], v161, s[16:19], s32 offen offset:0 sc1
  v_cvt_pk_bf16_f32 v156, v96, v97
  v_cndmask_b32 v156, v156, v5, vcc
  v_cvt_pk_bf16_f32 v157, v98, v99
  v_cndmask_b32 v157, v157, v5, vcc
  v_cvt_pk_bf16_f32 v158, v100, v101
  v_cndmask_b32 v158, v158, v5, vcc
  v_cvt_pk_bf16_f32 v159, v102, v103
  v_cndmask_b32 v159, v159, v5, vcc
  buffer_store_dwordx4 v[156:159], v161, s[16:19], s32 offen offset:640 sc1
QDONE_103:
  s_lshl_b32 s29, s28, 8
  s_add_u32 s29, s29, 17387520
  s_waitcnt vmcnt(0)
  v_cmp_ne_u32 vcc, 1, v164
  s_nop 4
  s_cbranch_vccz QF0_131
  s_cmp_lg_u32 s20, 0
  s_cbranch_scc1 PF0_132
  v_mov_b32 v5, 4
  s_mov_b32 s30, 0x20000
POLL_133:
  buffer_load_dword v6, v5, s[12:15], 0 offen offset:128 sc1
  s_waitcnt vmcnt(0)
  v_cmp_ne_u32 vcc, 1, v6
  s_nop 4
  s_cbranch_vccz POLLD_134
  s_sleep 2
  s_sub_u32 s30, s30, 1
  s_cmp_lg_u32 s30, 0
  s_cbranch_scc1 POLL_133
POLLD_134:
PF0_132:
QF0_131:
  s_waitcnt vmcnt(0)
  s_barrier
  s_cmp_lg_u32 s20, 0
  s_cbranch_scc1 SIG_135
  v_mov_b32 v5, 0
  v_mov_b32 v6, 1
  v_mov_b32 v7, 1
  s_mov_b64 exec, 1
  buffer_atomic_add v6, v5, s[16:19], s29 offen sc0 sc1
  s_waitcnt vmcnt(0)
  v_readfirstlane_b32 s43, v6
  s_nop 0
  s_cmp_lg_u32 s43, 47
  s_cbranch_scc1 SIGR_136
  buffer_store_dword v7, v5, s[16:19], s29 offen offset:128 sc1
SIGR_136:
  s_mov_b64 exec, -1
SIG_135:
ATT0_5:
  s_setprio 1
  s_and_b32 s21, s2, 7
  s_lshl_b32 s21, s21, 2
  s_lshr_b32 s27, s2, 6
  s_add_u32 s21, s21, s27
  s_bfe_u32 s22, s2, 0x30003
  s_lshl_b32 s34, s22, 3
  s_lshl_b32 s27, s20, 1
  s_add_u32 s34, s34, s27
  s_mul_i32 s23, s21, 155648
  s_add_u32 s23, s23, 10031104
  s_mul_i32 s25, s20, 5120
  s_add_u32 s24, s23, s25
  v_lshlrev_b32 v11, 2, v3
  v_cmp_gt_u32 vcc, 32, v1
  v_mov_b32 v5, 1073741824
  s_nop 0
  v_cndmask_b32 v16, v5, v11, vcc
  v_cndmask_b32 v17, 0, -1, vcc
  v_add_u32 v11, 8192, v11
  s_and_b32 s27, s21, 1
  s_lshl_b32 s27, s27, 1
  v_subrev_u32 v5, s27, v3
  v_lshlrev_b32 v6, 8, v2
  v_lshl_add_u32 v12, v5, 4, v6
  v_and_b32 v7, 1, v3
  v_cmp_lt_u32 vcc, 17, v3
  s_nop 1
  v_cndmask_b32 v7, v7, 3, vcc
  v_and_b32 v8, 27, v3
  v_cmp_eq_u32 vcc, 18, v8
  s_nop 1
  v_cndmask_b32 v7, v7, 2, vcc
  v_lshlrev_b32 v6, 6, v2
  v_lshl_add_u32 v7, v7, 4, v6
  v_add_u32 v7, 512, v7
  v_cmp_lt_u32 vcc, 15, v5
  s_nop 1
  v_cndmask_b32 v12, v12, v7, vcc
  v_add_u32 v12, 9216, v12
  v_mov_b32 v29, 0
  v_mov_b32 v30, 0
  v_mov_b32 v31, 0
  v_mov_b32 v33, 0
  v_mov_b32 v34, 0
  v_mov_b32 v35, 0
  v_mov_b32 v113, 0x3f803f80
  v_mov_b32 v114, 0x3f80
  v_mov_b32 v115, 0
  v_mov_b32 v36, 0
  v_mov_b32 v37, 0
  v_mov_b32 v38, 0
  v_mov_b32 v39, 0
  v_mov_b32 v40, 0
  v_mov_b32 v41, 0
  v_mov_b32 v42, 0
  v_mov_b32 v43, 0
  v_mov_b32 v44, 0
  v_mov_b32 v45, 0
  v_mov_b32 v46, 0
  v_mov_b32 v47, 0
  v_mov_b32 v48, 0
  v_mov_b32 v49, 0
  v_mov_b32 v50, 0
  v_mov_b32 v51, 0
  v_mov_b32 v52, 0
  v_mov_b32 v53, 0
  v_mov_b32 v54, 0
  v_mov_b32 v55, 0
  v_mov_b32 v56, 0
  v_mov_b32 v57, 0
  v_mov_b32 v58, 0
  v_mov_b32 v59, 0
  v_mov_b32 v60, 0
  v_mov_b32 v61, 0
  v_mov_b32 v62, 0
  v_mov_b32 v63, 0
  v_mov_b32 v64, 0
  v_mov_b32 v65, 0
  v_mov_b32 v66, 0
  v_mov_b32 v67, 0
  v_mov_b32 v120, 0
  v_mov_b32 v104, 0
  v_mov_b32 v121, 0
  v_mov_b32 v105, 0
  v_mov_b32 v122, 0
  v_mov_b32 v106, 0
  v_mov_b32 v123, 0
  v_mov_b32 v107, 0
  v_mov_b32 v13, v4
  v_mov_b32 v14, v11
  v_mov_b32 v15, v12
  s_mov_b32 s30, 0
  s_mov_b32 s33, 0
  s_cmp_lg_u32 s20, 0
  s_cbranch_scc1 APOLL_137
  s_lshr_b32 s27, s21, 3
  s_lshl_b32 s27, s27, 8
  s_add_u32 s27, s27, 17387520
  v_mov_b32 v5, 0
  s_mov_b32 s28, 0x20000
POLL_138:
  buffer_load_dword v6, v5, s[16:19], s27 offen offset:128 sc1
  s_waitcnt vmcnt(0)
  v_cmp_ne_u32 vcc, 1, v6
  s_nop 4
  s_cbranch_vccz POLLD_139
  s_sleep 2
  s_sub_u32 s28, s28, 1
  s_cmp_lg_u32 s28, 0
  s_cbranch_scc1 POLL_138
POLLD_139:
APOLL_137:
  s_barrier
  s_mov_b32 s27, 17402880
  v_mov_b32 v5, 0
  buffer_load_dword v9, v5, s[16:19], s27 offen offset:128 sc1
  s_lshl_b32 s27, s21, 6
  s_add_u32 s27, s27, s34
  s_lshl_b32 s28, s27, 7
  s_lshl_b32 s27, s27, 10
  s_add_u32 s27, s27, 7671808
  s_add_u32 s28, s28, 9768960
  buffer_load_dwordx4 v[20:23], v4, s[16:19], s27 offen offset:0 sc1
  buffer_load_dword v28, v16, s[16:19], s28 offen offset:0 sc1
  buffer_load_dwordx4 v[24:27], v4, s[16:19], s27 offen offset:1024 sc1
  buffer_load_dword v32, v16, s[16:19], s28 offen offset:128 sc1
  s_mov_b32 s32, 0
  s_add_u32 m0, s32, s25
  s_add_u32 s27, s24, 4096
  buffer_load_dwordx4 v4, s[16:19], s24 offen offset:0 sc1 lds
  buffer_load_dwordx4 v4, s[16:19], s24 offen offset:1024 sc1 lds
  buffer_load_dwordx4 v4, s[16:19], s24 offen offset:2048 sc1 lds
  buffer_load_dwordx4 v4, s[16:19], s24 offen offset:3072 sc1 lds
  s_add_u32 m0, m0, 4096
  s_add_u32 s24, s24, 19456
  buffer_load_dwordx4 v4, s[16:19], s27 offen offset:0 sc1 lds
  s_add_u32 s32, s32, 20480
  s_cmp_eq_u32 s32, 81920
  s_cselect_b32 s32, 0, s32
  s_add_u32 m0, s32, s25
  s_add_u32 s27, s24, 4096
  buffer_load_dwordx4 v4, s[16:19], s24 offen offset:0 sc1 lds
  buffer_load_dwordx4 v4, s[16:19], s24 offen offset:1024 sc1 lds
  buffer_load_dwordx4 v4, s[16:19], s24 offen offset:2048 sc1 lds
  buffer_load_dwordx4 v4, s[16:19], s24 offen offset:3072 sc1 lds
  s_add_u32 m0, m0, 4096
  s_add_u32 s24, s24, 19456
  buffer_load_dwordx4 v4, s[16:19], s27 offen offset:0 sc1 lds
  s_add_u32 s32, s32, 20480
  s_cmp_eq_u32 s32, 81920
  s_cselect_b32 s32, 0, s32
  s_waitcnt vmcnt(5)
  s_barrier
  v_readfirstlane_b32 s31, v9
  s_lshl_b32 s27, s34, 8
  s_add_u32 s27, s27, 15011840
  v_lshlrev_b32 v5, 3, v3
  buffer_load_dword v9, v5, s[16:19], s27 offen offset:0 sc1
  buffer_load_dword v10, v5, s[16:19], s27 offen offset:256 sc1
  ds_read_b128 v[108:111], v13
  ds_read_b32 v112, v14
  ds_read_b128 v[116:119], v15
  s_waitcnt lgkmcnt(1)
  v_mfma_f32_32x32x16_bf16 v[68:83], v[108:111], v[20:23], 0
  v_mfma_f32_32x32x8_bf16 v[68:83], v[112:113], v[28:29], v[68:83]
  v_mfma_f32_32x32x16_bf16 v[84:99], v[108:111], v[24:27], 0
  v_mfma_f32_32x32x8_bf16 v[84:99], v[112:113], v[32:33], v[84:99]
  s_nop 9
  v_max3_f32 v124, v68, v69, v70
  v_max3_f32 v124, v124, v71, v72
  v_max3_f32 v124, v124, v73, v74
  v_max3_f32 v124, v124, v75, v76
  v_max3_f32 v124, v124, v77, v78
  v_max3_f32 v124, v124, v79, v80
  v_max3_f32 v124, v124, v81, v82
  v_max_f32 v124, v124, v83
  v_mov_b32 v5, v124
  s_nop 1
  v_permlane32_swap_b32 v124, v5
  v_max_f32 v124, v124, v5
  v_sub_f32 v124, 0, v124
  v_and_b32 v5, 0xffff0000, v124
  v_sub_f32 v124, v124, v5
  v_and_b32 v6, 0xffff0000, v124
  v_sub_f32 v124, v124, v6
  v_lshrrev_b32 v5, 16, v5
  v_or_b32 v5, v5, v6
  v_and_b32 v29, v5, v17
  v_lshrrev_b32 v124, 16, v124
  v_bfi_b32 v29, v17, v5, v124
  v_max3_f32 v125, v84, v85, v86
  v_max3_f32 v125, v125, v87, v88
  v_max3_f32 v125, v125, v89, v90
  v_max3_f32 v125, v125, v91, v92
  v_max3_f32 v125, v125, v93, v94
  v_max3_f32 v125, v125, v95, v96
  v_max3_f32 v125, v125, v97, v98
  v_max_f32 v125, v125, v99
  v_mov_b32 v5, v125
  s_nop 1
  v_permlane32_swap_b32 v125, v5
  v_max_f32 v125, v125, v5
  v_sub_f32 v125, 0, v125
  v_and_b32 v5, 0xffff0000, v125
  v_sub_f32 v125, v125, v5
  v_and_b32 v6, 0xffff0000, v125
  v_sub_f32 v125, v125, v6
  v_lshrrev_b32 v5, 16, v5
  v_or_b32 v5, v5, v6
  v_and_b32 v33, v5, v17
  v_lshrrev_b32 v125, 16, v125
  v_bfi_b32 v33, v17, v5, v125
  v_mfma_f32_32x32x16_bf16 v[68:83], v[108:111], v[20:23], 0
  v_mfma_f32_32x32x8_bf16 v[68:83], v[112:113], v[28:29], v[68:83]
  s_nop 7
  s_mov_b32 s26, 0
.p2align 4
ATT_140:
  v_mfma_f32_32x32x16_bf16 v[84:99], v[108:111], v[24:27], 0
  ds_read_b128 v[108:111], v13 offset:1024
  s_nop 0
  v_exp_f32 v68, v68
  v_exp_f32 v69, v69
  v_exp_f32 v70, v70
  v_cvt_pk_bf16_f32 v100, v68, v69
  v_exp_f32 v71, v71
  v_exp_f32 v72, v72
  v_mfma_f32_32x32x8_bf16 v[84:99], v[112:113], v[32:33], v[84:99]
  ds_read_b32 v112, v14 offset:128
  v_cvt_pk_bf16_f32 v101, v70, v71
  v_exp_f32 v73, v73
  v_exp_f32 v74, v74
  v_cvt_pk_bf16_f32 v102, v72, v73
  v_exp_f32 v75, v75
  v_exp_f32 v76, v76
  v_mfma_f32_32x32x16_bf16 v[52:67], v[120:123], v[104:107], v[52:67]
  s_waitcnt lgkmcnt(2)
  ds_read_b128 v[120:123], v15 offset:640
  v_cvt_pk_bf16_f32 v103, v74, v75
  v_exp_f32 v77, v77
  v_exp_f32 v78, v78
  v_cvt_pk_bf16_f32 v104, v76, v77
  v_exp_f32 v79, v79
  v_exp_f32 v80, v80
  v_mfma_f32_32x32x16_bf16 v[36:51], v[116:119], v[100:103], v[36:51]
  s_waitcnt lgkmcnt(1)
  v_cvt_pk_bf16_f32 v105, v78, v79
  v_exp_f32 v81, v81
  v_exp_f32 v82, v82
  v_exp_f32 v83, v83
  v_cvt_pk_bf16_f32 v106, v80, v81
  v_cvt_pk_bf16_f32 v107, v82, v83
  v_mfma_f32_32x32x16_bf16 v[68:83], v[108:111], v[20:23], 0
  s_cmp_ge_u32 s26, 6
  v_exp_f32 v84, v84
  v_exp_f32 v85, v85
  v_exp_f32 v86, v86
  v_cvt_pk_bf16_f32 v100, v84, v85
  v_exp_f32 v87, v87
  v_exp_f32 v88, v88
  v_mfma_f32_32x32x8_bf16 v[68:83], v[112:113], v[28:29], v[68:83]
  s_waitcnt lgkmcnt(0)
  v_cvt_pk_bf16_f32 v101, v86, v87
  v_exp_f32 v89, v89
  v_exp_f32 v90, v90
  v_cvt_pk_bf16_f32 v102, v88, v89
  v_exp_f32 v91, v91
  v_exp_f32 v92, v92
  v_mfma_f32_32x32x16_bf16 v[36:51], v[120:123], v[104:107], v[36:51]
  s_cselect_b32 s24, 1073741824, s24
  v_cvt_pk_bf16_f32 v103, v90, v91
  v_exp_f32 v93, v93
  v_exp_f32 v94, v94
  v_cvt_pk_bf16_f32 v104, v92, v93
  v_exp_f32 v95, v95
  v_exp_f32 v96, v96
  v_mfma_f32_32x32x16_bf16 v[52:67], v[116:119], v[100:103], v[52:67]
  ds_read_b128 v[116:119], v15 offset:1280
  v_cvt_pk_bf16_f32 v105, v94, v95
  v_exp_f32 v97, v97
  v_exp_f32 v98, v98
  v_exp_f32 v99, v99
  v_cvt_pk_bf16_f32 v106, v96, v97
  v_cvt_pk_bf16_f32 v107, v98, v99
  v_mfma_f32_32x32x16_bf16 v[84:99], v[108:111], v[24:27], 0
  ds_read_b128 v[108:111], v13 offset:2048
  v_exp_f32 v68, v68
  v_exp_f32 v69, v69
  v_exp_f32 v70, v70
  v_cvt_pk_bf16_f32 v100, v68, v69
  v_exp_f32 v71, v71
  v_exp_f32 v72, v72
  v_mfma_f32_32x32x8_bf16 v[84:99], v[112:113], v[32:33], v[84:99]
  ds_read_b32 v112, v14 offset:256
  v_cvt_pk_bf16_f32 v101, v70, v71
  v_exp_f32 v73, v73
  v_exp_f32 v74, v74
  v_cvt_pk_bf16_f32 v102, v72, v73
  v_exp_f32 v75, v75
  v_exp_f32 v76, v76
  v_mfma_f32_32x32x16_bf16 v[52:67], v[120:123], v[104:107], v[52:67]
  s_waitcnt lgkmcnt(2)
  ds_read_b128 v[120:123], v15 offset:1920
  v_cvt_pk_bf16_f32 v103, v74, v75
  v_exp_f32 v77, v77
  v_exp_f32 v78, v78
  v_cvt_pk_bf16_f32 v104, v76, v77
  v_exp_f32 v79, v79
  v_exp_f32 v80, v80
  v_mfma_f32_32x32x16_bf16 v[36:51], v[116:119], v[100:103], v[36:51]
  s_waitcnt lgkmcnt(1)
  v_cvt_pk_bf16_f32 v105, v78, v79
  v_exp_f32 v81, v81
  v_exp_f32 v82, v82
  v_exp_f32 v83, v83
  v_cvt_pk_bf16_f32 v106, v80, v81
  v_cvt_pk_bf16_f32 v107, v82, v83
  v_mfma_f32_32x32x16_bf16 v[68:83], v[108:111], v[20:23], 0
  s_add_u32 m0, s32, s25
  v_exp_f32 v84, v84
  v_exp_f32 v85, v85
  v_exp_f32 v86, v86
  v_cvt_pk_bf16_f32 v100, v84, v85
  v_exp_f32 v87, v87
  v_exp_f32 v88, v88
  v_mfma_f32_32x32x8_bf16 v[68:83], v[112:113], v[28:29], v[68:83]
  s_waitcnt lgkmcnt(0)
  v_cvt_pk_bf16_f32 v101, v86, v87
  v_exp_f32 v89, v89
  v_exp_f32 v90, v90
  v_cvt_pk_bf16_f32 v102, v88, v89
  v_exp_f32 v91, v91
  v_exp_f32 v92, v92
  v_mfma_f32_32x32x16_bf16 v[36:51], v[120:123], v[104:107], v[36:51]
  s_add_u32 s27, s24, 4096
  buffer_load_dwordx4 v4, s[16:19], s24 offen offset:0 sc1 lds
  v_cvt_pk_bf16_f32 v103, v90, v91
  v_exp_f32 v93, v93
  v_exp_f32 v94, v94
  v_cvt_pk_bf16_f32 v104, v92, v93
  v_exp_f32 v95, v95
  v_exp_f32 v96, v96
  v_mfma_f32_32x32x16_bf16 v[52:67], v[116:119], v[100:103], v[52:67]
  ds_read_b128 v[116:119], v15 offset:2560
  v_cvt_pk_bf16_f32 v105, v94, v95
  v_exp_f32 v97, v97
  v_exp_f32 v98, v98
  v_exp_f32 v99, v99
  v_cvt_pk_bf16_f32 v106, v96, v97
  v_cvt_pk_bf16_f32 v107, v98, v99
  v_mfma_f32_32x32x16_bf16 v[84:99], v[108:111], v[24:27], 0
  ds_read_b128 v[108:111], v13 offset:3072
  v_exp_f32 v68, v68
  v_exp_f32 v69, v69
  v_exp_f32 v70, v70
  v_cvt_pk_bf16_f32 v100, v68, v69
  v_exp_f32 v71, v71
  v_exp_f32 v72, v72
  v_mfma_f32_32x32x8_bf16 v[84:99], v[112:113], v[32:33], v[84:99]
  ds_read_b32 v112, v14 offset:384
  v_cvt_pk_bf16_f32 v101, v70, v71
  v_exp_f32 v73, v73
  v_exp_f32 v74, v74
  v_cvt_pk_bf16_f32 v102, v72, v73
  v_exp_f32 v75, v75
  v_exp_f32 v76, v76
  v_mfma_f32_32x32x16_bf16 v[52:67], v[120:123], v[104:107], v[52:67]
  s_waitcnt lgkmcnt(2)
  ds_read_b128 v[120:123], v15 offset:3200
  v_cvt_pk_bf16_f32 v103, v74, v75
  v_exp_f32 v77, v77
  v_exp_f32 v78, v78
  v_cvt_pk_bf16_f32 v104, v76, v77
  v_exp_f32 v79, v79
  v_exp_f32 v80, v80
  v_mfma_f32_32x32x16_bf16 v[36:51], v[116:119], v[100:103], v[36:51]
  s_waitcnt lgkmcnt(1)
  v_cvt_pk_bf16_f32 v105, v78, v79
  v_exp_f32 v81, v81
  v_exp_f32 v82, v82
  v_exp_f32 v83, v83
  v_cvt_pk_bf16_f32 v106, v80, v81
  v_cvt_pk_bf16_f32 v107, v82, v83
  v_mfma_f32_32x32x16_bf16 v[68:83], v[108:111], v[20:23], 0
  buffer_load_dwordx4 v4, s[16:19], s24 offen offset:1024 sc1 lds
  v_exp_f32 v84, v84
  v_exp_f32 v85, v85
  v_exp_f32 v86, v86
  v_cvt_pk_bf16_f32 v100, v84, v85
  v_exp_f32 v87, v87
  v_exp_f32 v88, v88
  v_mfma_f32_32x32x8_bf16 v[68:83], v[112:113], v[28:29], v[68:83]
  s_waitcnt lgkmcnt(0)
  v_cvt_pk_bf16_f32 v101, v86, v87
  v_exp_f32 v89, v89
  v_exp_f32 v90, v90
  v_cvt_pk_bf16_f32 v102, v88, v89
  v_exp_f32 v91, v91
  v_exp_f32 v92, v92
  v_mfma_f32_32x32x16_bf16 v[36:51], v[120:123], v[104:107], v[36:51]
  buffer_load_dwordx4 v4, s[16:19], s24 offen offset:2048 sc1 lds
  v_cvt_pk_bf16_f32 v103, v90, v91
  v_exp_f32 v93, v93
  v_exp_f32 v94, v94
  v_cvt_pk_bf16_f32 v104, v92, v93
  v_exp_f32 v95, v95
  v_exp_f32 v96, v96
  v_mfma_f32_32x32x16_bf16 v[52:67], v[116:119], v[100:103], v[52:67]
  ds_read_b128 v[116:119], v15 offset:3840
  v_cvt_pk_bf16_f32 v105, v94, v95
  v_exp_f32 v97, v97
  v_exp_f32 v98, v98
  v_exp_f32 v99, v99
  v_cvt_pk_bf16_f32 v106, v96, v97
  v_cvt_pk_bf16_f32 v107, v98, v99
  v_mfma_f32_32x32x16_bf16 v[84:99], v[108:111], v[24:27], 0
  ds_read_b128 v[108:111], v13 offset:4096
  v_exp_f32 v68, v68
  v_exp_f32 v69, v69
  v_exp_f32 v70, v70
  v_cvt_pk_bf16_f32 v100, v68, v69
  v_exp_f32 v71, v71
  v_exp_f32 v72, v72
  v_mfma_f32_32x32x8_bf16 v[84:99], v[112:113], v[32:33], v[84:99]
  ds_read_b32 v112, v14 offset:512
  v_cvt_pk_bf16_f32 v101, v70, v71
  v_exp_f32 v73, v73
  v_exp_f32 v74, v74
  v_cvt_pk_bf16_f32 v102, v72, v73
  v_exp_f32 v75, v75
  v_exp_f32 v76, v76
  v_mfma_f32_32x32x16_bf16 v[52:67], v[120:123], v[104:107], v[52:67]
  s_waitcnt lgkmcnt(2)
  ds_read_b128 v[120:123], v15 offset:4480
  v_cvt_pk_bf16_f32 v103, v74, v75
  v_exp_f32 v77, v77
  v_exp_f32 v78, v78
  v_cvt_pk_bf16_f32 v104, v76, v77
  v_exp_f32 v79, v79
  v_exp_f32 v80, v80
  v_mfma_f32_32x32x16_bf16 v[36:51], v[116:119], v[100:103], v[36:51]
  s_waitcnt lgkmcnt(1)
  v_cvt_pk_bf16_f32 v105, v78, v79
  v_exp_f32 v81, v81
  v_exp_f32 v82, v82
  v_exp_f32 v83, v83
  v_cvt_pk_bf16_f32 v106, v80, v81
  v_cvt_pk_bf16_f32 v107, v82, v83
  v_mfma_f32_32x32x16_bf16 v[68:83], v[108:111], v[20:23], 0
  buffer_load_dwordx4 v4, s[16:19], s24 offen offset:3072 sc1 lds
  v_exp_f32 v84, v84
  v_exp_f32 v85, v85
  v_exp_f32 v86, v86
  v_cvt_pk_bf16_f32 v100, v84, v85
  v_exp_f32 v87, v87
  v_exp_f32 v88, v88
  v_mfma_f32_32x32x8_bf16 v[68:83], v[112:113], v[28:29], v[68:83]
  s_waitcnt lgkmcnt(0)
  v_cvt_pk_bf16_f32 v101, v86, v87
  v_exp_f32 v89, v89
  v_exp_f32 v90, v90
  v_cvt_pk_bf16_f32 v102, v88, v89
  v_exp_f32 v91, v91
  v_exp_f32 v92, v92
  v_mfma_f32_32x32x16_bf16 v[36:51], v[120:123], v[104:107], v[36:51]
  s_add_u32 m0, m0, 4096
  v_cvt_pk_bf16_f32 v103, v90, v91
  v_exp_f32 v93, v93
  v_exp_f32 v94, v94
  v_cvt_pk_bf16_f32 v104, v92, v93
  v_exp_f32 v95, v95
  v_exp_f32 v96, v96
  v_mfma_f32_32x32x16_bf16 v[52:67], v[116:119], v[100:103], v[52:67]
  ds_read_b128 v[116:119], v15 offset:5120
  v_cvt_pk_bf16_f32 v105, v94, v95
  v_exp_f32 v97, v97
  v_exp_f32 v98, v98
  v_exp_f32 v99, v99
  v_cvt_pk_bf16_f32 v106, v96, v97
  v_cvt_pk_bf16_f32 v107, v98, v99
  v_mfma_f32_32x32x16_bf16 v[84:99], v[108:111], v[24:27], 0
  ds_read_b128 v[108:111], v13 offset:5120
  v_exp_f32 v68, v68
  v_exp_f32 v69, v69
  v_exp_f32 v70, v70
  v_cvt_pk_bf16_f32 v100, v68, v69
  v_exp_f32 v71, v71
  v_exp_f32 v72, v72
  v_mfma_f32_32x32x8_bf16 v[84:99], v[112:113], v[32:33], v[84:99]
  ds_read_b32 v112, v14 offset:640
  v_cvt_pk_bf16_f32 v101, v70, v71
  v_exp_f32 v73, v73
  v_exp_f32 v74, v74
  v_cvt_pk_bf16_f32 v102, v72, v73
  v_exp_f32 v75, v75
  v_exp_f32 v76, v76
  v_mfma_f32_32x32x16_bf16 v[52:67], v[120:123], v[104:107], v[52:67]
  s_waitcnt lgkmcnt(2)
  ds_read_b128 v[120:123], v15 offset:5760
  v_cvt_pk_bf16_f32 v103, v74, v75
  v_exp_f32 v77, v77
  v_exp_f32 v78, v78
  v_cvt_pk_bf16_f32 v104, v76, v77
  v_exp_f32 v79, v79
  v_exp_f32 v80, v80
  v_mfma_f32_32x32x16_bf16 v[36:51], v[116:119], v[100:103], v[36:51]
  s_waitcnt lgkmcnt(1)
  v_cvt_pk_bf16_f32 v105, v78, v79
  v_exp_f32 v81, v81
  v_exp_f32 v82, v82
  v_exp_f32 v83, v83
  v_cvt_pk_bf16_f32 v106, v80, v81
  v_cvt_pk_bf16_f32 v107, v82, v83
  v_mfma_f32_32x32x16_bf16 v[68:83], v[108:111], v[20:23], 0
  s_add_u32 s24, s24, 19456
  buffer_load_dwordx4 v4, s[16:19], s27 offen offset:0 sc1 lds
  v_exp_f32 v84, v84
  v_exp_f32 v85, v85
  v_exp_f32 v86, v86
  v_cvt_pk_bf16_f32 v100, v84, v85
  v_exp_f32 v87, v87
  v_exp_f32 v88, v88
  v_mfma_f32_32x32x8_bf16 v[68:83], v[112:113], v[28:29], v[68:83]
  s_waitcnt lgkmcnt(0)
  v_cvt_pk_bf16_f32 v101, v86, v87
  v_exp_f32 v89, v89
  v_exp_f32 v90, v90
  v_cvt_pk_bf16_f32 v102, v88, v89
  v_exp_f32 v91, v91
  v_exp_f32 v92, v92
  v_mfma_f32_32x32x16_bf16 v[36:51], v[120:123], v[104:107], v[36:51]
  s_add_u32 s32, s32, 20480
  v_cvt_pk_bf16_f32 v103, v90, v91
  v_exp_f32 v93, v93
  v_exp_f32 v94, v94
  v_cvt_pk_bf16_f32 v104, v92, v93
  v_exp_f32 v95, v95
  v_exp_f32 v96, v96
  v_mfma_f32_32x32x16_bf16 v[52:67], v[116:119], v[100:103], v[52:67]
  ds_read_b128 v[116:119], v15 offset:6400
  v_cvt_pk_bf16_f32 v105, v94, v95
  v_exp_f32 v97, v97
  v_exp_f32 v98, v98
  v_exp_f32 v99, v99
  v_cvt_pk_bf16_f32 v106, v96, v97
  v_cvt_pk_bf16_f32 v107, v98, v99
  v_mfma_f32_32x32x16_bf16 v[84:99], v[108:111], v[24:27], 0
  ds_read_b128 v[108:111], v13 offset:6144
  v_exp_f32 v68, v68
  v_exp_f32 v69, v69
  v_exp_f32 v70, v70
  v_cvt_pk_bf16_f32 v100, v68, v69
  v_exp_f32 v71, v71
  v_exp_f32 v72, v72
  v_mfma_f32_32x32x8_bf16 v[84:99], v[112:113], v[32:33], v[84:99]
  ds_read_b32 v112, v14 offset:768
  v_cvt_pk_bf16_f32 v101, v70, v71
  v_exp_f32 v73, v73
  v_exp_f32 v74, v74
  v_cvt_pk_bf16_f32 v102, v72, v73
  v_exp_f32 v75, v75
  v_exp_f32 v76, v76
  v_mfma_f32_32x32x16_bf16 v[52:67], v[120:123], v[104:107], v[52:67]
  s_waitcnt lgkmcnt(2)
  ds_read_b128 v[120:123], v15 offset:7040
  v_cvt_pk_bf16_f32 v103, v74, v75
  v_exp_f32 v77, v77
  v_exp_f32 v78, v78
  v_cvt_pk_bf16_f32 v104, v76, v77
  v_exp_f32 v79, v79
  v_exp_f32 v80, v80
  v_mfma_f32_32x32x16_bf16 v[36:51], v[116:119], v[100:103], v[36:51]
  s_waitcnt lgkmcnt(1)
  v_cvt_pk_bf16_f32 v105, v78, v79
  v_exp_f32 v81, v81
  v_exp_f32 v82, v82
  v_exp_f32 v83, v83
  v_cvt_pk_bf16_f32 v106, v80, v81
  v_cvt_pk_bf16_f32 v107, v82, v83
  v_mfma_f32_32x32x16_bf16 v[68:83], v[108:111], v[20:23], 0
  s_cmp_eq_u32 s32, 81920
  s_cselect_b32 s32, 0, s32
  v_exp_f32 v84, v84
  v_exp_f32 v85, v85
  v_exp_f32 v86, v86
  v_cvt_pk_bf16_f32 v100, v84, v85
  v_exp_f32 v87, v87
  v_exp_f32 v88, v88
  v_mfma_f32_32x32x8_bf16 v[68:83], v[112:113], v[28:29], v[68:83]
  s_waitcnt lgkmcnt(0)
  v_cvt_pk_bf16_f32 v101, v86, v87
  v_exp_f32 v89, v89
  v_exp_f32 v90, v90
  v_cvt_pk_bf16_f32 v102, v88, v89
  v_exp_f32 v91, v91
  v_exp_f32 v92, v92
  v_mfma_f32_32x32x16_bf16 v[36:51], v[120:123], v[104:107], v[36:51]
  s_add_u32 s30, s30, 20480
  v_cvt_pk_bf16_f32 v103, v90, v91
  v_exp_f32 v93, v93
  v_exp_f32 v94, v94
  v_cvt_pk_bf16_f32 v104, v92, v93
  v_exp_f32 v95, v95
  v_exp_f32 v96, v96
  v_mfma_f32_32x32x16_bf16 v[52:67], v[116:119], v[100:103], v[52:67]
  ds_read_b128 v[116:119], v15 offset:7680
  v_cvt_pk_bf16_f32 v105, v94, v95
  v_exp_f32 v97, v97
  v_exp_f32 v98, v98
  v_exp_f32 v99, v99
  v_cvt_pk_bf16_f32 v106, v96, v97
  v_cvt_pk_bf16_f32 v107, v98, v99
  v_mfma_f32_32x32x16_bf16 v[84:99], v[108:111], v[24:27], 0
  ds_read_b128 v[108:111], v13 offset:7168
  v_exp_f32 v68, v68
  v_exp_f32 v69, v69
  v_exp_f32 v70, v70
  v_cvt_pk_bf16_f32 v100, v68, v69
  v_exp_f32 v71, v71
  v_exp_f32 v72, v72
  v_mfma_f32_32x32x8_bf16 v[84:99], v[112:113], v[32:33], v[84:99]
  ds_read_b32 v112, v14 offset:896
  v_cvt_pk_bf16_f32 v101, v70, v71
  v_exp_f32 v73, v73
  v_exp_f32 v74, v74
  v_cvt_pk_bf16_f32 v102, v72, v73
  v_exp_f32 v75, v75
  v_exp_f32 v76, v76
  v_mfma_f32_32x32x16_bf16 v[52:67], v[120:123], v[104:107], v[52:67]
  s_waitcnt lgkmcnt(2)
  ds_read_b128 v[120:123], v15 offset:8320
  v_cvt_pk_bf16_f32 v103, v74, v75
  v_exp_f32 v77, v77
  v_exp_f32 v78, v78
  v_cvt_pk_bf16_f32 v104, v76, v77
  v_exp_f32 v79, v79
  v_exp_f32 v80, v80
  v_mfma_f32_32x32x16_bf16 v[36:51], v[116:119], v[100:103], v[36:51]
  s_waitcnt lgkmcnt(1)
  v_cvt_pk_bf16_f32 v105, v78, v79
  v_exp_f32 v81, v81
  v_exp_f32 v82, v82
  v_exp_f32 v83, v83
  v_cvt_pk_bf16_f32 v106, v80, v81
  v_cvt_pk_bf16_f32 v107, v82, v83
  v_mfma_f32_32x32x16_bf16 v[68:83], v[108:111], v[20:23], 0
  s_cmp_eq_u32 s30, 81920
  s_cselect_b32 s30, 0, s30
  v_exp_f32 v84, v84
  v_exp_f32 v85, v85
  v_exp_f32 v86, v86
  v_cvt_pk_bf16_f32 v100, v84, v85
  v_exp_f32 v87, v87
  v_exp_f32 v88, v88
  v_mfma_f32_32x32x8_bf16 v[68:83], v[112:113], v[28:29], v[68:83]
  s_waitcnt lgkmcnt(0)
  v_cvt_pk_bf16_f32 v101, v86, v87
  v_exp_f32 v89, v89
  v_exp_f32 v90, v90
  v_cvt_pk_bf16_f32 v102, v88, v89
  v_exp_f32 v91, v91
  v_exp_f32 v92, v92
  v_mfma_f32_32x32x16_bf16 v[36:51], v[120:123], v[104:107], v[36:51]
  s_waitcnt vmcnt(5)
  s_barrier
  v_cvt_pk_bf16_f32 v103, v90, v91
  v_exp_f32 v93, v93
  v_exp_f32 v94, v94
  v_cvt_pk_bf16_f32 v104, v92, v93
  v_exp_f32 v95, v95
  v_exp_f32 v96, v96
  v_mfma_f32_32x32x16_bf16 v[52:67], v[116:119], v[100:103], v[52:67]
  ds_read_b128 v[116:119], v15 offset:8960
  v_add_u32 v13, s30, v4
  v_add_u32 v14, s30, v11
  v_cvt_pk_bf16_f32 v105, v94, v95
  v_exp_f32 v97, v97
  v_exp_f32 v98, v98
  v_exp_f32 v99, v99
  v_cvt_pk_bf16_f32 v106, v96, v97
  v_cvt_pk_bf16_f32 v107, v98, v99
  v_mfma_f32_32x32x16_bf16 v[84:99], v[108:111], v[24:27], 0
  ds_read_b128 v[108:111], v13 offset:0
  v_exp_f32 v68, v68
  v_exp_f32 v69, v69
  v_exp_f32 v70, v70
  v_cvt_pk_bf16_f32 v100, v68, v69
  v_exp_f32 v71, v71
  v_exp_f32 v72, v72
  v_mfma_f32_32x32x8_bf16 v[84:99], v[112:113], v[32:33], v[84:99]
  ds_read_b32 v112, v14 offset:0
  v_cvt_pk_bf16_f32 v101, v70, v71
  v_exp_f32 v73, v73
  v_exp_f32 v74, v74
  v_cvt_pk_bf16_f32 v102, v72, v73
  v_exp_f32 v75, v75
  v_exp_f32 v76, v76
  v_mfma_f32_32x32x16_bf16 v[52:67], v[120:123], v[104:107], v[52:67]
  s_waitcnt lgkmcnt(2)
  ds_read_b128 v[120:123], v15 offset:9600
  v_cvt_pk_bf16_f32 v103, v74, v75
  v_exp_f32 v77, v77
  v_exp_f32 v78, v78
  v_cvt_pk_bf16_f32 v104, v76, v77
  v_exp_f32 v79, v79
  v_exp_f32 v80, v80
  v_mfma_f32_32x32x16_bf16 v[36:51], v[116:119], v[100:103], v[36:51]
  s_waitcnt lgkmcnt(1)
  v_cvt_pk_bf16_f32 v105, v78, v79
  v_exp_f32 v81, v81
  v_exp_f32 v82, v82
  v_exp_f32 v83, v83
  v_cvt_pk_bf16_f32 v106, v80, v81
  v_cvt_pk_bf16_f32 v107, v82, v83
  v_mfma_f32_32x32x16_bf16 v[68:83], v[108:111], v[20:23], 0
  s_add_u32 s26, s26, 1
  v_exp_f32 v84, v84
  v_exp_f32 v85, v85
  v_exp_f32 v86, v86
  v_cvt_pk_bf16_f32 v100, v84, v85
  v_exp_f32 v87, v87
  v_exp_f32 v88, v88
  v_mfma_f32_32x32x8_bf16 v[68:83], v[112:113], v[28:29], v[68:83]
  s_waitcnt lgkmcnt(0)
  v_add_u32 v15, s30, v12
  v_cvt_pk_bf16_f32 v101, v86, v87
  v_exp_f32 v89, v89
  v_exp_f32 v90, v90
  v_cvt_pk_bf16_f32 v102, v88, v89
  v_exp_f32 v91, v91
  v_exp_f32 v92, v92
  v_mfma_f32_32x32x16_bf16 v[36:51], v[120:123], v[104:107], v[36:51]
  s_cmp_lt_u32 s26, 8
  v_cvt_pk_bf16_f32 v103, v90, v91
  v_exp_f32 v93, v93
  v_exp_f32 v94, v94
  v_cvt_pk_bf16_f32 v104, v92, v93
  v_exp_f32 v95, v95
  v_exp_f32 v96, v96
  v_mfma_f32_32x32x16_bf16 v[52:67], v[116:119], v[100:103], v[52:67]
  ds_read_b128 v[116:119], v15 offset:0
  v_cvt_pk_bf16_f32 v105, v94, v95
  v_exp_f32 v97, v97
  v_exp_f32 v98, v98
  v_exp_f32 v99, v99
  v_cvt_pk_bf16_f32 v106, v96, v97
  v_cvt_pk_bf16_f32 v107, v98, v99
  s_cbranch_scc1 ATT_140
  s_nop 0
  v_mfma_f32_32x32x16_bf16 v[52:67], v[120:123], v[104:107], v[52:67]
  s_setprio 3
  s_waitcnt vmcnt(0) lgkmcnt(0)
  s_mov_b32 s27, 0x71800000
  v_add_f32 v124, v46, abs(v36)
  s_nop 7
  v_add_f32 v125, v62, abs(v52)
  v_add_f32 v124, v124, abs(v37)
  v_add_f32 v125, v125, abs(v53)
  v_add_f32 v124, v124, abs(v38)
  v_add_f32 v125, v125, abs(v54)
  v_add_f32 v124, v124, abs(v39)
  v_add_f32 v125, v125, abs(v55)
  v_add_f32 v124, v124, abs(v40)
  v_add_f32 v125, v125, abs(v56)
  v_add_f32 v124, v124, abs(v41)
  v_add_f32 v125, v125, abs(v57)
  v_add_f32 v124, v124, abs(v42)
  v_add_f32 v125, v125, abs(v58)
  v_add_f32 v124, v124, abs(v43)
  v_add_f32 v125, v125, abs(v59)
  v_add_f32 v124, v124, abs(v44)
  v_add_f32 v125, v125, abs(v60)
  v_add_f32 v124, v124, abs(v45)
  v_add_f32 v125, v125, abs(v61)
  v_cmp_nge_f32 vcc, s27, v124
  v_cmp_nge_f32 s[40:41], s27, v125
  s_nop 1
  s_or_b64 vcc, vcc, s[40:41]
  s_nop 4
  s_cbranch_vccnz ATTFB_142
ATTFIN_141:
  s_cmp_eq_u32 s31, 1
  s_cbranch_scc1 AGOK_143
  s_mov_b32 s27, 17402880
  v_mov_b32 v5, 0
  s_mov_b32 s28, 0x20000
POLL_144:
  buffer_load_dword v6, v5, s[16:19], s27 offen offset:128 sc1
  s_waitcnt vmcnt(0)
  v_cmp_ne_u32 vcc, 1, v6
  s_nop 4
  s_cbranch_vccz POLLD_145
  s_sleep 2
  s_sub_u32 s28, s28, 1
  s_cmp_lg_u32 s28, 0
  s_cbranch_scc1 POLL_144
POLLD_145:
  s_lshl_b32 s27, s34, 8
  s_add_u32 s27, s27, 15011840
  v_lshlrev_b32 v5, 3, v3
  buffer_load_dword v9, v5, s[16:19], s27 offen offset:0 sc1
  buffer_load_dword v10, v5, s[16:19], s27 offen offset:256 sc1
AGOK_143:
  s_lshr_b32 s27, s21, 3
  s_mul_i32 s27, s27, 9
  s_mul_i32 s28, s34, 36
  s_add_u32 s27, s27, s28
  s_add_u32 s28, s27, 8
  s_and_b32 s29, s21, 7
  s_add_u32 s27, s27, s29
  s_lshl_b32 s27, s27, 10
  s_add_u32 s27, s27, 15028224
  s_lshl_b32 s28, s28, 10
  s_add_u32 s28, s28, 15028224
  s_lshl_b32 s29, s29, 7
  s_add_u32 s28, s28, s29
  v_mov_b32 v6, v16
  s_waitcnt vmcnt(0)
  v_rcp_f32 v5, v46
  s_nop 0
  v_mul_f32 v5, v5, v9
  v_mul_f32 v36, v36, v5
  v_mul_f32 v37, v37, v5
  v_mul_f32 v38, v38, v5
  v_mul_f32 v39, v39, v5
  v_mul_f32 v40, v40, v5
  v_mul_f32 v41, v41, v5
  v_mul_f32 v42, v42, v5
  v_mul_f32 v43, v43, v5
  v_mul_f32 v44, v44, v5
  v_mul_f32 v45, v45, v5
  v_cvt_pk_bf16_f32 v48, v36, v37
  v_cvt_pk_bf16_f32 v49, v38, v39
  v_cvt_pk_bf16_f32 v50, v40, v41
  v_cvt_pk_bf16_f32 v51, v42, v43
  v_cvt_pk_bf16_f32 v47, v44, v45
  buffer_store_dwordx4 v[48:51], v4, s[16:19], s27 offen sc1
  buffer_store_dword v47, v6, s[16:19], s28 offen sc1
  s_add_u32 s27, s27, 36864
  s_add_u32 s28, s28, 36864
  v_rcp_f32 v5, v62
  s_nop 0
  v_mul_f32 v5, v5, v10
  v_mul_f32 v52, v52, v5
  v_mul_f32 v53, v53, v5
  v_mul_f32 v54, v54, v5
  v_mul_f32 v55, v55, v5
  v_mul_f32 v56, v56, v5
  v_mul_f32 v57, v57, v5
  v_mul_f32 v58, v58, v5
  v_mul_f32 v59, v59, v5
  v_mul_f32 v60, v60, v5
  v_mul_f32 v61, v61, v5
  v_cvt_pk_bf16_f32 v64, v52, v53
  v_cvt_pk_bf16_f32 v65, v54, v55
  v_cvt_pk_bf16_f32 v66, v56, v57
  v_cvt_pk_bf16_f32 v67, v58, v59
  v_cvt_pk_bf16_f32 v63, v60, v61
  buffer_store_dwordx4 v[64:67], v4, s[16:19], s27 offen sc1
  buffer_store_dword v63, v6, s[16:19], s28 offen sc1
  s_lshl_b32 s27, s34, 7
  s_lshl_b32 s28, s21, 2
  s_add_u32 s27, s27, s28
  s_add_u32 s27, s27, 17394688
  v_mov_b32 v5, 0
  v_mov_b32 v7, 1
  s_waitcnt vmcnt(0)
  s_mov_b64 exec, 1
  buffer_store_dword v7, v5, s[16:19], s27 offen sc1
  s_mov_b64 exec, -1
  s_endpgm
ATTFB_142:
  v_mov_b32 v29, 0
  v_mov_b32 v30, 0
  v_mov_b32 v124, 0xff800000
  v_mov_b32 v33, 0
  v_mov_b32 v34, 0
  v_mov_b32 v125, 0xff800000
  v_mov_b32 v36, 0
  v_mov_b32 v37, 0
  v_mov_b32 v38, 0
  v_mov_b32 v39, 0
  v_mov_b32 v40, 0
  v_mov_b32 v41, 0
  v_mov_b32 v42, 0
  v_mov_b32 v43, 0
  v_mov_b32 v44, 0
  v_mov_b32 v45, 0
  v_mov_b32 v46, 0
  v_mov_b32 v47, 0
  v_mov_b32 v48, 0
  v_mov_b32 v49, 0
  v_mov_b32 v50, 0
  v_mov_b32 v51, 0
  v_mov_b32 v52, 0
  v_mov_b32 v53, 0
  v_mov_b32 v54, 0
  v_mov_b32 v55, 0
  v_mov_b32 v56, 0
  v_mov_b32 v57, 0
  v_mov_b32 v58, 0
  v_mov_b32 v59, 0
  v_mov_b32 v60, 0
  v_mov_b32 v61, 0
  v_mov_b32 v62, 0
  v_mov_b32 v63, 0
  v_mov_b32 v64, 0
  v_mov_b32 v65, 0
  v_mov_b32 v66, 0
  v_mov_b32 v67, 0
  s_mov_b32 s26, 0
ATTF1_146:
  s_lshr_b32 s27, s26, 3
  s_mul_i32 s27, s27, 19456
  s_add_u32 s27, s27, s23
  s_and_b32 s29, s26, 7
  s_lshl_b32 s28, s29, 10
  s_add_u32 s28, s28, s27
  buffer_load_dwordx4 v[108:111], v4, s[16:19], s28 offen sc1
  s_lshl_b32 s28, s29, 7
  s_add_u32 s28, s28, s27
  buffer_load_dword v112, v11, s[16:19], s28 offen sc1
  s_waitcnt vmcnt(0)
  v_mfma_f32_32x32x16_bf16 v[68:83], v[108:111], v[20:23], 0
  v_mfma_f32_32x32x8_bf16 v[68:83], v[112:113], v[28:29], v[68:83]
  v_mfma_f32_32x32x16_bf16 v[84:99], v[108:111], v[24:27], 0
  v_mfma_f32_32x32x8_bf16 v[84:99], v[112:113], v[32:33], v[84:99]
  s_nop 9
  v_max3_f32 v124, v124, v68, v69
  v_max3_f32 v124, v124, v70, v71
  v_max3_f32 v124, v124, v72, v73
  v_max3_f32 v124, v124, v74, v75
  v_max3_f32 v124, v124, v76, v77
  v_max3_f32 v124, v124, v78, v79
  v_max3_f32 v124, v124, v80, v81
  v_max3_f32 v124, v124, v82, v83
  v_max3_f32 v125, v125, v84, v85
  v_max3_f32 v125, v125, v86, v87
  v_max3_f32 v125, v125, v88, v89
  v_max3_f32 v125, v125, v90, v91
  v_max3_f32 v125, v125, v92, v93
  v_max3_f32 v125, v125, v94, v95
  v_max3_f32 v125, v125, v96, v97
  v_max3_f32 v125, v125, v98, v99
  s_add_u32 s26, s26, 1
  s_cmp_lt_u32 s26, 64
  s_cbranch_scc1 ATTF1_146
  v_mov_b32 v5, v124
  s_nop 1
  v_permlane32_swap_b32 v124, v5
  v_max_f32 v124, v124, v5
  v_sub_f32 v124, 0, v124
  v_and_b32 v5, 0xffff0000, v124
  v_sub_f32 v124, v124, v5
  v_and_b32 v6, 0xffff0000, v124
  v_sub_f32 v124, v124, v6
  v_lshrrev_b32 v5, 16, v5
  v_or_b32 v5, v5, v6
  v_and_b32 v29, v5, v17
  v_lshrrev_b32 v124, 16, v124
  v_bfi_b32 v29, v17, v5, v124
  v_mov_b32 v5, v125
  s_nop 1
  v_permlane32_swap_b32 v125, v5
  v_max_f32 v125, v125, v5
  v_sub_f32 v125, 0, v125
  v_and_b32 v5, 0xffff0000, v125
  v_sub_f32 v125, v125, v5
  v_and_b32 v6, 0xffff0000, v125
  v_sub_f32 v125, v125, v6
  v_lshrrev_b32 v5, 16, v5
  v_or_b32 v5, v5, v6
  v_and_b32 v33, v5, v17
  v_lshrrev_b32 v125, 16, v125
  v_bfi_b32 v33, v17, v5, v125
  s_mov_b32 s26, 0
ATTF2_147:
  s_lshr_b32 s27, s26, 3
  s_mul_i32 s27, s27, 19456
  s_add_u32 s27, s27, s23
  s_and_b32 s29, s26, 7
  s_lshl_b32 s28, s29, 10
  s_add_u32 s28, s28, s27
  buffer_load_dwordx4 v[108:111], v4, s[16:19], s28 offen sc1
  s_lshl_b32 s28, s29, 7
  s_add_u32 s28, s28, s27
  buffer_load_dword v112, v11, s[16:19], s28 offen sc1
  s_mul_i32 s28, s29, 1280
  s_add_u32 s28, s28, s27
  buffer_load_dwordx4 v[116:119], v12, s[16:19], s28 offen sc1
  buffer_load_dwordx4 v[120:123], v12, s[16:19], s28 offen offset:640 sc1
  s_waitcnt vmcnt(0)
  v_mfma_f32_32x32x16_bf16 v[68:83], v[108:111], v[20:23], 0
  v_mfma_f32_32x32x8_bf16 v[68:83], v[112:113], v[28:29], v[68:83]
  v_mfma_f32_32x32x16_bf16 v[84:99], v[108:111], v[24:27], 0
  v_mfma_f32_32x32x8_bf16 v[84:99], v[112:113], v[32:33], v[84:99]
  s_nop 9
  v_exp_f32 v68, v68
  v_exp_f32 v69, v69
  v_exp_f32 v70, v70
  v_exp_f32 v71, v71
  v_exp_f32 v72, v72
  v_exp_f32 v73, v73
  v_exp_f32 v74, v74
  v_exp_f32 v75, v75
  v_exp_f32 v76, v76
  v_exp_f32 v77, v77
  v_exp_f32 v78, v78
  v_exp_f32 v79, v79
  v_exp_f32 v80, v80
  v_exp_f32 v81, v81
  v_exp_f32 v82, v82
  v_exp_f32 v83, v83
  v_cvt_pk_bf16_f32 v100, v68, v69
  v_cvt_pk_bf16_f32 v101, v70, v71
  v_cvt_pk_bf16_f32 v102, v72, v73
  v_cvt_pk_bf16_f32 v103, v74, v75
  v_cvt_pk_bf16_f32 v104, v76, v77
  v_cvt_pk_bf16_f32 v105, v78, v79
  v_cvt_pk_bf16_f32 v106, v80, v81
  v_cvt_pk_bf16_f32 v107, v82, v83
  v_mfma_f32_32x32x16_bf16 v[36:51], v[116:119], v[100:103], v[36:51]
  s_nop 0
  v_mfma_f32_32x32x16_bf16 v[36:51], v[120:123], v[104:107], v[36:51]
  v_exp_f32 v84, v84
  v_exp_f32 v85, v85
  v_exp_f32 v86, v86
  v_exp_f32 v87, v87
  v_exp_f32 v88, v88
  v_exp_f32 v89, v89
  v_exp_f32 v90, v90
  v_exp_f32 v91, v91
  v_exp_f32 v92, v92
  v_exp_f32 v93, v93
  v_exp_f32 v94, v94
  v_exp_f32 v95, v95
  v_exp_f32 v96, v96
  v_exp_f32 v97, v97
  v_exp_f32 v98, v98
  v_exp_f32 v99, v99
  v_cvt_pk_bf16_f32 v100, v84, v85
  v_cvt_pk_bf16_f32 v101, v86, v87
  v_cvt_pk_bf16_f32 v102, v88, v89
  v_cvt_pk_bf16_f32 v103, v90, v91
  v_cvt_pk_bf16_f32 v104, v92, v93
  v_cvt_pk_bf16_f32 v105, v94, v95
  v_cvt_pk_bf16_f32 v106, v96, v97
  v_cvt_pk_bf16_f32 v107, v98, v99
  v_mfma_f32_32x32x16_bf16 v[52:67], v[116:119], v[100:103], v[52:67]
  s_nop 0
  v_mfma_f32_32x32x16_bf16 v[52:67], v[120:123], v[104:107], v[52:67]
  s_add_u32 s26, s26, 1
  s_cmp_lt_u32 s26, 64
  s_cbranch_scc1 ATTF2_147
  s_nop 15
  s_branch ATTFIN_141
END_1:
  s_endpgm
.section .rodata,"a"
.p2align 6
.amdhsa_kernel gated_mix__softmax_full_mha__mixer_token_mlp__prompt_kernel
  .amdhsa_next_free_vgpr 254
  .amdhsa_next_free_sgpr 102
  .amdhsa_accum_offset 256
  .amdhsa_group_segment_fixed_size 0
  .amdhsa_kernarg_size 96
  .amdhsa_user_sgpr_count 2
  .amdhsa_user_sgpr_kernarg_segment_ptr 1
  .amdhsa_system_sgpr_workgroup_id_x 1
  .amdhsa_float_denorm_mode_32 3
.end_amdhsa_kernel
```
